```python
import torch

def _softmax(x, axis=-1):
    return torch.softmax(x, dim=axis)
def _gelu(x):
    return torch.nn.functional.gelu(x, approximate="tanh")
def _silu(x):
    return torch.nn.functional.silu(x)
def _sigmoid(x):
    return torch.sigmoid(x)
def _layernorm(x, axis=-1, eps=1e-5):
    m = x.mean(dim=axis, keepdim=True)
    v = x.var(dim=axis, keepdim=True, unbiased=False)
    return (x - m) / torch.sqrt(v + eps)
def _scatter_add(tgt, idx, src, axis=0):
    return tgt.clone().index_add_(axis, idx, src)
def _segment_sum(src, seg, n):
    out = torch.zeros((n,) + src.shape[1:], dtype=src.dtype)
    return out.index_add_(0, seg, src)
def _pad(x, pw):
    flat = tuple(v for pair in reversed(pw) for v in pair)
    return torch.nn.functional.pad(x, flat)

kernel_name = 'recurrent_scan__linear_kernel_hedgehog__dense_activation_silu__prompt'

def setup_inputs():

    _w = (lambda a: (lambda t: t.to(torch.bfloat16) if t.is_floating_point() else t)(torch.as_tensor(a)))
    def _A_setup():
        B, S, D, H = 1, 2048, 640, 32
        Dh = D // H
        return {
            "x": _w((lambda *s: torch.randn(*s, dtype=torch.bfloat16) * 0.05)(B, S, D)),
            "wqkv": _w((lambda *s: torch.randn(*s, dtype=torch.bfloat16) * 0.4)(D, 3 * D)),
            "w_phi": _w((lambda *s: torch.randn(*s, dtype=torch.bfloat16) * 0.4)(H, Dh, Dh) * (Dh ** -0.5)),
            "wo": _w((lambda *s: torch.randn(*s, dtype=torch.bfloat16) * 0.2)(D, D)),
        }
    _A_in = _A_setup()

    def _B_setup():
        B, S, D, F = 1, 2048, 640, 1536
        return {
            "x": _w((lambda *s: torch.randn(*s, dtype=torch.bfloat16) * 0.05)(B, S, D)),
            "w1": _w((lambda *s: torch.randn(*s, dtype=torch.bfloat16) * 0.4)(D, F) * (D ** -0.5)),
            "w2": _w((lambda *s: torch.randn(*s, dtype=torch.bfloat16) * 0.1)(F, D) * (F ** -0.5)),
        }
    _B_in = _B_setup()

    return {
        "A_x": _A_in["x"],
        "A_wqkv": _A_in["wqkv"],
        "A_w_phi": _A_in["w_phi"],
        "A_wo": _A_in["wo"],
        "B_x": _B_in["x"],
        "B_w1": _B_in["w1"],
        "B_w2": _B_in["w2"],
    }

def reference(A_x, A_wqkv, A_w_phi, A_wo, B_x, B_w1, B_w2):
    def _A_ref(x, wqkv, w_phi, wo):
        B, S, D = x.shape
        H = 32; Dh = D // H
        qkv = (lambda x, *d: x.permute(*d))((x @ wqkv).reshape(B, S, 3, H, Dh), 2, 0, 3, 1, 4)
        q, k, v = qkv[0], qkv[1], qkv[2]
        pq = torch.einsum("bhsd,hdf->bhsf", q, w_phi)
        pk = torch.einsum("bhsd,hdf->bhsf", k, w_phi)
        phi_q = torch.concatenate([_softmax(pq, axis=-1), _softmax(-pq, axis=-1)], axis=-1)
        phi_k = torch.concatenate([_softmax(pk, axis=-1), _softmax(-pk, axis=-1)], axis=-1)
        kv = torch.einsum("bhsf,bhsd->bhfd", phi_k, v)
        z  = torch.einsum("bhsf->bhf", phi_k)
        num = torch.einsum("bhqf,bhfd->bhqd", phi_q, kv)
        den = torch.einsum("bhqf,bhf->bhq", phi_q, z)[..., None] + 1e-6
        o = num / den
        return (lambda x, *d: x.permute(*d))(o, 0, 2, 1, 3).reshape(B, S, D) @ wo

    def _B_ref(x, w1, w2):
        h = torch.einsum("bsd,df->bsf", x, w1)
        h = _silu(h)
        out = torch.einsum("bsf,fd->bsd", h, w2)
        return out

    x = A_x
    xn = _layernorm(x, axis=-1)
    s = _A_ref(xn, A_wqkv, A_w_phi, A_wo)
    g = _silu(_B_ref(xn, B_w1, B_w2))
    return x + s * g
```

```asm
; @launch grid=(256,1,1) block=(256,1,1) lds=163840
.amdgcn_target "amdgcn-amd-amdhsa--gfx950"
.text
.globl recurrent_scan__linear_kernel_hedgehog__dense_activation_silu__prompt_kernel
.p2align 8
.type recurrent_scan__linear_kernel_hedgehog__dense_activation_silu__prompt_kernel,@function
recurrent_scan__linear_kernel_hedgehog__dense_activation_silu__prompt_kernel:
    s_cmp_ge_u32 s2, 256
    s_cbranch_scc1 L_end
    s_load_dwordx16 s[4:19], s[0:1], 0
    s_load_dwordx4 s[20:23], s[0:1], 64
    s_getpc_b64 s[64:65]
    s_lshr_b32 s61, s2, 3
    s_and_b32 s63, s61, 15
    s_mul_i32 s63, s63, 34
    v_min_u32 v2, 33, v0
    v_add_lshl_u32 v2, v2, s63, 7
    global_load_dword v10, v2, s[64:65]
    v_lshrrev_b32 v6, 6, v0
    v_and_b32 v1, 63, v0
    s_and_b32 s62, s2, 7
    v_readfirstlane_b32 s56, v6
    s_and_b32 s59, s62, 3
    s_lshr_b32 s63, s62, 2
    s_lshl_b32 s63, s63, 3
    s_lshr_b32 s57, s61, 2
    s_add_u32 s57, s57, s63
    s_and_b32 s60, s61, 3
    s_and_b32 s63, s60, 1
    s_lshl_b32 s58, s59, 1
    s_add_u32 s58, s58, s63
    s_lshl_b32 s72, s56, 12
    s_lshl_b32 s63, s57, 7
    s_lshl_b32 s64, s56, 5
    s_add_u32 s63, s63, s64
    v_lshrrev_b32 v6, 3, v1
    v_add_u32_e64 v6, s63, v6
    v_mul_u32_u24 v6, 1280, v6
    v_lshrrev_b32 v7, 4, v1
    v_xor_b32 v7, v7, v1
    v_and_b32_e64 v7, 7, v7
    v_lshl_add_u32 v90, v7, 4, v6
    v_xor_b32_e64 v7, 64, v90
    v_add_u32 v91, 9216, v7
    v_add_u32 v92, 18432, v90
    v_add_u32 v93, 18432, v91
    s_lshl_b32 s91, s56, 11
    s_cmp_ge_u32 s60, 2
    s_cbranch_scc1 L_typeB
    s_mul_i32 s73, s56, 5120
    s_mul_i32 s63, s58, 160
    s_mul_i32 s64, s56, 61440
    s_add_u32 s63, s63, s64
    v_add_u32_e64 v2, 0, v1
    v_mul_u32_u24 v6, 3277, v2
    v_lshrrev_b32 v6, 16, v6
    v_mul_u32_u24 v7, 20, v6
    v_sub_u32_e64 v7, v2, v7
    v_mul_u32_u24 v8, 13108, v7
    v_lshrrev_b32 v8, 16, v8
    v_mul_u32_u24 v9, 5, v8
    v_sub_u32_e64 v9, v7, v9
    v_mul_u32_u24 v6, 3840, v6
    v_lshl_add_u32 v6, v9, 4, v6
    v_and_b32_e64 v7, 1, v8
    v_mul_u32_u24 v7, 1280, v7
    v_lshrrev_b32_e64 v8, 1, v8
    v_mul_u32_u24 v8, 80, v8
    v_add3_u32 v6, v6, v7, v8
    s_add_u32 s64, s63, 1280
    v_add_u32 v94, s64, v6
    v_add_u32 v2, 64, v1
    v_mul_u32_u24 v6, 3277, v2
    v_lshrrev_b32 v6, 16, v6
    v_mul_u32_u24 v7, 20, v6
    v_sub_u32_e64 v7, v2, v7
    v_mul_u32_u24 v8, 13108, v7
    v_lshrrev_b32 v8, 16, v8
    v_mul_u32_u24 v9, 5, v8
    v_sub_u32_e64 v9, v7, v9
    v_mul_u32_u24 v6, 3840, v6
    v_lshl_add_u32 v6, v9, 4, v6
    v_and_b32_e64 v7, 1, v8
    v_mul_u32_u24 v7, 1280, v7
    v_lshrrev_b32_e64 v8, 1, v8
    v_mul_u32_u24 v8, 80, v8
    v_add3_u32 v6, v6, v7, v8
    s_add_u32 s64, s63, 256
    v_add_u32 v95, s64, v6
    s_waitcnt lgkmcnt(0)
    s_mov_b32 s24, s4
    s_and_b32 s25, s5, 0xffff
    s_mov_b32 s26, 2621440
    s_mov_b32 s27, 0x20000
    s_add_u32 m0, s72, 0
    s_movk_i32 s69, 0
    buffer_load_dwordx4 v90, s[24:27], s69 offen offset:0 lds
    buffer_load_dwordx4 v91, s[24:27], s69 offen offset:1024 lds
    buffer_load_dwordx4 v92, s[24:27], s69 offen offset:2048 lds
    buffer_load_dwordx4 v93, s[24:27], s69 offen offset:3072 lds
    v_add_u32 v2, 128, v1
    v_mul_u32_u24 v6, 3277, v2
    v_lshrrev_b32 v6, 16, v6
    v_mul_u32_u24 v7, 20, v6
    v_sub_u32 v7, v2, v7
    v_mul_u32_u24 v8, 13108, v7
    v_lshrrev_b32 v8, 16, v8
    v_mul_u32_u24 v9, 5, v8
    v_sub_u32_e64 v9, v7, v9
    v_mul_u32_u24 v6, 3840, v6
    v_lshl_add_u32 v6, v9, 4, v6
    v_and_b32_e64 v7, 1, v8
    v_mul_u32_u24 v7, 1280, v7
    v_lshrrev_b32_e64 v8, 1, v8
    v_mul_u32_u24 v8, 80, v8
    v_add3_u32 v6, v6, v7, v8
    s_sub_u32 s64, s63, 768
    v_add_u32_e64 v96, s64, v6
    v_add_u32 v2, 192, v1
    v_mul_u32_u24 v6, 3277, v2
    v_lshrrev_b32 v6, 16, v6
    v_mul_u32_u24 v7, 20, v6
    v_sub_u32_e64 v7, v2, v7
    v_mul_u32_u24 v8, 13108, v7
    v_lshrrev_b32 v8, 16, v8
    v_mul_u32_u24 v9, 5, v8
    v_sub_u32_e64 v9, v7, v9
    v_mul_u32_u24 v6, 3840, v6
    v_lshl_add_u32 v6, v9, 4, v6
    v_and_b32_e64 v7, 1, v8
    v_mul_u32_u24 v7, 1280, v7
    v_lshrrev_b32_e64 v8, 1, v8
    v_mul_u32_u24 v8, 80, v8
    v_add3_u32 v6, v6, v7, v8
    s_sub_u32 s64, s63, 1792
    v_add_u32_e64 v97, s64, v6
    v_add_u32 v2, 256, v1
    v_mul_u32_u24 v6, 3277, v2
    v_lshrrev_b32 v6, 16, v6
    v_mul_u32_u24 v7, 20, v6
    v_sub_u32_e64 v7, v2, v7
    v_mul_u32_u24 v8, 13108, v7
    v_lshrrev_b32 v8, 16, v8
    v_mul_u32_u24 v9, 5, v8
    v_sub_u32_e64 v9, v7, v9
    v_mul_u32_u24 v6, 3840, v6
    v_lshl_add_u32 v6, v9, 4, v6
    v_and_b32_e64 v7, 1, v8
    v_mul_u32_u24 v7, 1280, v7
    v_lshrrev_b32_e64 v8, 1, v8
    v_mul_u32_u24 v8, 80, v8
    v_add3_u32 v6, v6, v7, v8
    s_add_u32 s64, s63, 1280
    v_add_u32 v98, s64, v6
    s_mov_b32 s28, s6
    s_and_b32 s29, s7, 0xffff
    s_mov_b32 s30, 2457600
    s_mov_b32 s31, 0x20000
    s_mov_b32 s70, 0
    s_add_u32 m0, s73, 16384
    s_nop 0
    buffer_load_dwordx4 v94, s[28:31], s70 offen offset:0 lds
    buffer_load_dwordx4 v95, s[28:31], s70 offen offset:1024 lds
    buffer_load_dwordx4 v96, s[28:31], s70 offen offset:2048 lds
    buffer_load_dwordx4 v97, s[28:31], s70 offen offset:3072 lds
    s_add_u32 m0, s73, 20480
    s_nop 0
    buffer_load_dwordx4 v98, s[28:31], s70 offen offset:0 lds
    v_lshrrev_b32 v11, 4, v1
    v_bfe_u32 v12, v1, 2, 2
    v_and_b32 v13, 3, v1
    v_lshrrev_b32 v14, 5, v1
    v_and_b32 v15, 31, v1
    s_mov_b32 s36, s22
    s_and_b32 s37, s23, 0xffff
    s_mov_b32 s38, 14630912
    s_mov_b32 s39, 0x20000
    s_mov_b32 s52, s20
    s_and_b32 s53, s21, 0xffff
    s_mov_b32 s54, 256
    s_mov_b32 s55, 0x20000
    s_memrealtime s[82:83]
    s_mov_b32 s44, s8
    s_and_b32 s45, s9, 0xffff
    s_mov_b32 s46, 25600
    s_mov_b32 s47, 0x20000
    s_cmp_eq_u32 s2, 0
    s_cselect_b32 s63, 0, 2130706432
    v_lshlrev_b32 v7, 8, v0
    v_add_u32 v7, s63, v7
    s_waitcnt lgkmcnt(0)
    s_or_b32 s82, s82, 1
    v_mov_b32 v6, s82
    buffer_store_dword v6, v7, s[52:55], 0 offen sc1
    s_mul_i32 s63, s58, 3200
    v_lshlrev_b32_e64 v2, 3, v0
    v_add_u32 v3, 2048, v2
    v_cmp_gt_u32 vcc, 3200, v3
    v_mov_b32 v4, 2130706432
    buffer_load_dwordx2 v[100:101], v2, s[44:47], s63 offen
    v_cndmask_b32_e64 v3, v4, v3, vcc
    buffer_load_dwordx2 v[102:103], v3, s[44:47], s63 offen
    s_cmp_eq_u32 s56, 1
    s_cselect_b32 s44, s6, s4
    s_cselect_b32 s45, s7, s5
    s_mov_b32 s46, 2621440
    s_cselect_b32 s46, 2457600, s46
    s_mov_b32 s101, 128
    s_cselect_b32 s101, 245760, s101
    s_cmp_eq_u32 s56, 2
    s_cselect_b32 s44, s14, s44
    s_cselect_b32 s45, s15, s45
    s_cselect_b32 s46, 1966080, s46
    s_cselect_b32 s101, 196608, s101
    s_and_b32 s45, s45, 0xffff
    s_lshl_b32 s63, s57, 2
    s_add_u32 s63, s63, s60
    s_lshl_b32 s63, s63, 5
    v_add_u32 v2, s63, v15
    v_mul_u32_u24 v2, 1280, v2
    v_mul_u32_u24 v3, 7282, v15
    v_lshrrev_b32 v3, 16, v3
    v_mul_u32_u24 v4, 9, v3
    v_sub_u32_e64 v4, v15, v4
    v_mul_u32_u24 v5, 21846, v4
    v_lshrrev_b32 v5, 16, v5
    v_mul_u32_u24 v6, 3, v5
    v_sub_u32 v6, v4, v6
    s_lshl_b32 s63, s61, 1
    v_add_u32 v3, s63, v3
    v_mul_u32_u24 v3, 30, v3
    v_mad_u32_u24 v3, v5, 10, v3
    s_mul_i32 s64, s59, 5
    s_lshr_b32 s64, s64, 1
    v_add3_u32 v3, v3, v6, s64
    v_lshlrev_b32_e64 v3, 7, v3
    v_mul_u32_u24 v4, 10923, v15
    v_lshrrev_b32 v4, 16, v4
    v_mul_u32_u24 v5, 6, v4
    v_sub_u32 v5, v15, v5
    v_add_u32 v4, s63, v4
    v_mul_u32_u24 v4, 24, v4
    s_mul_i32 s64, s59, 6
    v_add3_u32 v4, v4, v5, s64
    v_lshlrev_b32 v4, 7, v4
    s_cmp_eq_u32 s56, 1
    s_cselect_b64 vcc, -1, 0
    s_cselect_b32 s64, 18, 32
    v_cndmask_b32 v2, v2, v3, vcc
    s_cmp_eq_u32 s56, 2
    s_cselect_b64 vcc, -1, 0
    s_cselect_b32 s64, 12, s64
    v_cndmask_b32 v2, v2, v4, vcc
    s_cmp_eq_u32 s56, 3
    s_cselect_b32 s64, 0, s64
    v_mul_u32_u24 v3, s101, v14
    v_add_u32 v2, v2, v3
    v_cmp_gt_u32 vcc, s64, v15
    v_mov_b32 v3, 2130706432
    s_add_u32 m0, s72, 36864
    s_movk_i32 s69, 128
    buffer_load_dwordx4 v90, s[24:27], s69 offen offset:0 lds
    v_cndmask_b32 v99, v3, v2, vcc
    s_mul_i32 s100, s101, 1
    s_waitcnt vmcnt(13)
    buffer_load_dword v10, v99, s[44:47], s100 offen
    v_and_b32 v6, 1, v11
    v_lshlrev_b32 v6, 2, v6
    v_and_b32 v7, 7, v1
    v_cmp_eq_u32 vcc, v6, v7
    v_mov_b32 v6, 0x3f803f80
    s_nop 0
    v_cndmask_b32 v20, 0, v6, vcc
    v_cndmask_b32 v21, 0, v6, vcc
    v_cndmask_b32 v22, 0, v6, vcc
    v_cndmask_b32 v23, 0, v6, vcc
    v_lshlrev_b32 v6, 7, v15
    v_add_u32_e64 v6, s72, v6
    v_bfe_u32 v7, v15, 1, 3
    v_xor_b32 v7, v7, v14
    s_xor_b32 s63, s56, 0
    s_lshl_b32 s63, s63, 1
    v_xor_b32 v8, s63, v7
    v_lshl_add_u32 v106, v8, 4, v6
    s_xor_b32 s63, s56, 1
    s_lshl_b32 s63, s63, 1
    v_xor_b32_e64 v8, s63, v7
    buffer_load_dwordx4 v91, s[24:27], s69 offen offset:1024 lds
    v_lshl_add_u32 v107, v8, 4, v6
    s_xor_b32 s63, s56, 2
    s_lshl_b32 s63, s63, 1
    v_xor_b32_e64 v8, s63, v7
    v_lshl_add_u32 v108, v8, 4, v6
    s_xor_b32 s63, s56, 3
    s_lshl_b32 s63, s63, 1
    v_xor_b32_e64 v8, s63, v7
    v_lshl_add_u32 v109, v8, 4, v6
    v_lshl_add_u32 v6, v14, 3, v12
    v_mul_u32_u24 v6, 320, v6
    v_and_b32_e64 v7, 1, v13
    v_mul_u32_u24 v7, 160, v7
    v_add_u32 v6, v6, v7
    v_and_b32 v7, 1, v11
    v_lshlrev_b32 v7, 1, v7
    v_lshrrev_b32 v8, 1, v13
    v_add_u32_e64 v7, v7, v8
    v_lshl_add_u32 v6, v7, 3, v6
    s_xor_b32 s63, s56, 0
    s_mul_i32 s63, s63, 5120
    v_add_u32 v110, s63, v6
    s_xor_b32 s63, s56, 1
    buffer_load_dwordx4 v92, s[24:27], s69 offen offset:2048 lds
    s_mul_i32 s63, s63, 5120
    v_add_u32 v111, s63, v6
    s_xor_b32 s63, s56, 2
    s_mul_i32 s63, s63, 5120
    v_add_u32 v112, s63, v6
    s_xor_b32 s63, s56, 3
    s_mul_i32 s63, s63, 5120
    v_add_u32 v113, s63, v6
    v_mov_b32_e64 v2, v0
    v_mul_u32_u24 v3, 656, v2
    v_lshrrev_b32_e64 v3, 16, v3
    v_mul_u32_u24 v4, 100, v3
    v_sub_u32_e64 v4, v2, v4
    v_mul_u32_u24 v5, 13108, v4
    v_lshrrev_b32 v5, 16, v5
    v_mul_u32_u24 v6, 5, v5
    v_sub_u32 v6, v4, v6
    v_and_b32 v7, 1, v3
    v_mul_u32_u24 v7, 1960, v7
    v_lshrrev_b32_e64 v3, 1, v3
    v_mul_u32_u24 v3, 3840, v3
    v_mul_u32_u24 v5, 96, v5
    v_lshl_add_u32 v5, v6, 3, v5
    v_add3_u32 v3, v3, v5, v7
    buffer_load_dwordx4 v93, s[24:27], s69 offen offset:3072 lds
    v_add_u32 v104, 147456, v3
    v_add_u32 v2, 256, v0
    v_mul_u32_u24 v3, 656, v2
    v_lshrrev_b32_e64 v3, 16, v3
    v_mul_u32_u24 v4, 100, v3
    v_sub_u32_e64 v4, v2, v4
    v_mul_u32_u24 v5, 13108, v4
    v_lshrrev_b32 v5, 16, v5
    v_mul_u32_u24 v6, 5, v5
    v_sub_u32 v6, v4, v6
    v_and_b32 v7, 1, v3
    v_mul_u32_u24 v7, 1960, v7
    v_lshrrev_b32_e64 v3, 1, v3
    v_mul_u32_u24 v3, 3840, v3
    v_mul_u32_u24 v5, 96, v5
    v_lshl_add_u32 v5, v6, 3, v5
    v_add3_u32 v3, v3, v5, v7
    v_add_u32 v105, 147456, v3
    v_cmp_gt_u32 vcc, 144, v0
    v_mov_b32 v3, 155136
    s_nop 0
    v_cndmask_b32 v105, v3, v105, vcc
    s_lshr_b32 s63, s61, 2
    s_lshl_b32 s63, s63, 4
    s_mov_b32 s70, 245760
    s_add_u32 m0, s73, 53248
    s_nop 0
    buffer_load_dwordx4 v94, s[28:31], s70 offen offset:0 lds
    s_and_b32 s64, s60, 1
    s_lshl_b32 s64, s64, 3
    s_add_u32 s63, s63, s64
    s_add_u32 s63, s63, s62
    s_add_u32 s63, s63, 128
    s_mul_i32 s90, s63, 6554
    s_lshr_b32 s90, s90, 16
    s_mul_i32 s64, s90, 10
    s_sub_u32 s89, s63, s64
    s_cmp_lt_u32 s90, 17
    s_cselect_b32 s68, 0, 2130706432
    s_cmp_lt_u32 s90, 12
    s_cselect_b32 s40, s16, s10
    s_cselect_b32 s41, s17, s11
    s_mov_b32 s42, 819200
    s_cselect_b32 s42, 1966080, s42
    s_cselect_b32 s64, 0, 48
    s_cselect_b32 s65, 1, 0
    s_and_b32 s41, s41, 0xffff
    s_mov_b32 s43, 0x20000
    s_lshl_b32 s66, s90, 2
    s_add_u32 s66, s66, s56
    s_sub_u32 s64, s66, s64
    buffer_load_dwordx4 v95, s[28:31], s70 offen offset:1024 lds
    s_mul_i32 s63, s90, 86
    s_lshr_b32 s63, s63, 8
    s_sub_u32 s67, s90, s63
    s_sub_u32 s67, s67, 1
    s_mul_i32 s66, s63, 3
    s_add_u32 s63, s63, 8
    s_cmp_eq_u32 s66, s90
    s_cselect_b32 s67, s63, s67
    s_cmp_lt_u32 s90, 12
    s_cselect_b32 s67, s67, s90
    s_lshl_b32 s66, s67, 2
    s_add_u32 s66, s66, s56
    s_mul_i32 s64, s64, 40960
    s_lshl_b32 s63, s89, 7
    s_add_u32 s64, s64, s63
    s_add_u32 s64, s64, s68
    v_lshrrev_b32 v6, 3, v1
    v_mul_u32_u24 v6, 1280, v6
    v_and_b32_e64 v7, 7, v1
    v_lshl_add_u32 v6, v7, 4, v6
    v_add_u32 v114, s64, v6
    v_and_b32 v6, 1, v11
    v_lshlrev_b32_e64 v6, 2, v6
    v_lshl_add_u32 v6, v14, 4, v6
    buffer_load_dwordx4 v96, s[28:31], s70 offen offset:2048 lds
    v_lshlrev_b32 v7, 3, v11
    s_cmp_eq_u32 s65, 1
    s_cselect_b64 vcc, -1, 0
    s_cselect_b32 s63, 2, 1
    s_lshl_b32 s63, s63, 9
    v_cndmask_b32 v6, v7, v6, vcc
    v_add_u32 v6, v6, v12
    v_lshlrev_b32 v6, 7, v6
    v_lshl_add_u32 v6, v13, 3, v6
    s_add_u32 s64, s72, 147456
    v_add_u32 v116, s64, v6
    v_add_u32 v117, s63, v116
    v_lshlrev_b32 v6, 4, v1
    s_lshl_b32 s63, s89, 2
    s_add_u32 s63, s63, 0
    s_mul_i32 s64, s63, 13108
    s_lshr_b32 s64, s64, 16
    s_mul_i32 s65, s64, 335
    s_add_u32 s63, s63, s65
    s_mul_i32 s65, s66, 5
    s_add_u32 s63, s63, s65
    s_lshl_b32 s63, s63, 10
    s_add_u32 s63, s63, 8912896
    buffer_load_dwordx4 v97, s[28:31], s70 offen offset:3072 lds
    s_add_u32 s63, s63, s68
    v_add_u32 v120, s63, v6
    s_lshl_b32 s63, s89, 2
    s_add_u32 s63, s63, 1
    s_mul_i32 s64, s63, 13108
    s_lshr_b32 s64, s64, 16
    s_mul_i32 s65, s64, 335
    s_add_u32 s63, s63, s65
    s_mul_i32 s65, s66, 5
    s_add_u32 s63, s63, s65
    s_lshl_b32 s63, s63, 10
    s_add_u32 s63, s63, 8912896
    s_add_u32 s63, s63, s68
    v_add_u32 v121, s63, v6
    s_lshl_b32 s63, s89, 2
    s_add_u32 s63, s63, 2
    s_mul_i32 s64, s63, 13108
    s_lshr_b32 s64, s64, 16
    s_mul_i32 s65, s64, 335
    s_add_u32 s63, s63, s65
    s_mul_i32 s65, s66, 5
    s_add_u32 s63, s63, s65
    s_lshl_b32 s63, s63, 10
    s_add_u32 m0, s73, 57344
    s_nop 0
    buffer_load_dwordx4 v98, s[28:31], s70 offen offset:0 lds
    s_add_u32 s63, s63, 8912896
    s_add_u32 s63, s63, s68
    v_add_u32 v122, s63, v6
    s_lshl_b32 s63, s89, 2
    s_add_u32 s63, s63, 3
    s_mul_i32 s64, s63, 13108
    s_lshr_b32 s64, s64, 16
    s_mul_i32 s65, s64, 335
    s_add_u32 s63, s63, s65
    s_mul_i32 s65, s66, 5
    s_add_u32 s63, s63, s65
    s_lshl_b32 s63, s63, 10
    s_add_u32 s63, s63, 8912896
    s_add_u32 s63, s63, s68
    v_add_u32 v123, s63, v6
    s_lshl_b32 s63, s89, 7
    s_lshl_b32 s64, s90, 2
    s_add_u32 s63, s63, s64
    s_add_u32 s63, s63, 13547520
    s_add_u32 s63, s63, s68
    v_cmp_eq_u32 vcc, 0, v0
    v_mov_b32 v6, s63
    v_mov_b32 v115, 2130706432
    v_cndmask_b32 v115, v115, v6, vcc
    s_lshl_b32 s63, s59, 2
    s_add_u32 s63, s63, s60
    s_lshl_b32 s63, s63, 2
    s_add_u32 s63, s63, s56
    s_lshl_b32 s64, s57, 6
    s_add_u32 s63, s63, s64
    s_lshl_b32 s63, s63, 1
    v_lshrrev_b32 v2, 5, v1
    v_add_u32 v118, s63, v2
    v_mul_u32_u24 v2, 1280, v118
    v_and_b32_e64 v3, 31, v1
    v_lshl_add_u32 v2, v3, 4, v2
    v_cmp_gt_u32_e64 vcc, 16, v3
    v_mov_b32 v4, 2130706432
    buffer_load_dwordx4 v[124:127], v2, s[24:27], 0 offen
    v_cndmask_b32_e64 v4, v4, v2, vcc
    buffer_load_dwordx4 v[128:131], v2, s[24:27], 0 offen offset:512
    buffer_load_dwordx4 v[132:135], v4, s[24:27], 0 offen offset:1024
    s_mul_i32 s100, s101, 3
    s_waitcnt vmcnt(11)
    buffer_load_dword v10, v99, s[44:47], s100 offen
    s_barrier
    ds_read_b128 a[0:3], v106 offset:0
    ds_read_b64_tr_b16 a[160:161], v110 offset:16384
    ds_read_b64_tr_b16 a[162:163], v110 offset:17664
    ds_read_b64_tr_b16 a[164:165], v110 offset:16416
    ds_read_b64_tr_b16 a[166:167], v110 offset:17696
    ds_read_b64_tr_b16 a[168:169], v110 offset:16448
    ds_read_b64_tr_b16 a[170:171], v110 offset:17728
    ds_read_b64_tr_b16 a[172:173], v110 offset:16480
    ds_read_b64_tr_b16 a[174:175], v110 offset:17760
    ds_read_b64_tr_b16 a[176:177], v110 offset:16512
    ds_read_b64_tr_b16 a[178:179], v110 offset:17792
    s_waitcnt lgkmcnt(6)
    v_mfma_f32_32x32x16_bf16 v[176:191], a[160:163], a[0:3], 0
    ds_read_b128 a[4:7], v107 offset:0
    ds_read_b64_tr_b16 a[180:181], v111 offset:16384
    ds_read_b64_tr_b16 a[182:183], v111 offset:17664
    ds_read_b64_tr_b16 a[184:185], v111 offset:16416
    ds_read_b64_tr_b16 a[186:187], v111 offset:17696
    ds_read_b64_tr_b16 a[188:189], v111 offset:16448
    v_mfma_f32_32x32x16_bf16 v[192:207], a[164:167], a[0:3], 0
    ds_read_b64_tr_b16 a[190:191], v111 offset:17728
    ds_read_b64_tr_b16 a[192:193], v111 offset:16480
    ds_read_b64_tr_b16 a[194:195], v111 offset:17760
    ds_read_b64_tr_b16 a[196:197], v111 offset:16512
    ds_read_b64_tr_b16 a[198:199], v111 offset:17792
    s_waitcnt lgkmcnt(11)
    v_mfma_f32_32x32x16_bf16 v[208:223], a[168:171], a[0:3], 0
    s_add_u32 m0, s72, 73728
    s_movk_i32 s69, 256
    buffer_load_dwordx4 v90, s[24:27], s69 offen offset:0 lds
    v_mov_b32 v136, 0
    v_mov_b32 v137, 0
    v_mov_b32_e64 v138, 0
    v_mfma_f32_32x32x16_bf16 v[224:239], a[172:175], a[0:3], 0
    buffer_load_dwordx4 v91, s[24:27], s69 offen offset:1024 lds
    v_mov_b32 v139, 0
    v_lshlrev_b32 v2, 4, v0
    v_add_u32 v2, 147456, v2
    ds_write_b128 v2, v[136:139] offset:0
    ds_write_b128 v2, v[136:139] offset:4096
    v_mfma_f32_32x32x16_bf16 v[240:255], a[176:179], a[0:3], 0
    buffer_load_dwordx4 v92, s[24:27], s69 offen offset:2048 lds
    ds_write_b128 v2, v[136:139] offset:8192
    s_mov_b32 s88, 0xffffff00
    s_mov_b32 s76, 0x7060500
    s_mov_b32 s77, 0x7060501
    s_mov_b32 s78, 0x7060502
    v_mfma_f32_16x16x32_bf16 v[156:159], v[20:23], a[160:163], 0
    s_mov_b32 s79, 0x7060503
    s_mov_b32 s48, s18
    v_mfma_f32_16x16x32_bf16 v[160:163], v[20:23], a[164:167], 0
    s_and_b32 s49, s19, 0xffff
    s_mov_b32 s50, 2621440
    v_mfma_f32_16x16x32_bf16 v[164:167], v[20:23], a[168:171], 0
    s_mov_b32 s51, 0x20000
    v_mfma_f32_16x16x32_bf16 v[168:171], v[20:23], a[172:175], 0
    buffer_load_dwordx4 v93, s[24:27], s69 offen offset:3072 lds
    v_mfma_f32_16x16x32_bf16 v[172:175], v[20:23], a[176:179], 0
    s_waitcnt lgkmcnt(9)
    v_mfma_f32_32x32x16_bf16 v[176:191], a[180:183], a[4:7], v[176:191]
    ds_read_b128 a[8:11], v108 offset:0
    ds_read_b64_tr_b16 a[160:161], v112 offset:16384
    ds_read_b64_tr_b16 a[162:163], v112 offset:17664
    ds_read_b64_tr_b16 a[164:165], v112 offset:16416
    ds_read_b64_tr_b16 a[166:167], v112 offset:17696
    ds_read_b64_tr_b16 a[168:169], v112 offset:16448
    v_mfma_f32_32x32x16_bf16 v[192:207], a[184:187], a[4:7], v[192:207]
    ds_read_b64_tr_b16 a[170:171], v112 offset:17728
    ds_read_b64_tr_b16 a[172:173], v112 offset:16480
    ds_read_b64_tr_b16 a[174:175], v112 offset:17760
    ds_read_b64_tr_b16 a[176:177], v112 offset:16512
    ds_read_b64_tr_b16 a[178:179], v112 offset:17792
    s_waitcnt lgkmcnt(14)
    v_mfma_f32_32x32x16_bf16 v[208:223], a[188:191], a[4:7], v[208:223]
    s_mov_b32 s70, 491520
    s_add_u32 m0, s73, 90112
    s_nop 0
    buffer_load_dwordx4 v94, s[28:31], s70 offen offset:0 lds
    v_mfma_f32_32x32x16_bf16 v[224:239], a[192:195], a[4:7], v[224:239]
    buffer_load_dwordx4 v95, s[28:31], s70 offen offset:1024 lds
    v_mfma_f32_32x32x16_bf16 v[240:255], a[196:199], a[4:7], v[240:255]
    s_waitcnt lgkmcnt(6)
    v_mfma_f32_32x32x16_bf16 v[176:191], a[160:163], a[8:11], v[176:191]
    ds_read_b128 a[12:15], v109 offset:0
    ds_read_b64_tr_b16 a[180:181], v113 offset:16384
    ds_read_b64_tr_b16 a[182:183], v113 offset:17664
    ds_read_b64_tr_b16 a[184:185], v113 offset:16416
    ds_read_b64_tr_b16 a[186:187], v113 offset:17696
    ds_read_b64_tr_b16 a[188:189], v113 offset:16448
    v_mfma_f32_32x32x16_bf16 v[192:207], a[164:167], a[8:11], v[192:207]
    ds_read_b64_tr_b16 a[190:191], v113 offset:17728
    ds_read_b64_tr_b16 a[192:193], v113 offset:16480
    ds_read_b64_tr_b16 a[194:195], v113 offset:17760
    ds_read_b64_tr_b16 a[196:197], v113 offset:16512
    ds_read_b64_tr_b16 a[198:199], v113 offset:17792
    s_waitcnt lgkmcnt(11)
    v_mfma_f32_32x32x16_bf16 v[208:223], a[168:171], a[8:11], v[208:223]
    buffer_load_dwordx4 v96, s[28:31], s70 offen offset:2048 lds
    v_mfma_f32_32x32x16_bf16 v[224:239], a[172:175], a[8:11], v[224:239]
    buffer_load_dwordx4 v97, s[28:31], s70 offen offset:3072 lds
    v_mfma_f32_32x32x16_bf16 v[240:255], a[176:179], a[8:11], v[240:255]
    s_add_u32 m0, s73, 94208
    s_nop 0
    buffer_load_dwordx4 v98, s[28:31], s70 offen offset:0 lds
    s_waitcnt vmcnt(13) lgkmcnt(0)
    s_barrier
    v_mfma_f32_32x32x16_bf16 v[176:191], a[180:183], a[12:15], v[176:191]
    ds_read_b128 a[16:19], v106 offset:36864
    ds_read_b64_tr_b16 a[160:161], v110 offset:53248
    ds_read_b64_tr_b16 a[162:163], v110 offset:54528
    ds_read_b64_tr_b16 a[164:165], v110 offset:53280
    ds_read_b64_tr_b16 a[166:167], v110 offset:54560
    ds_read_b64_tr_b16 a[168:169], v110 offset:53312
    v_mfma_f32_32x32x16_bf16 v[192:207], a[184:187], a[12:15], v[192:207]
    ds_read_b64_tr_b16 a[170:171], v110 offset:54592
    ds_read_b64_tr_b16 a[172:173], v110 offset:53344
    ds_read_b64_tr_b16 a[174:175], v110 offset:54624
    ds_read_b64_tr_b16 a[176:177], v110 offset:53376
    ds_read_b64_tr_b16 a[178:179], v110 offset:54656
    v_mfma_f32_32x32x16_bf16 v[208:223], a[188:191], a[12:15], v[208:223]
    v_add_u32 v106, 73728, v106
    v_add_u32 v110, 90112, v110
    s_mul_i32 s100, s101, 5
    s_waitcnt vmcnt(9)
    buffer_load_dword v10, v99, s[44:47], s100 offen
    buffer_load_dword v16, off, s[52:55], 0 sc1
    ds_write_b64 v104, v[100:101]
    v_mfma_f32_32x32x16_bf16 v[224:239], a[192:195], a[12:15], v[224:239]
    s_add_u32 m0, s72, 110592
    s_movk_i32 s69, 384
    buffer_load_dwordx4 v90, s[24:27], s69 offen offset:0 lds
    ds_write_b64 v105, v[102:103]
    v_mfma_f32_32x32x16_bf16 v[240:255], a[196:199], a[12:15], v[240:255]
    s_waitcnt lgkmcnt(8)
    v_mfma_f32_32x32x16_bf16 v[176:191], a[160:163], a[16:19], v[176:191]
    ds_read_b128 a[20:23], v107 offset:36864
    ds_read_b64_tr_b16 a[180:181], v111 offset:53248
    ds_read_b64_tr_b16 a[182:183], v111 offset:54528
    ds_read_b64_tr_b16 a[184:185], v111 offset:53280
    ds_read_b64_tr_b16 a[186:187], v111 offset:54560
    ds_read_b64_tr_b16 a[188:189], v111 offset:53312
    v_mfma_f32_32x32x16_bf16 v[192:207], a[164:167], a[16:19], v[192:207]
    ds_read_b64_tr_b16 a[190:191], v111 offset:54592
    ds_read_b64_tr_b16 a[192:193], v111 offset:53344
    ds_read_b64_tr_b16 a[194:195], v111 offset:54624
    ds_read_b64_tr_b16 a[196:197], v111 offset:53376
    ds_read_b64_tr_b16 a[198:199], v111 offset:54656
    s_waitcnt lgkmcnt(13)
    v_mfma_f32_32x32x16_bf16 v[208:223], a[168:171], a[16:19], v[208:223]
    v_add_u32 v107, 73728, v107
    v_add_u32 v111, 90112, v111
    buffer_load_dwordx4 v91, s[24:27], s69 offen offset:1024 lds
    v_mfma_f32_32x32x16_bf16 v[224:239], a[172:175], a[16:19], v[224:239]
    buffer_load_dwordx4 v92, s[24:27], s69 offen offset:2048 lds
    v_mfma_f32_32x32x16_bf16 v[240:255], a[176:179], a[16:19], v[240:255]
    buffer_load_dwordx4 v93, s[24:27], s69 offen offset:3072 lds
    v_mfma_f32_16x16x32_bf16 v[156:159], v[20:23], a[160:163], v[156:159]
    v_mfma_f32_16x16x32_bf16 v[160:163], v[20:23], a[164:167], v[160:163]
    v_mfma_f32_16x16x32_bf16 v[164:167], v[20:23], a[168:171], v[164:167]
    v_mfma_f32_16x16x32_bf16 v[168:171], v[20:23], a[172:175], v[168:171]
    s_mov_b32 s70, 737280
    s_add_u32 m0, s73, 126976
    v_mfma_f32_16x16x32_bf16 v[172:175], v[20:23], a[176:179], v[172:175]
    buffer_load_dwordx4 v94, s[28:31], s70 offen offset:0 lds
    s_waitcnt lgkmcnt(6)
    v_mfma_f32_32x32x16_bf16 v[176:191], a[180:183], a[20:23], v[176:191]
    ds_read_b128 a[24:27], v108 offset:36864
    ds_read_b64_tr_b16 a[160:161], v112 offset:53248
    ds_read_b64_tr_b16 a[162:163], v112 offset:54528
    ds_read_b64_tr_b16 a[164:165], v112 offset:53280
    ds_read_b64_tr_b16 a[166:167], v112 offset:54560
    ds_read_b64_tr_b16 a[168:169], v112 offset:53312
    v_mfma_f32_32x32x16_bf16 v[192:207], a[184:187], a[20:23], v[192:207]
    ds_read_b64_tr_b16 a[170:171], v112 offset:54592
    ds_read_b64_tr_b16 a[172:173], v112 offset:53344
    ds_read_b64_tr_b16 a[174:175], v112 offset:54624
    ds_read_b64_tr_b16 a[176:177], v112 offset:53376
    ds_read_b64_tr_b16 a[178:179], v112 offset:54656
    s_waitcnt lgkmcnt(11)
    v_mfma_f32_32x32x16_bf16 v[208:223], a[188:191], a[20:23], v[208:223]
    v_add_u32 v108, 73728, v108
    v_add_u32 v112, 90112, v112
    buffer_load_dwordx4 v95, s[28:31], s70 offen offset:1024 lds
    v_mfma_f32_32x32x16_bf16 v[224:239], a[192:195], a[20:23], v[224:239]
    buffer_load_dwordx4 v96, s[28:31], s70 offen offset:2048 lds
    v_mfma_f32_32x32x16_bf16 v[240:255], a[196:199], a[20:23], v[240:255]
    s_waitcnt lgkmcnt(6)
    v_mfma_f32_32x32x16_bf16 v[176:191], a[160:163], a[24:27], v[176:191]
    ds_read_b128 a[28:31], v109 offset:36864
    ds_read_b64_tr_b16 a[180:181], v113 offset:53248
    ds_read_b64_tr_b16 a[182:183], v113 offset:54528
    ds_read_b64_tr_b16 a[184:185], v113 offset:53280
    ds_read_b64_tr_b16 a[186:187], v113 offset:54560
    ds_read_b64_tr_b16 a[188:189], v113 offset:53312
    v_mfma_f32_32x32x16_bf16 v[192:207], a[164:167], a[24:27], v[192:207]
    ds_read_b64_tr_b16 a[190:191], v113 offset:54592
    ds_read_b64_tr_b16 a[192:193], v113 offset:53344
    ds_read_b64_tr_b16 a[194:195], v113 offset:54624
    ds_read_b64_tr_b16 a[196:197], v113 offset:53376
    ds_read_b64_tr_b16 a[198:199], v113 offset:54656
    s_waitcnt lgkmcnt(11)
    v_mfma_f32_32x32x16_bf16 v[208:223], a[168:171], a[24:27], v[208:223]
    v_add_u32 v109, 73728, v109
    v_add_u32 v113, 90112, v113
    buffer_load_dwordx4 v97, s[28:31], s70 offen offset:3072 lds
    v_mfma_f32_32x32x16_bf16 v[224:239], a[172:175], a[24:27], v[224:239]
    s_add_u32 m0, s73, 131072
    s_nop 0
    buffer_load_dwordx4 v98, s[28:31], s70 offen offset:0 lds
    v_mfma_f32_32x32x16_bf16 v[240:255], a[176:179], a[24:27], v[240:255]
    s_mul_i32 s100, s101, 7
    s_waitcnt vmcnt(10)
    buffer_load_dword v10, v99, s[44:47], s100 offen
    s_waitcnt lgkmcnt(0)
    s_barrier
    v_mfma_f32_32x32x16_bf16 v[176:191], a[180:183], a[28:31], v[176:191]
    ds_read_b128 a[32:35], v106 offset:0
    ds_read_b64_tr_b16 a[160:161], v110 offset:0
    ds_read_b64_tr_b16 a[162:163], v110 offset:1280
    ds_read_b64_tr_b16 a[164:165], v110 offset:32
    ds_read_b64_tr_b16 a[166:167], v110 offset:1312
    ds_read_b64_tr_b16 a[168:169], v110 offset:64
    v_mfma_f32_32x32x16_bf16 v[192:207], a[184:187], a[28:31], v[192:207]
    ds_read_b64_tr_b16 a[170:171], v110 offset:1344
    ds_read_b64_tr_b16 a[172:173], v110 offset:96
    ds_read_b64_tr_b16 a[174:175], v110 offset:1376
    ds_read_b64_tr_b16 a[176:177], v110 offset:128
    ds_read_b64_tr_b16 a[178:179], v110 offset:1408
    v_mfma_f32_32x32x16_bf16 v[208:223], a[188:191], a[28:31], v[208:223]
    s_add_u32 m0, s72, 0
    s_movk_i32 s69, 512
    buffer_load_dwordx4 v90, s[24:27], s69 offen offset:0 lds
    v_and_b32 v2, 1, v13
    v_cmp_eq_u32_e64 vcc, v2, v14
    v_mul_u32_u24 v2, 3840, v14
    v_mfma_f32_32x32x16_bf16 v[224:239], a[192:195], a[28:31], v[224:239]
    buffer_load_dwordx4 v91, s[24:27], s69 offen offset:1024 lds
    v_mul_u32_u24 v3, 96, v12
    v_and_b32 v4, 1, v11
    v_lshlrev_b32 v4, 1, v4
    v_lshrrev_b32_e64 v5, 1, v13
    v_mfma_f32_32x32x16_bf16 v[240:255], a[196:199], a[28:31], v[240:255]
    v_add_u32_e64 v4, v4, v5
    v_lshl_add_u32 v3, v4, 3, v3
    v_add_u32_e64 v2, v2, v3
    v_mov_b32 v3, 7680
    s_waitcnt lgkmcnt(6)
    v_mfma_f32_32x32x16_bf16 v[176:191], a[160:163], a[32:35], v[176:191]
    ds_read_b128 a[36:39], v107 offset:0
    ds_read_b64_tr_b16 a[180:181], v111 offset:0
    ds_read_b64_tr_b16 a[182:183], v111 offset:1280
    ds_read_b64_tr_b16 a[184:185], v111 offset:32
    ds_read_b64_tr_b16 a[186:187], v111 offset:1312
    ds_read_b64_tr_b16 a[188:189], v111 offset:64
    v_mfma_f32_32x32x16_bf16 v[192:207], a[164:167], a[32:35], v[192:207]
    ds_read_b64_tr_b16 a[190:191], v111 offset:1344
    ds_read_b64_tr_b16 a[192:193], v111 offset:96
    ds_read_b64_tr_b16 a[194:195], v111 offset:1376
    ds_read_b64_tr_b16 a[196:197], v111 offset:128
    ds_read_b64_tr_b16 a[198:199], v111 offset:1408
    s_waitcnt lgkmcnt(11)
    v_mfma_f32_32x32x16_bf16 v[208:223], a[168:171], a[32:35], v[208:223]
    buffer_load_dwordx4 v92, s[24:27], s69 offen offset:2048 lds
    v_cndmask_b32_e64 v2, v3, v2, vcc
    v_add_u32 v104, 147456, v2
    ds_read_b64_tr_b16 a[200:201], v104 offset:0
    ds_read_b64_tr_b16 a[202:203], v104 offset:384
    ds_read_b64_tr_b16 a[204:205], v104 offset:768
    v_mfma_f32_32x32x16_bf16 v[224:239], a[172:175], a[32:35], v[224:239]
    buffer_load_dwordx4 v93, s[24:27], s69 offen offset:3072 lds
    ds_read_b64_tr_b16 a[206:207], v104 offset:1152
    ds_read_b64_tr_b16 a[208:209], v104 offset:1536
    ds_read_b64_tr_b16 a[210:211], v104 offset:1920
    ds_read_b64_tr_b16 a[212:213], v104 offset:32
    ds_read_b64_tr_b16 a[214:215], v104 offset:416
    v_mfma_f32_32x32x16_bf16 v[240:255], a[176:179], a[32:35], v[240:255]
    s_mov_b32 s70, 983040
    s_add_u32 m0, s73, 16384
    s_nop 0
    buffer_load_dwordx4 v94, s[28:31], s70 offen offset:0 lds
    ds_read_b64_tr_b16 a[216:217], v104 offset:800
    ds_read_b64_tr_b16 a[218:219], v104 offset:1184
    ds_read_b64_tr_b16 a[220:221], v104 offset:1568
    v_mfma_f32_16x16x32_bf16 v[156:159], v[20:23], a[160:163], v[156:159]
    ds_read_b64_tr_b16 a[222:223], v104 offset:1952
    ds_read_b64_tr_b16 a[224:225], v104 offset:2336
    v_mfma_f32_16x16x32_bf16 v[160:163], v[20:23], a[164:167], v[160:163]
    ds_read_b64_tr_b16 a[226:227], v104 offset:2720
    ds_read_b64_tr_b16 a[228:229], v104 offset:3104
    v_mfma_f32_16x16x32_bf16 v[164:167], v[20:23], a[168:171], v[164:167]
    ds_read_b64_tr_b16 a[230:231], v104 offset:3488
    ds_read_b64_tr_b16 a[232:233], v104 offset:1600
    v_mfma_f32_16x16x32_bf16 v[168:171], v[20:23], a[172:175], v[168:171]
    buffer_load_dwordx4 v95, s[28:31], s70 offen offset:1024 lds
    ds_read_b64_tr_b16 a[234:235], v104 offset:1984
    v_mfma_f32_16x16x32_bf16 v[172:175], v[20:23], a[176:179], v[172:175]
    ds_read_b64_tr_b16 a[236:237], v104 offset:2368
    s_waitcnt lgkmcnt(15)
    v_mfma_f32_32x32x16_bf16 v[176:191], a[180:183], a[36:39], v[176:191]
    ds_read_b128 a[40:43], v108 offset:0
    ds_read_b64_tr_b16 a[160:161], v112 offset:0
    ds_read_b64_tr_b16 a[162:163], v112 offset:1280
    ds_read_b64_tr_b16 a[164:165], v112 offset:32
    ds_read_b64_tr_b16 a[166:167], v112 offset:1312
    ds_read_b64_tr_b16 a[168:169], v112 offset:64
    v_mfma_f32_32x32x16_bf16 v[192:207], a[184:187], a[36:39], v[192:207]
    ds_read_b64_tr_b16 a[170:171], v112 offset:1344
    ds_read_b64_tr_b16 a[172:173], v112 offset:96
    ds_read_b64_tr_b16 a[174:175], v112 offset:1376
    ds_read_b64_tr_b16 a[176:177], v112 offset:128
    ds_read_b64_tr_b16 a[178:179], v112 offset:1408
    v_mfma_f32_32x32x16_bf16 v[208:223], a[188:191], a[36:39], v[208:223]
    buffer_load_dwordx4 v96, s[28:31], s70 offen offset:2048 lds
    ds_read_b64_tr_b16 a[238:239], v104 offset:2752
    ds_read_b64_tr_b16 a[240:241], v104 offset:3136
    ds_read_b64_tr_b16 a[242:243], v104 offset:3520
    v_mov_b32 v4, 0x3f803f80
    v_mov_b32 v2, 0
    v_mov_b32 v3, 0
    v_dot2c_f32_bf16 v2, v4, v124
    v_dot2c_f32_bf16 v3, v124, v124
    v_dot2c_f32_bf16 v2, v4, v125
    v_dot2c_f32_bf16 v3, v125, v125
    v_dot2c_f32_bf16 v2, v4, v126
    v_dot2c_f32_bf16 v3, v126, v126
    v_dot2c_f32_bf16 v2, v4, v127
    v_dot2c_f32_bf16 v3, v127, v127
    v_dot2c_f32_bf16 v2, v4, v128
    v_dot2c_f32_bf16 v3, v128, v128
    v_dot2c_f32_bf16 v2, v4, v129
    v_dot2c_f32_bf16 v3, v129, v129
    v_dot2c_f32_bf16 v2, v4, v130
    v_dot2c_f32_bf16 v3, v130, v130
    v_dot2c_f32_bf16 v2, v4, v131
    v_dot2c_f32_bf16 v3, v131, v131
    v_dot2c_f32_bf16 v2, v4, v132
    v_dot2c_f32_bf16 v3, v132, v132
    v_dot2c_f32_bf16 v2, v4, v133
    v_dot2c_f32_bf16 v3, v133, v133
    v_dot2c_f32_bf16 v2, v4, v134
    v_dot2c_f32_bf16 v3, v134, v134
    v_dot2c_f32_bf16 v2, v4, v135
    v_dot2c_f32_bf16 v3, v135, v135
    v_mfma_f32_32x32x16_bf16 v[224:239], a[192:195], a[36:39], v[224:239]
    buffer_load_dwordx4 v97, s[28:31], s70 offen offset:3072 lds
    v_add_f32_dpp v2, v2, v2 row_ror:8 row_mask:0xf bank_mask:0xf
    v_add_f32_dpp v3, v3, v3 row_ror:8 row_mask:0xf bank_mask:0xf
    s_nop 0
    v_add_f32_dpp v2, v2, v2 row_ror:4 row_mask:0xf bank_mask:0xf
    v_add_f32_dpp v3, v3, v3 row_ror:4 row_mask:0xf bank_mask:0xf
    v_mfma_f32_32x32x16_bf16 v[240:255], a[196:199], a[36:39], v[240:255]
    v_add_f32_dpp v2, v2, v2 row_ror:2 row_mask:0xf bank_mask:0xf
    v_add_f32_dpp v3, v3, v3 row_ror:2 row_mask:0xf bank_mask:0xf
    s_nop 0
    v_add_f32_dpp v2, v2, v2 row_ror:1 row_mask:0xf bank_mask:0xf
    v_add_f32_dpp v3, v3, v3 row_ror:1 row_mask:0xf bank_mask:0xf
    s_waitcnt lgkmcnt(9)
    v_mfma_f32_32x32x16_bf16 v[176:191], a[160:163], a[40:43], v[176:191]
    ds_read_b128 a[44:47], v109 offset:0
    ds_read_b64_tr_b16 a[180:181], v113 offset:0
    ds_read_b64_tr_b16 a[182:183], v113 offset:1280
    ds_read_b64_tr_b16 a[184:185], v113 offset:32
    ds_read_b64_tr_b16 a[186:187], v113 offset:1312
    ds_read_b64_tr_b16 a[188:189], v113 offset:64
    v_mfma_f32_32x32x16_bf16 v[192:207], a[164:167], a[40:43], v[192:207]
    ds_read_b64_tr_b16 a[190:191], v113 offset:1344
    ds_read_b64_tr_b16 a[192:193], v113 offset:96
    ds_read_b64_tr_b16 a[194:195], v113 offset:1376
    ds_read_b64_tr_b16 a[196:197], v113 offset:128
    ds_read_b64_tr_b16 a[198:199], v113 offset:1408
    s_waitcnt lgkmcnt(14)
    v_mfma_f32_32x32x16_bf16 v[208:223], a[168:171], a[40:43], v[208:223]
    s_add_u32 m0, s73, 20480
    s_nop 0
    buffer_load_dwordx4 v98, s[28:31], s70 offen offset:0 lds
    v_mov_b32 v4, v2
    v_mov_b32 v5, v3
    s_nop 0
    v_permlane16_swap_b32 v4, v2
    v_permlane16_swap_b32 v5, v3
    v_mfma_f32_32x32x16_bf16 v[224:239], a[172:175], a[40:43], v[224:239]
    s_mul_i32 s100, s101, 8
    s_waitcnt vmcnt(9)
    buffer_load_dword v10, v99, s[44:47], s100 offen
    v_add_f32 v2, v4, v2
    v_add_f32 v3, v5, v3
    v_mul_f32 v124, 0xbacccccd, v2
    v_mul_f32 v3, 0x3acccccd, v3
    v_mfma_f32_32x32x16_bf16 v[240:255], a[176:179], a[40:43], v[240:255]
    v_fma_f32 v3, -v124, v124, v3
    v_max_f32_e64 v3, 0, v3
    v_add_f32 v3, 0x3727c5ac, v3
    s_waitcnt lgkmcnt(0)
    s_barrier
    v_mfma_f32_32x32x16_bf16 v[176:191], a[180:183], a[44:47], v[176:191]
    ds_read_b128 a[48:51], v106 offset:36864
    ds_read_b64_tr_b16 a[160:161], v110 offset:36864
    ds_read_b64_tr_b16 a[162:163], v110 offset:38144
    ds_read_b64_tr_b16 a[164:165], v110 offset:36896
    ds_read_b64_tr_b16 a[166:167], v110 offset:38176
    ds_read_b64_tr_b16 a[168:169], v110 offset:36928
    v_mfma_f32_32x32x16_bf16 v[192:207], a[184:187], a[44:47], v[192:207]
    ds_read_b64_tr_b16 a[170:171], v110 offset:38208
    ds_read_b64_tr_b16 a[172:173], v110 offset:36960
    ds_read_b64_tr_b16 a[174:175], v110 offset:38240
    ds_read_b64_tr_b16 a[176:177], v110 offset:36992
    ds_read_b64_tr_b16 a[178:179], v110 offset:38272
    v_mfma_f32_32x32x16_bf16 v[208:223], a[188:191], a[44:47], v[208:223]
    v_subrev_u32 v106, 73728, v106
    v_subrev_u32 v110, 73728, v110
    s_add_u32 m0, s72, 36864
    s_movk_i32 s69, 640
    buffer_load_dwordx4 v90, s[24:27], s69 offen offset:0 lds
    v_mfma_f32_32x32x16_bf16 v[224:239], a[192:195], a[44:47], v[224:239]
    buffer_load_dwordx4 v91, s[24:27], s69 offen offset:1024 lds
    v_rsq_f32 v125, v3
    v_and_b32 v4, 31, v1
    v_cmp_eq_u32 vcc, 0, v4
    v_mfma_f32_32x32x16_bf16 v[240:255], a[196:199], a[44:47], v[240:255]
    buffer_load_dwordx4 v92, s[24:27], s69 offen offset:2048 lds
    v_mul_f32_e64 v126, v3, v125
    v_mul_f32 v127, 0x3fb8aa3b, v125
    v_lshlrev_b32_e64 v118, 4, v118
    v_add_u32 v118, 13549568, v118
    s_waitcnt lgkmcnt(6)
    v_mfma_f32_32x32x16_bf16 v[176:191], a[160:163], a[48:51], v[176:191]
    ds_read_b128 a[52:55], v107 offset:36864
    ds_read_b64_tr_b16 a[180:181], v111 offset:36864
    ds_read_b64_tr_b16 a[182:183], v111 offset:38144
    ds_read_b64_tr_b16 a[184:185], v111 offset:36896
    ds_read_b64_tr_b16 a[186:187], v111 offset:38176
    ds_read_b64_tr_b16 a[188:189], v111 offset:36928
    v_mfma_f32_32x32x16_bf16 v[192:207], a[164:167], a[48:51], v[192:207]
    ds_read_b64_tr_b16 a[190:191], v111 offset:38208
    ds_read_b64_tr_b16 a[192:193], v111 offset:36960
    ds_read_b64_tr_b16 a[194:195], v111 offset:38240
    ds_read_b64_tr_b16 a[196:197], v111 offset:36992
    ds_read_b64_tr_b16 a[198:199], v111 offset:38272
    s_waitcnt lgkmcnt(11)
    v_mfma_f32_32x32x16_bf16 v[208:223], a[168:171], a[48:51], v[208:223]
    v_subrev_u32 v107, 73728, v107
    v_subrev_u32 v111, 73728, v111
    buffer_load_dwordx4 v93, s[24:27], s69 offen offset:3072 lds
    v_mov_b32 v4, 2130706432
    v_cndmask_b32 v118, v4, v118, vcc
    s_mov_b32 s80, 0
    v_cmp_eq_u32 vcc, 0, v16
    s_nop 0
    s_cbranch_vccz L_ok_nonA
L_retry_nonA:
    s_sleep 1
    buffer_load_dword v16, off, s[52:55], 0 sc1
    s_waitcnt vmcnt(0)
    v_cmp_eq_u32 vcc, 0, v16
    s_add_u32 s80, s80, 1
    s_cmp_lt_u32 s80, 100000
    s_cselect_b64 s[82:83], vcc, 0
    s_cmp_lg_u64 s[82:83], 0
    s_cbranch_scc1 L_retry_nonA
    s_nop 4
L_ok_nonA:
    v_mfma_f32_32x32x16_bf16 v[224:239], a[172:175], a[48:51], v[224:239]
    s_mov_b32 s70, 1228800
    s_add_u32 m0, s73, 53248
    s_nop 0
    buffer_load_dwordx4 v94, s[28:31], s70 offen offset:0 lds
    v_perm_b32 v124, v124, v16, s76
    v_perm_b32 v125, v125, v16, s77
    v_perm_b32 v126, v126, v16, s78
    v_mfma_f32_32x32x16_bf16 v[240:255], a[176:179], a[48:51], v[240:255]
    v_perm_b32 v127, v127, v16, s79
    buffer_store_dwordx4 v[124:127], v118, s[36:39], 0 offen sc1
    s_mov_b32 s32, s14
    s_and_b32 s33, s15, 0xffff
    s_mov_b32 s34, 1966080
    s_mov_b32 s35, 0x20000
    v_mfma_f32_16x16x32_bf16 v[156:159], v[20:23], a[160:163], v[156:159]
    s_mul_i32 s87, s59, 384
    s_lshl_b32 s63, s60, 6
    v_mfma_f32_16x16x32_bf16 v[160:163], v[20:23], a[164:167], v[160:163]
    buffer_load_dwordx4 v95, s[28:31], s70 offen offset:1024 lds
    s_add_u32 s87, s87, s63
    v_mfma_f32_16x16x32_bf16 v[164:167], v[20:23], a[168:171], v[164:167]
    s_lshl_b32 s63, s56, 4
    v_lshrrev_b32_e64 v6, 3, v1
    v_mfma_f32_16x16x32_bf16 v[168:171], v[20:23], a[172:175], v[168:171]
    v_add_u32_e64 v6, s63, v6
    v_mul_u32_u24 v6, 3072, v6
    v_mfma_f32_16x16x32_bf16 v[172:175], v[20:23], a[176:179], v[172:175]
    v_lshrrev_b32 v7, 2, v1
    s_waitcnt lgkmcnt(6)
    v_mfma_f32_32x32x16_bf16 v[176:191], a[180:183], a[52:55], v[176:191]
    ds_read_b128 a[56:59], v108 offset:36864
    ds_read_b64_tr_b16 a[160:161], v112 offset:36864
    ds_read_b64_tr_b16 a[162:163], v112 offset:38144
    ds_read_b64_tr_b16 a[164:165], v112 offset:36896
    ds_read_b64_tr_b16 a[166:167], v112 offset:38176
    ds_read_b64_tr_b16 a[168:169], v112 offset:36928
    v_mfma_f32_32x32x16_bf16 v[192:207], a[184:187], a[52:55], v[192:207]
    ds_read_b64_tr_b16 a[170:171], v112 offset:38208
    ds_read_b64_tr_b16 a[172:173], v112 offset:36960
    ds_read_b64_tr_b16 a[174:175], v112 offset:38240
    ds_read_b64_tr_b16 a[176:177], v112 offset:36992
    ds_read_b64_tr_b16 a[178:179], v112 offset:38272
    s_waitcnt lgkmcnt(11)
    v_mfma_f32_32x32x16_bf16 v[208:223], a[188:191], a[52:55], v[208:223]
    v_subrev_u32 v108, 73728, v108
    v_subrev_u32 v112, 73728, v112
    buffer_load_dwordx4 v96, s[28:31], s70 offen offset:2048 lds
    v_and_b32 v7, 4, v7
    v_xor_b32 v7, v7, v1
    v_and_b32 v7, 7, v7
    v_mfma_f32_32x32x16_bf16 v[224:239], a[192:195], a[52:55], v[224:239]
    buffer_load_dwordx4 v97, s[28:31], s70 offen offset:3072 lds
    v_lshl_add_u32 v6, v7, 4, v6
    s_lshl_b32 s63, s87, 1
    v_add_u32 v17, s63, v6
    v_add_u32 v18, 23552, v17
    v_lshlrev_b32_e64 v2, 15, v14
    v_mfma_f32_32x32x16_bf16 v[240:255], a[196:199], a[52:55], v[240:255]
    s_add_u32 m0, s73, 57344
    s_nop 0
    buffer_load_dwordx4 v98, s[28:31], s70 offen offset:0 lds
    v_lshl_add_u32 v2, v15, 7, v2
    v_lshrrev_b32 v3, 1, v15
    v_and_b32 v3, 4, v3
    s_waitcnt lgkmcnt(6)
    v_mfma_f32_32x32x16_bf16 v[176:191], a[160:163], a[56:59], v[176:191]
    ds_read_b128 a[60:63], v109 offset:36864
    ds_read_b64_tr_b16 a[180:181], v113 offset:36864
    ds_read_b64_tr_b16 a[182:183], v113 offset:38144
    ds_read_b64_tr_b16 a[184:185], v113 offset:36896
    ds_read_b64_tr_b16 a[186:187], v113 offset:38176
    ds_read_b64_tr_b16 a[188:189], v113 offset:36928
    v_mfma_f32_32x32x16_bf16 v[192:207], a[164:167], a[56:59], v[192:207]
    ds_read_b64_tr_b16 a[190:191], v113 offset:38208
    ds_read_b64_tr_b16 a[192:193], v113 offset:36960
    ds_read_b64_tr_b16 a[194:195], v113 offset:38240
    ds_read_b64_tr_b16 a[196:197], v113 offset:36992
    ds_read_b64_tr_b16 a[198:199], v113 offset:38272
    s_waitcnt lgkmcnt(11)
    v_mfma_f32_32x32x16_bf16 v[208:223], a[168:171], a[56:59], v[208:223]
    v_subrev_u32 v109, 73728, v109
    v_subrev_u32 v113, 73728, v113
    v_xor_b32 v3, v3, v15
    v_and_b32_e64 v3, 7, v3
    v_lshl_add_u32 v2, v3, 4, v2
    s_add_u32 s63, s72, 0
    v_mfma_f32_32x32x16_bf16 v[224:239], a[172:175], a[56:59], v[224:239]
    v_add_u32 v19, s63, v2
    v_xor_b32 v24, 16, v19
    v_xor_b32 v25, 32, v19
    v_xor_b32_e64 v26, 48, v19
    v_mfma_f32_32x32x16_bf16 v[240:255], a[176:179], a[56:59], v[240:255]
    v_xor_b32_e64 v27, 64, v19
    v_xor_b32 v28, 80, v19
    v_xor_b32 v29, 96, v19
    v_xor_b32 v30, 112, v19
    s_waitcnt vmcnt(11) lgkmcnt(0)
    s_barrier
    v_mfma_f32_32x32x16_bf16 v[176:191], a[180:183], a[60:63], v[176:191]
    ds_read_b128 a[64:67], v106 offset:0
    ds_read_b64_tr_b16 a[160:161], v110 offset:0
    ds_read_b64_tr_b16 a[162:163], v110 offset:1280
    ds_read_b64_tr_b16 a[164:165], v110 offset:32
    ds_read_b64_tr_b16 a[166:167], v110 offset:1312
    ds_read_b64_tr_b16 a[168:169], v110 offset:64
    v_mfma_f32_32x32x16_bf16 v[192:207], a[184:187], a[60:63], v[192:207]
    ds_read_b64_tr_b16 a[170:171], v110 offset:1344
    ds_read_b64_tr_b16 a[172:173], v110 offset:96
    ds_read_b64_tr_b16 a[174:175], v110 offset:1376
    ds_read_b64_tr_b16 a[176:177], v110 offset:128
    ds_read_b64_tr_b16 a[178:179], v110 offset:1408
    v_mfma_f32_32x32x16_bf16 v[208:223], a[188:191], a[60:63], v[208:223]
    s_add_u32 m0, s72, 73728
    s_movk_i32 s69, 768
    buffer_load_dwordx4 v90, s[24:27], s69 offen offset:0 lds
    v_lshl_add_u32 v2, v11, 3, v12
    v_lshlrev_b32 v2, 7, v2
    v_and_b32_e64 v3, 1, v13
    v_mfma_f32_32x32x16_bf16 v[224:239], a[192:195], a[60:63], v[224:239]
    buffer_load_dwordx4 v91, s[24:27], s69 offen offset:1024 lds
    v_lshl_add_u32 v2, v3, 3, v2
    s_lshl_b32 s63, s56, 14
    s_add_u32 s63, s63, 0
    v_add_u32 v2, s63, v2
    v_and_b32 v3, 1, v11
    v_mfma_f32_32x32x16_bf16 v[240:255], a[196:199], a[60:63], v[240:255]
    buffer_load_dwordx4 v92, s[24:27], s69 offen offset:2048 lds
    v_lshlrev_b32 v3, 2, v3
    v_xor_b32 v3, v3, v12
    v_lshrrev_b32 v4, 1, v13
    v_add_u32 v5, 0, v4
    s_waitcnt lgkmcnt(6)
    v_mfma_f32_32x32x16_bf16 v[176:191], a[160:163], a[64:67], v[176:191]
    ds_read_b128 a[68:71], v107 offset:0
    ds_read_b64_tr_b16 a[180:181], v111 offset:0
    ds_read_b64_tr_b16 a[182:183], v111 offset:1280
    ds_read_b64_tr_b16 a[184:185], v111 offset:32
    ds_read_b64_tr_b16 a[186:187], v111 offset:1312
    ds_read_b64_tr_b16 a[188:189], v111 offset:64
    v_mfma_f32_32x32x16_bf16 v[192:207], a[164:167], a[64:67], v[192:207]
    ds_read_b64_tr_b16 a[190:191], v111 offset:1344
    ds_read_b64_tr_b16 a[192:193], v111 offset:96
    ds_read_b64_tr_b16 a[194:195], v111 offset:1376
    ds_read_b64_tr_b16 a[196:197], v111 offset:128
    ds_read_b64_tr_b16 a[198:199], v111 offset:1408
    s_waitcnt lgkmcnt(11)
    v_mfma_f32_32x32x16_bf16 v[208:223], a[168:171], a[64:67], v[208:223]
    buffer_load_dwordx4 v93, s[24:27], s69 offen offset:3072 lds
    v_xor_b32_e64 v5, v5, v3
    v_lshl_add_u32 v31, v5, 4, v2
    v_xor_b32_e64 v5, 64, v31
    v_add_u32 v32, 512, v5
    v_mfma_f32_32x32x16_bf16 v[224:239], a[172:175], a[64:67], v[224:239]
    s_mov_b32 s70, 1474560
    s_add_u32 m0, s73, 90112
    s_nop 0
    buffer_load_dwordx4 v94, s[28:31], s70 offen offset:0 lds
    v_add_u32 v5, 2, v4
    v_xor_b32_e64 v5, v5, v3
    v_lshl_add_u32 v33, v5, 4, v2
    v_mfma_f32_32x32x16_bf16 v[240:255], a[176:179], a[64:67], v[240:255]
    v_xor_b32_e64 v5, 64, v33
    v_add_u32 v34, 512, v5
    v_add_u32 v5, 4, v4
    v_xor_b32 v5, v5, v3
    v_mfma_f32_16x16x32_bf16 v[156:159], v[20:23], a[160:163], v[156:159]
    v_lshl_add_u32 v35, v5, 4, v2
    v_xor_b32_e64 v5, 64, v35
    v_mfma_f32_16x16x32_bf16 v[160:163], v[20:23], a[164:167], v[160:163]
    buffer_load_dwordx4 v95, s[28:31], s70 offen offset:1024 lds
    v_add_u32 v36, 512, v5
    v_mfma_f32_16x16x32_bf16 v[164:167], v[20:23], a[168:171], v[164:167]
    v_add_u32 v5, 5, v4
    v_xor_b32 v5, v5, v3
    v_mfma_f32_16x16x32_bf16 v[168:171], v[20:23], a[172:175], v[168:171]
    v_lshl_add_u32 v37, v5, 4, v2
    v_xor_b32_e64 v5, 64, v37
    v_mfma_f32_16x16x32_bf16 v[172:175], v[20:23], a[176:179], v[172:175]
    v_add_u32 v38, 512, v5
    s_waitcnt lgkmcnt(6)
    v_mfma_f32_32x32x16_bf16 v[176:191], a[180:183], a[68:71], v[176:191]
    ds_read_b128 a[72:75], v108 offset:0
    ds_read_b64_tr_b16 a[160:161], v112 offset:0
    ds_read_b64_tr_b16 a[162:163], v112 offset:1280
    ds_read_b64_tr_b16 a[164:165], v112 offset:32
    ds_read_b64_tr_b16 a[166:167], v112 offset:1312
    ds_read_b64_tr_b16 a[168:169], v112 offset:64
    v_mfma_f32_32x32x16_bf16 v[192:207], a[184:187], a[68:71], v[192:207]
    ds_read_b64_tr_b16 a[170:171], v112 offset:1344
    ds_read_b64_tr_b16 a[172:173], v112 offset:96
    ds_read_b64_tr_b16 a[174:175], v112 offset:1376
    ds_read_b64_tr_b16 a[176:177], v112 offset:128
    ds_read_b64_tr_b16 a[178:179], v112 offset:1408
    s_waitcnt lgkmcnt(11)
    v_mfma_f32_32x32x16_bf16 v[208:223], a[188:191], a[68:71], v[208:223]
    buffer_load_dwordx4 v96, s[28:31], s70 offen offset:2048 lds
    v_xor_b32 v5, 7, v3
    v_lshlrev_b32 v5, 4, v5
    v_and_b32 v6, -9, v2
    v_min_u32 v7, 1, v13
    v_mfma_f32_32x32x16_bf16 v[224:239], a[192:195], a[68:71], v[224:239]
    buffer_load_dwordx4 v97, s[28:31], s70 offen offset:3072 lds
    v_lshl_add_u32 v6, v7, 3, v6
    v_add_u32 v39, v5, v6
    v_xor_b32 v5, 64, v39
    v_add_u32 v40, 512, v5
    s_lshl_b32 s63, s58, 4
    v_mfma_f32_32x32x16_bf16 v[240:255], a[196:199], a[68:71], v[240:255]
    s_add_u32 m0, s73, 94208
    s_nop 0
    buffer_load_dwordx4 v98, s[28:31], s70 offen offset:0 lds
    s_add_u32 s63, s63, s57
    s_mul_i32 s63, s63, 13568
    s_mul_i32 s64, s56, 3360
    s_waitcnt lgkmcnt(6)
    v_mfma_f32_32x32x16_bf16 v[176:191], a[160:163], a[72:75], v[176:191]
    ds_read_b128 a[76:79], v109 offset:0
    ds_read_b64_tr_b16 a[180:181], v113 offset:0
    ds_read_b64_tr_b16 a[182:183], v113 offset:1280
    ds_read_b64_tr_b16 a[184:185], v113 offset:32
    ds_read_b64_tr_b16 a[186:187], v113 offset:1312
    ds_read_b64_tr_b16 a[188:189], v113 offset:64
    v_mfma_f32_32x32x16_bf16 v[192:207], a[164:167], a[72:75], v[192:207]
    ds_read_b64_tr_b16 a[190:191], v113 offset:1344
    ds_read_b64_tr_b16 a[192:193], v113 offset:96
    ds_read_b64_tr_b16 a[194:195], v113 offset:1376
    ds_read_b64_tr_b16 a[196:197], v113 offset:128
    ds_read_b64_tr_b16 a[198:199], v113 offset:1408
    s_waitcnt lgkmcnt(11)
    v_mfma_f32_32x32x16_bf16 v[208:223], a[168:171], a[72:75], v[208:223]
    s_add_u32 m0, s72, 147456
    s_movk_i32 s71, 0
    buffer_load_dwordx4 v114, s[40:43], s71 offen offset:0 lds
    s_add_u32 s63, s63, s64
    s_add_u32 s63, s63, 11698176
    v_mul_u32_u24 v2, 21, v11
    v_mfma_f32_32x32x16_bf16 v[224:239], a[172:175], a[72:75], v[224:239]
    s_movk_i32 s71, 9216
    buffer_load_dwordx4 v114, s[40:43], s71 offen offset:1024 lds
    v_and_b32 v3, 15, v1
    v_add_u32 v2, v2, v3
    v_lshlrev_b32 v2, 4, v2
    v_add_u32_e64 v44, s63, v2
    v_mfma_f32_32x32x16_bf16 v[240:255], a[176:179], a[72:75], v[240:255]
    v_mov_b32 v4, 2130706432
    v_cmp_gt_u32 vcc, 5, v3
    s_nop 1
    v_cndmask_b32 v45, v4, v44, vcc
    v_cmp_gt_u32 vcc, 32, v1
    s_waitcnt vmcnt(11) lgkmcnt(0)
    s_barrier
    v_mfma_f32_32x32x16_bf16 v[176:191], a[180:183], a[76:79], v[176:191]
    ds_read_b128 a[80:83], v106 offset:36864
    ds_read_b64_tr_b16 a[160:161], v110 offset:36864
    ds_read_b64_tr_b16 a[162:163], v110 offset:38144
    ds_read_b64_tr_b16 a[164:165], v110 offset:36896
    ds_read_b64_tr_b16 a[166:167], v110 offset:38176
    ds_read_b64_tr_b16 a[168:169], v110 offset:36928
    v_mfma_f32_32x32x16_bf16 v[192:207], a[184:187], a[76:79], v[192:207]
    ds_read_b64_tr_b16 a[170:171], v110 offset:38208
    ds_read_b64_tr_b16 a[172:173], v110 offset:36960
    ds_read_b64_tr_b16 a[174:175], v110 offset:38240
    ds_read_b64_tr_b16 a[176:177], v110 offset:36992
    ds_read_b64_tr_b16 a[178:179], v110 offset:38272
    v_mfma_f32_32x32x16_bf16 v[208:223], a[188:191], a[76:79], v[208:223]
    v_add_u32 v106, 73728, v106
    v_add_u32 v110, 73728, v110
    s_movk_i32 s71, 18432
    buffer_load_dwordx4 v114, s[40:43], s71 offen offset:2048 lds
    v_cndmask_b32 v46, v4, v44, vcc
    v_cndmask_b32_e64 v47, v4, v45, vcc
    v_mfma_f32_32x32x16_bf16 v[224:239], a[192:195], a[76:79], v[224:239]
    s_movk_i32 s71, 27648
    buffer_load_dwordx4 v114, s[40:43], s71 offen offset:3072 lds
    s_and_b32 s63, s62, 1
    s_lshl_b32 s63, s63, 2
    s_add_u32 s84, s63, s60
    s_lshr_b32 s63, s62, 1
    v_mfma_f32_32x32x16_bf16 v[240:255], a[196:199], a[76:79], v[240:255]
    s_add_u32 m0, s72, 110592
    s_movk_i32 s69, 896
    buffer_load_dwordx4 v90, s[24:27], s69 offen offset:0 lds
    s_lshl_b32 s63, s63, 3
    s_lshr_b32 s64, s61, 2
    s_waitcnt lgkmcnt(6)
    v_mfma_f32_32x32x16_bf16 v[176:191], a[160:163], a[80:83], v[176:191]
    ds_read_b128 a[84:87], v107 offset:36864
    ds_read_b64_tr_b16 a[180:181], v111 offset:36864
    ds_read_b64_tr_b16 a[182:183], v111 offset:38144
    ds_read_b64_tr_b16 a[184:185], v111 offset:36896
    ds_read_b64_tr_b16 a[186:187], v111 offset:38176
    ds_read_b64_tr_b16 a[188:189], v111 offset:36928
    v_mfma_f32_32x32x16_bf16 v[192:207], a[164:167], a[80:83], v[192:207]
    ds_read_b64_tr_b16 a[190:191], v111 offset:38208
    ds_read_b64_tr_b16 a[192:193], v111 offset:36960
    ds_read_b64_tr_b16 a[194:195], v111 offset:38240
    ds_read_b64_tr_b16 a[196:197], v111 offset:36992
    ds_read_b64_tr_b16 a[198:199], v111 offset:38272
    s_waitcnt lgkmcnt(11)
    v_mfma_f32_32x32x16_bf16 v[208:223], a[168:171], a[80:83], v[208:223]
    v_add_u32 v107, 73728, v107
    v_add_u32 v111, 73728, v111
    buffer_load_dwordx4 v91, s[24:27], s69 offen offset:1024 lds
    s_add_u32 s63, s63, s64
    s_lshr_b32 s86, s63, 1
    s_lshl_b32 s85, s63, 2
    v_mfma_f32_32x32x16_bf16 v[224:239], a[172:175], a[80:83], v[224:239]
    buffer_load_dwordx4 v92, s[24:27], s69 offen offset:2048 lds
    s_add_u32 s85, s85, s56
    s_mul_i32 s74, s56, 5120
    s_mul_i32 s63, s84, 348160
    s_add_u32 s63, s63, s74
    s_add_u32 s63, s63, 8912896
    v_mfma_f32_32x32x16_bf16 v[240:255], a[176:179], a[80:83], v[240:255]
    v_lshlrev_b32 v48, 4, v1
    v_add_u32_e64 v41, s63, v48
    s_mul_i32 s63, s85, 49152
    v_add_u32_e64 v42, s63, v48
    s_mul_i32 s63, s85, 20480
    s_add_u32 s63, s63, 6291456
    v_mfma_f32_16x16x32_bf16 v[156:159], v[20:23], a[160:163], v[156:159]
    v_add_u32_e64 v43, s63, v48
    s_mul_i32 s63, s84, 80
    v_mfma_f32_16x16x32_bf16 v[160:163], v[20:23], a[164:167], v[160:163]
    buffer_load_dwordx4 v93, s[24:27], s69 offen offset:3072 lds
    s_add_u32 s64, s63, 79
    v_mfma_f32_16x16x32_bf16 v[164:167], v[20:23], a[168:171], v[164:167]
    s_lshr_b32 s63, s63, 6
    s_lshr_b32 s64, s64, 6
    v_mfma_f32_16x16x32_bf16 v[168:171], v[20:23], a[172:175], v[168:171]
    s_sub_u32 s64, s64, s63
    s_lshl_b32 s63, s63, 7
    v_mfma_f32_16x16x32_bf16 v[172:175], v[20:23], a[176:179], v[172:175]
    s_lshl_b32 s64, s64, 7
    s_waitcnt lgkmcnt(6)
    v_mfma_f32_32x32x16_bf16 v[176:191], a[180:183], a[84:87], v[176:191]
    ds_read_b128 a[88:91], v108 offset:36864
    ds_read_b64_tr_b16 a[160:161], v112 offset:36864
    ds_read_b64_tr_b16 a[162:163], v112 offset:38144
    ds_read_b64_tr_b16 a[164:165], v112 offset:36896
    ds_read_b64_tr_b16 a[166:167], v112 offset:38176
    ds_read_b64_tr_b16 a[168:169], v112 offset:36928
    v_mfma_f32_32x32x16_bf16 v[192:207], a[184:187], a[84:87], v[192:207]
    ds_read_b64_tr_b16 a[170:171], v112 offset:38208
    ds_read_b64_tr_b16 a[172:173], v112 offset:36960
    ds_read_b64_tr_b16 a[174:175], v112 offset:38240
    ds_read_b64_tr_b16 a[176:177], v112 offset:36992
    ds_read_b64_tr_b16 a[178:179], v112 offset:38272
    s_waitcnt lgkmcnt(11)
    v_mfma_f32_32x32x16_bf16 v[208:223], a[188:191], a[84:87], v[208:223]
    v_add_u32 v108, 73728, v108
    v_add_u32 v112, 73728, v112
    s_mov_b32 s70, 1720320
    s_add_u32 m0, s73, 126976
    s_nop 0
    buffer_load_dwordx4 v94, s[28:31], s70 offen offset:0 lds
    s_add_u32 s63, s63, 13547520
    v_mfma_f32_32x32x16_bf16 v[224:239], a[192:195], a[84:87], v[224:239]
    buffer_load_dwordx4 v95, s[28:31], s70 offen offset:1024 lds
    v_min_u32 v2, 11, v15
    v_mul_u32_u24 v3, s64, v14
    v_lshl_add_u32 v2, v2, 2, v3
    v_add_u32_e64 v49, s63, v2
    v_mfma_f32_32x32x16_bf16 v[240:255], a[196:199], a[84:87], v[240:255]
    buffer_load_dwordx4 v96, s[28:31], s70 offen offset:2048 lds
    v_min_u32_e64 v2, 4, v15
    v_lshl_add_u32 v2, v2, 2, v3
    v_add_u32 v51, s63, v2
    s_lshl_b32 s63, s86, 7
    s_waitcnt lgkmcnt(6)
    v_mfma_f32_32x32x16_bf16 v[176:191], a[160:163], a[88:91], v[176:191]
    ds_read_b128 a[92:95], v109 offset:36864
    ds_read_b64_tr_b16 a[180:181], v113 offset:36864
    ds_read_b64_tr_b16 a[182:183], v113 offset:38144
    ds_read_b64_tr_b16 a[184:185], v113 offset:36896
    ds_read_b64_tr_b16 a[186:187], v113 offset:38176
    ds_read_b64_tr_b16 a[188:189], v113 offset:36928
    v_mfma_f32_32x32x16_bf16 v[192:207], a[164:167], a[88:91], v[192:207]
    ds_read_b64_tr_b16 a[190:191], v113 offset:38208
    ds_read_b64_tr_b16 a[192:193], v113 offset:36960
    ds_read_b64_tr_b16 a[194:195], v113 offset:38240
    ds_read_b64_tr_b16 a[196:197], v113 offset:36992
    ds_read_b64_tr_b16 a[198:199], v113 offset:38272
    s_waitcnt lgkmcnt(11)
    v_mfma_f32_32x32x16_bf16 v[208:223], a[168:171], a[88:91], v[208:223]
    v_add_u32 v109, 73728, v109
    v_add_u32 v113, 73728, v113
    buffer_load_dwordx4 v97, s[28:31], s70 offen offset:3072 lds
    v_and_b32_e64 v2, 7, v1
    v_lshl_add_u32 v52, v2, 2, s63
    v_add_u32 v52, 13543424, v52
    v_mfma_f32_32x32x16_bf16 v[224:239], a[172:175], a[88:91], v[224:239]
    s_add_u32 m0, s73, 131072
    s_nop 0
    buffer_load_dwordx4 v98, s[28:31], s70 offen offset:0 lds
    v_lshl_add_u32 v6, v14, 3, v12
    v_mul_u32_u24 v6, 128, v6
    v_lshrrev_b32 v7, 1, v12
    v_lshl_add_u32 v6, v7, 6, v6
    v_mfma_f32_32x32x16_bf16 v[240:255], a[176:179], a[88:91], v[240:255]
    v_and_b32_e64 v7, 1, v11
    v_lshl_add_u32 v7, v7, 2, v13
    v_lshl_add_u32 v6, v7, 3, v6
    s_xor_b32 s63, s56, 0
    s_lshl_b32 s63, s63, 11
    s_waitcnt vmcnt(13) lgkmcnt(0)
    s_barrier
    v_mfma_f32_32x32x16_bf16 v[176:191], a[180:183], a[92:95], v[176:191]
    ds_read_b128 a[96:99], v106 offset:0
    ds_read_b64_tr_b16 a[160:161], v110 offset:0
    ds_read_b64_tr_b16 a[162:163], v110 offset:1280
    ds_read_b64_tr_b16 a[164:165], v110 offset:32
    ds_read_b64_tr_b16 a[166:167], v110 offset:1312
    ds_read_b64_tr_b16 a[168:169], v110 offset:64
    v_mfma_f32_32x32x16_bf16 v[192:207], a[184:187], a[92:95], v[192:207]
    ds_read_b64_tr_b16 a[170:171], v110 offset:1344
    ds_read_b64_tr_b16 a[172:173], v110 offset:96
    ds_read_b64_tr_b16 a[174:175], v110 offset:1376
    ds_read_b64_tr_b16 a[176:177], v110 offset:128
    ds_read_b64_tr_b16 a[178:179], v110 offset:1408
    v_mfma_f32_32x32x16_bf16 v[208:223], a[188:191], a[92:95], v[208:223]
    s_add_u32 m0, s72, 0
    s_movk_i32 s69, 1024
    buffer_load_dwordx4 v90, s[24:27], s69 offen offset:0 lds
    v_add_u32 v58, s63, v6
    v_xor_b32 v59, 64, v58
    s_xor_b32 s63, s56, 1
    v_mfma_f32_32x32x16_bf16 v[224:239], a[192:195], a[92:95], v[224:239]
    buffer_load_dwordx4 v91, s[24:27], s69 offen offset:1024 lds
    s_lshl_b32 s63, s63, 11
    v_add_u32 v60, s63, v6
    v_xor_b32 v61, 64, v60
    s_xor_b32 s63, s56, 2
    s_lshl_b32 s63, s63, 11
    v_mfma_f32_32x32x16_bf16 v[240:255], a[196:199], a[92:95], v[240:255]
    buffer_load_dwordx4 v92, s[24:27], s69 offen offset:2048 lds
    v_add_u32 v62, s63, v6
    v_xor_b32 v63, 64, v62
    s_xor_b32 s63, s56, 3
    s_lshl_b32 s63, s63, 11
    s_waitcnt lgkmcnt(6)
    v_mfma_f32_32x32x16_bf16 v[176:191], a[160:163], a[96:99], v[176:191]
    ds_read_b128 a[100:103], v107 offset:0
    ds_read_b64_tr_b16 a[180:181], v111 offset:0
    ds_read_b64_tr_b16 a[182:183], v111 offset:1280
    ds_read_b64_tr_b16 a[184:185], v111 offset:32
    ds_read_b64_tr_b16 a[186:187], v111 offset:1312
    ds_read_b64_tr_b16 a[188:189], v111 offset:64
    v_mfma_f32_32x32x16_bf16 v[192:207], a[164:167], a[96:99], v[192:207]
    ds_read_b64_tr_b16 a[190:191], v111 offset:1344
    ds_read_b64_tr_b16 a[192:193], v111 offset:96
    ds_read_b64_tr_b16 a[194:195], v111 offset:1376
    ds_read_b64_tr_b16 a[196:197], v111 offset:128
    ds_read_b64_tr_b16 a[198:199], v111 offset:1408
    s_waitcnt lgkmcnt(11)
    v_mfma_f32_32x32x16_bf16 v[208:223], a[168:171], a[96:99], v[208:223]
    buffer_load_dwordx4 v93, s[24:27], s69 offen offset:3072 lds
    v_add_u32 v64, s63, v6
    v_xor_b32 v65, 64, v64
    v_add_u32 v58, 73728, v58
    v_add_u32 v59, 73728, v59
    v_mfma_f32_32x32x16_bf16 v[224:239], a[172:175], a[96:99], v[224:239]
    s_mov_b32 s70, 1966080
    s_add_u32 m0, s73, 16384
    s_nop 0
    buffer_load_dwordx4 v94, s[28:31], s70 offen offset:0 lds
    v_add_u32 v60, 73728, v60
    v_add_u32 v61, 73728, v61
    v_add_u32 v62, 73728, v62
    v_mfma_f32_32x32x16_bf16 v[240:255], a[176:179], a[96:99], v[240:255]
    v_add_u32 v63, 73728, v63
    v_add_u32 v64, 73728, v64
    v_add_u32 v65, 73728, v65
    s_waitcnt vmcnt(14)
    ds_read_b64_tr_b16 v[136:137], v116 offset:0
    ds_read_b64_tr_b16 v[138:139], v117 offset:0
    ds_read_b64_tr_b16 v[140:141], v116 offset:32
    v_mfma_f32_16x16x32_bf16 v[156:159], v[20:23], a[160:163], v[156:159]
    ds_read_b64_tr_b16 v[142:143], v117 offset:32
    ds_read_b64_tr_b16 v[144:145], v116 offset:64
    v_mfma_f32_16x16x32_bf16 v[160:163], v[20:23], a[164:167], v[160:163]
    buffer_load_dwordx4 v95, s[28:31], s70 offen offset:1024 lds
    ds_read_b64_tr_b16 v[146:147], v117 offset:64
    v_mfma_f32_16x16x32_bf16 v[164:167], v[20:23], a[168:171], v[164:167]
    ds_read_b64_tr_b16 v[148:149], v116 offset:96
    ds_read_b64_tr_b16 v[150:151], v117 offset:96
    v_mfma_f32_16x16x32_bf16 v[168:171], v[20:23], a[172:175], v[168:171]
    s_waitcnt lgkmcnt(6)
    buffer_store_dwordx4 v[136:139], v120, s[36:39], 0 offen sc1
    s_waitcnt lgkmcnt(4)
    buffer_store_dwordx4 v[140:143], v121, s[36:39], 0 offen sc1
    v_mfma_f32_16x16x32_bf16 v[172:175], v[20:23], a[176:179], v[172:175]
    s_waitcnt lgkmcnt(2)
    buffer_store_dwordx4 v[144:147], v122, s[36:39], 0 offen sc1
    v_mfma_f32_32x32x16_bf16 v[176:191], a[180:183], a[100:103], v[176:191]
    ds_read_b128 a[104:107], v108 offset:0
    ds_read_b64_tr_b16 a[160:161], v112 offset:0
    ds_read_b64_tr_b16 a[162:163], v112 offset:1280
    ds_read_b64_tr_b16 a[164:165], v112 offset:32
    ds_read_b64_tr_b16 a[166:167], v112 offset:1312
    ds_read_b64_tr_b16 a[168:169], v112 offset:64
    v_mfma_f32_32x32x16_bf16 v[192:207], a[184:187], a[100:103], v[192:207]
    ds_read_b64_tr_b16 a[170:171], v112 offset:1344
    ds_read_b64_tr_b16 a[172:173], v112 offset:96
    ds_read_b64_tr_b16 a[174:175], v112 offset:1376
    ds_read_b64_tr_b16 a[176:177], v112 offset:128
    ds_read_b64_tr_b16 a[178:179], v112 offset:1408
    v_mfma_f32_32x32x16_bf16 v[208:223], a[188:191], a[100:103], v[208:223]
    buffer_load_dwordx4 v96, s[28:31], s70 offen offset:2048 lds
    s_waitcnt lgkmcnt(11)
    buffer_store_dwordx4 v[148:151], v123, s[36:39], 0 offen sc1
    s_lshl_b32 s63, s57, 7
    s_lshl_b32 s64, s56, 5
    s_add_u32 s63, s63, s64
    s_lshl_b32 s63, s63, 4
    v_mfma_f32_32x32x16_bf16 v[224:239], a[192:195], a[100:103], v[224:239]
    buffer_load_dwordx4 v97, s[28:31], s70 offen offset:3072 lds
    s_add_u32 s63, s63, 13549568
    v_lshl_add_u32 v132, v15, 4, s63
    v_lshrrev_b32 v68, 0, v16
    v_lshrrev_b32 v69, 8, v16
    v_lshrrev_b32_e64 v70, 16, v16
    v_mfma_f32_32x32x16_bf16 v[240:255], a[196:199], a[100:103], v[240:255]
    s_add_u32 m0, s73, 20480
    s_nop 0
    buffer_load_dwordx4 v98, s[28:31], s70 offen offset:0 lds
    v_lshrrev_b32 v71, 24, v16
    buffer_load_dwordx4 v[128:131], v132, s[36:39], 0 offen sc1
    s_waitcnt lgkmcnt(6)
    v_mfma_f32_32x32x16_bf16 v[176:191], a[160:163], a[104:107], v[176:191]
    ds_read_b128 a[108:111], v109 offset:0
    ds_read_b64_tr_b16 a[180:181], v113 offset:0
    ds_read_b64_tr_b16 a[182:183], v113 offset:1280
    ds_read_b64_tr_b16 a[184:185], v113 offset:32
    ds_read_b64_tr_b16 a[186:187], v113 offset:1312
    ds_read_b64_tr_b16 a[188:189], v113 offset:64
    v_mfma_f32_32x32x16_bf16 v[192:207], a[164:167], a[104:107], v[192:207]
    ds_read_b64_tr_b16 a[190:191], v113 offset:1344
    ds_read_b64_tr_b16 a[192:193], v113 offset:96
    ds_read_b64_tr_b16 a[194:195], v113 offset:1376
    ds_read_b64_tr_b16 a[196:197], v113 offset:128
    ds_read_b64_tr_b16 a[198:199], v113 offset:1408
    s_waitcnt lgkmcnt(11)
    v_mfma_f32_32x32x16_bf16 v[208:223], a[168:171], a[104:107], v[208:223]
    v_mfma_f32_32x32x16_bf16 v[224:239], a[172:175], a[104:107], v[224:239]
    v_mfma_f32_32x32x16_bf16 v[240:255], a[176:179], a[104:107], v[240:255]
    s_waitcnt vmcnt(14) lgkmcnt(0)
    s_barrier
    v_mfma_f32_32x32x16_bf16 v[176:191], a[180:183], a[108:111], v[176:191]
    ds_read_b128 a[112:115], v106 offset:36864
    ds_read_b64_tr_b16 a[160:161], v110 offset:36864
    ds_read_b64_tr_b16 a[162:163], v110 offset:38144
    ds_read_b64_tr_b16 a[164:165], v110 offset:36896
    ds_read_b64_tr_b16 a[166:167], v110 offset:38176
    ds_read_b64_tr_b16 a[168:169], v110 offset:36928
    v_mfma_f32_32x32x16_bf16 v[192:207], a[184:187], a[108:111], v[192:207]
    ds_read_b64_tr_b16 a[170:171], v110 offset:38208
    ds_read_b64_tr_b16 a[172:173], v110 offset:36960
    ds_read_b64_tr_b16 a[174:175], v110 offset:38240
    ds_read_b64_tr_b16 a[176:177], v110 offset:36992
    ds_read_b64_tr_b16 a[178:179], v110 offset:38272
    v_mfma_f32_32x32x16_bf16 v[208:223], a[188:191], a[108:111], v[208:223]
    v_subrev_u32 v106, 73728, v106
    v_subrev_u32 v110, 73728, v110
    s_add_u32 m0, s72, 36864
    s_movk_i32 s69, 1152
    buffer_load_dwordx4 v90, s[24:27], s69 offen offset:0 lds
    v_mfma_f32_32x32x16_bf16 v[224:239], a[192:195], a[108:111], v[224:239]
    buffer_load_dwordx4 v91, s[24:27], s69 offen offset:1024 lds
    v_mfma_f32_32x32x16_bf16 v[240:255], a[196:199], a[108:111], v[240:255]
    buffer_load_dwordx4 v92, s[24:27], s69 offen offset:2048 lds
    s_waitcnt lgkmcnt(6)
    v_mfma_f32_32x32x16_bf16 v[176:191], a[160:163], a[112:115], v[176:191]
    ds_read_b128 a[116:119], v107 offset:36864
    ds_read_b64_tr_b16 a[180:181], v111 offset:36864
    ds_read_b64_tr_b16 a[182:183], v111 offset:38144
    ds_read_b64_tr_b16 a[184:185], v111 offset:36896
    ds_read_b64_tr_b16 a[186:187], v111 offset:38176
    ds_read_b64_tr_b16 a[188:189], v111 offset:36928
    v_mfma_f32_32x32x16_bf16 v[192:207], a[164:167], a[112:115], v[192:207]
    ds_read_b64_tr_b16 a[190:191], v111 offset:38208
    ds_read_b64_tr_b16 a[192:193], v111 offset:36960
    ds_read_b64_tr_b16 a[194:195], v111 offset:38240
    ds_read_b64_tr_b16 a[196:197], v111 offset:36992
    ds_read_b64_tr_b16 a[198:199], v111 offset:38272
    s_waitcnt lgkmcnt(11)
    v_mfma_f32_32x32x16_bf16 v[208:223], a[168:171], a[112:115], v[208:223]
    v_subrev_u32 v107, 73728, v107
    v_subrev_u32 v111, 73728, v111
    buffer_load_dwordx4 v93, s[24:27], s69 offen offset:3072 lds
    v_mfma_f32_32x32x16_bf16 v[224:239], a[172:175], a[112:115], v[224:239]
    s_mov_b32 s70, 2211840
    s_add_u32 m0, s73, 53248
    s_nop 0
    buffer_load_dwordx4 v94, s[28:31], s70 offen offset:0 lds
    v_mfma_f32_32x32x16_bf16 v[240:255], a[176:179], a[112:115], v[240:255]
    v_mfma_f32_16x16x32_bf16 v[156:159], v[20:23], a[160:163], v[156:159]
    v_mfma_f32_16x16x32_bf16 v[160:163], v[20:23], a[164:167], v[160:163]
    buffer_load_dwordx4 v95, s[28:31], s70 offen offset:1024 lds
    v_mfma_f32_16x16x32_bf16 v[164:167], v[20:23], a[168:171], v[164:167]
    v_mfma_f32_16x16x32_bf16 v[168:171], v[20:23], a[172:175], v[168:171]
    v_mfma_f32_16x16x32_bf16 v[172:175], v[20:23], a[176:179], v[172:175]
    s_waitcnt lgkmcnt(6)
    v_mfma_f32_32x32x16_bf16 v[176:191], a[180:183], a[116:119], v[176:191]
    ds_read_b128 a[120:123], v108 offset:36864
    ds_read_b64_tr_b16 a[160:161], v112 offset:36864
    ds_read_b64_tr_b16 a[162:163], v112 offset:38144
    ds_read_b64_tr_b16 a[164:165], v112 offset:36896
    ds_read_b64_tr_b16 a[166:167], v112 offset:38176
    ds_read_b64_tr_b16 a[168:169], v112 offset:36928
    v_mfma_f32_32x32x16_bf16 v[192:207], a[184:187], a[116:119], v[192:207]
    ds_read_b64_tr_b16 a[170:171], v112 offset:38208
    ds_read_b64_tr_b16 a[172:173], v112 offset:36960
    ds_read_b64_tr_b16 a[174:175], v112 offset:38240
    ds_read_b64_tr_b16 a[176:177], v112 offset:36992
    ds_read_b64_tr_b16 a[178:179], v112 offset:38272
    s_waitcnt lgkmcnt(11)
    v_mfma_f32_32x32x16_bf16 v[208:223], a[188:191], a[116:119], v[208:223]
    v_subrev_u32 v108, 73728, v108
    v_subrev_u32 v112, 73728, v112
    buffer_load_dwordx4 v96, s[28:31], s70 offen offset:2048 lds
    s_mov_b32 s80, 0
    s_waitcnt vmcnt(7)
    v_xor_b32_e64 v133, v128, v68
    v_bitop3_b32 v133, v133, v129, v69 bitop3:0xf6
    v_bitop3_b32 v133, v133, v130, v70 bitop3:0xf6
    v_bitop3_b32 v133, v133, v131, v71 bitop3:0xf6
    v_and_b32 v133, 0xff, v133
    v_cmp_ne_u32 vcc, 0, v133
    s_nop 0
    s_cbranch_vccz L_ok_stA
L_retry_stA:
    s_sleep 1
    buffer_load_dwordx4 v[128:131], v132, s[36:39], 0 offen sc1
    s_waitcnt vmcnt(0)
    v_xor_b32 v133, v128, v68
    v_bitop3_b32 v133, v133, v129, v69 bitop3:0xf6
    v_bitop3_b32 v133, v133, v130, v70 bitop3:0xf6
    v_bitop3_b32 v133, v133, v131, v71 bitop3:0xf6
    v_and_b32 v133, 0xff, v133
    v_cmp_ne_u32 vcc, 0, v133
    s_add_u32 s80, s80, 1
    s_cmp_lt_u32 s80, 100000
    s_cselect_b64 s[82:83], vcc, 0
    s_cmp_lg_u64 s[82:83], 0
    s_cbranch_scc1 L_retry_stA
    s_nop 4
L_ok_stA:
    v_mfma_f32_32x32x16_bf16 v[224:239], a[192:195], a[116:119], v[224:239]
    buffer_load_dwordx4 v97, s[28:31], s70 offen offset:3072 lds
    v_cmp_eq_u32 vcc, 0, v14
    v_and_b32 v128, s88, v128
    v_and_b32 v66, s88, v129
    v_cndmask_b32 v128, 0, v128, vcc
    v_mfma_f32_32x32x16_bf16 v[240:255], a[196:199], a[116:119], v[240:255]
    s_add_u32 m0, s73, 57344
    s_nop 0
    buffer_load_dwordx4 v98, s[28:31], s70 offen offset:0 lds
    v_and_b32 v67, s88, v130
    v_cvt_pk_bf16_f32 v76, v128, v128
    v_and_b32 v72, s88, v131
    s_waitcnt lgkmcnt(6)
    v_mfma_f32_32x32x16_bf16 v[176:191], a[160:163], a[120:123], v[176:191]
    ds_read_b128 a[124:127], v109 offset:36864
    ds_read_b64_tr_b16 a[180:181], v113 offset:36864
    ds_read_b64_tr_b16 a[182:183], v113 offset:38144
    ds_read_b64_tr_b16 a[184:185], v113 offset:36896
    ds_read_b64_tr_b16 a[186:187], v113 offset:38176
    ds_read_b64_tr_b16 a[188:189], v113 offset:36928
    v_mfma_f32_32x32x16_bf16 v[192:207], a[164:167], a[120:123], v[192:207]
    ds_read_b64_tr_b16 a[190:191], v113 offset:38208
    ds_read_b64_tr_b16 a[192:193], v113 offset:36960
    ds_read_b64_tr_b16 a[194:195], v113 offset:38240
    ds_read_b64_tr_b16 a[196:197], v113 offset:36992
    ds_read_b64_tr_b16 a[198:199], v113 offset:38272
    s_waitcnt lgkmcnt(11)
    v_mfma_f32_32x32x16_bf16 v[208:223], a[168:171], a[120:123], v[208:223]
    v_subrev_u32 v109, 73728, v109
    v_subrev_u32 v113, 73728, v113
    s_mov_b32 s70, 0
    s_add_u32 m0, s91, 73728
    s_nop 0
    buffer_load_dwordx4 v17, s[32:35], s70 offen offset:0 lds
    v_and_b32 v129, 0xffff0000, v76
    v_mfma_f32_32x32x16_bf16 v[224:239], a[172:175], a[120:123], v[224:239]
    buffer_load_dwordx4 v18, s[32:35], s70 offen offset:1024 lds
    v_and_b32 v73, s88, v131
    v_sub_f32 v129, v128, v129
    v_mov_b32 v78, 0
    v_cvt_pk_bf16_f32 v77, v129, 0
    v_mfma_f32_32x32x16_bf16 v[240:255], a[176:179], a[120:123], v[240:255]
    v_mov_b32 v79, 0
    s_waitcnt lgkmcnt(0)
    s_barrier
    v_mfma_f32_32x32x16_bf16 v[176:191], a[180:183], a[124:127], v[176:191]
    ds_read_b128 a[128:131], v106 offset:0
    ds_read_b64_tr_b16 a[160:161], v110 offset:0
    ds_read_b64_tr_b16 a[162:163], v110 offset:1280
    ds_read_b64_tr_b16 a[164:165], v110 offset:32
    ds_read_b64_tr_b16 a[166:167], v110 offset:1312
    ds_read_b64_tr_b16 a[168:169], v110 offset:64
    v_mfma_f32_32x32x16_bf16 v[192:207], a[184:187], a[124:127], v[192:207]
    ds_read_b64_tr_b16 a[170:171], v110 offset:1344
    ds_read_b64_tr_b16 a[172:173], v110 offset:96
    ds_read_b64_tr_b16 a[174:175], v110 offset:1376
    ds_read_b64_tr_b16 a[176:177], v110 offset:128
    ds_read_b64_tr_b16 a[178:179], v110 offset:1408
    v_mfma_f32_32x32x16_bf16 v[208:223], a[188:191], a[124:127], v[208:223]
    s_mov_b32 s70, 196608
    s_add_u32 m0, s91, 81920
    s_nop 0
    buffer_load_dwordx4 v17, s[32:35], s70 offen offset:0 lds
    v_mfma_f32_32x32x16_bf16 v[224:239], a[192:195], a[124:127], v[224:239]
    buffer_load_dwordx4 v18, s[32:35], s70 offen offset:1024 lds
    v_mfma_f32_32x32x16_bf16 v[240:255], a[196:199], a[124:127], v[240:255]
    s_mov_b32 s70, 393216
    s_add_u32 m0, s91, 90112
    s_nop 0
    buffer_load_dwordx4 v17, s[32:35], s70 offen offset:0 lds
    s_waitcnt lgkmcnt(6)
    v_mfma_f32_32x32x16_bf16 v[176:191], a[160:163], a[128:131], v[176:191]
    ds_read_b128 a[132:135], v107 offset:0
    ds_read_b64_tr_b16 a[180:181], v111 offset:0
    ds_read_b64_tr_b16 a[182:183], v111 offset:1280
    ds_read_b64_tr_b16 a[184:185], v111 offset:32
    ds_read_b64_tr_b16 a[186:187], v111 offset:1312
    ds_read_b64_tr_b16 a[188:189], v111 offset:64
    v_mfma_f32_32x32x16_bf16 v[192:207], a[164:167], a[128:131], v[192:207]
    ds_read_b64_tr_b16 a[190:191], v111 offset:1344
    ds_read_b64_tr_b16 a[192:193], v111 offset:96
    ds_read_b64_tr_b16 a[194:195], v111 offset:1376
    ds_read_b64_tr_b16 a[196:197], v111 offset:128
    ds_read_b64_tr_b16 a[198:199], v111 offset:1408
    s_waitcnt lgkmcnt(11)
    v_mfma_f32_32x32x16_bf16 v[208:223], a[168:171], a[128:131], v[208:223]
    buffer_load_dwordx4 v18, s[32:35], s70 offen offset:1024 lds
    v_mfma_f32_32x32x16_bf16 v[224:239], a[172:175], a[128:131], v[224:239]
    s_mov_b32 s70, 589824
    s_add_u32 m0, s91, 98304
    s_nop 0
    buffer_load_dwordx4 v17, s[32:35], s70 offen offset:0 lds
    v_mfma_f32_32x32x16_bf16 v[240:255], a[176:179], a[128:131], v[240:255]
    v_mfma_f32_16x16x32_bf16 v[156:159], v[20:23], a[160:163], v[156:159]
    v_mfma_f32_16x16x32_bf16 v[160:163], v[20:23], a[164:167], v[160:163]
    buffer_load_dwordx4 v18, s[32:35], s70 offen offset:1024 lds
    v_mfma_f32_16x16x32_bf16 v[164:167], v[20:23], a[168:171], v[164:167]
    v_mfma_f32_16x16x32_bf16 v[168:171], v[20:23], a[172:175], v[168:171]
    v_mfma_f32_16x16x32_bf16 v[172:175], v[20:23], a[176:179], v[172:175]
    s_waitcnt lgkmcnt(6)
    v_mfma_f32_32x32x16_bf16 v[176:191], a[180:183], a[132:135], v[176:191]
    ds_read_b128 a[136:139], v108 offset:0
    ds_read_b64_tr_b16 a[160:161], v112 offset:0
    ds_read_b64_tr_b16 a[162:163], v112 offset:1280
    ds_read_b64_tr_b16 a[164:165], v112 offset:32
    ds_read_b64_tr_b16 a[166:167], v112 offset:1312
    ds_read_b64_tr_b16 a[168:169], v112 offset:64
    v_mfma_f32_32x32x16_bf16 v[192:207], a[184:187], a[132:135], v[192:207]
    ds_read_b64_tr_b16 a[170:171], v112 offset:1344
    ds_read_b64_tr_b16 a[172:173], v112 offset:96
    ds_read_b64_tr_b16 a[174:175], v112 offset:1376
    ds_read_b64_tr_b16 a[176:177], v112 offset:128
    ds_read_b64_tr_b16 a[178:179], v112 offset:1408
    s_waitcnt lgkmcnt(11)
    v_mfma_f32_32x32x16_bf16 v[208:223], a[188:191], a[132:135], v[208:223]
    s_mov_b32 s70, 786432
    s_add_u32 m0, s91, 110592
    s_nop 0
    buffer_load_dwordx4 v17, s[32:35], s70 offen offset:0 lds
    v_mfma_f32_32x32x16_bf16 v[224:239], a[192:195], a[132:135], v[224:239]
    buffer_load_dwordx4 v18, s[32:35], s70 offen offset:1024 lds
    v_mfma_f32_32x32x16_bf16 v[240:255], a[196:199], a[132:135], v[240:255]
    s_mov_b32 s70, 983040
    s_add_u32 m0, s91, 118784
    s_nop 0
    buffer_load_dwordx4 v17, s[32:35], s70 offen offset:0 lds
    s_waitcnt lgkmcnt(6)
    v_mfma_f32_32x32x16_bf16 v[176:191], a[160:163], a[136:139], v[176:191]
    ds_read_b128 a[140:143], v109 offset:0
    ds_read_b64_tr_b16 a[180:181], v113 offset:0
    ds_read_b64_tr_b16 a[182:183], v113 offset:1280
    ds_read_b64_tr_b16 a[184:185], v113 offset:32
    ds_read_b64_tr_b16 a[186:187], v113 offset:1312
    ds_read_b64_tr_b16 a[188:189], v113 offset:64
    v_mfma_f32_32x32x16_bf16 v[192:207], a[164:167], a[136:139], v[192:207]
    ds_read_b64_tr_b16 a[190:191], v113 offset:1344
    ds_read_b64_tr_b16 a[192:193], v113 offset:96
    ds_read_b64_tr_b16 a[194:195], v113 offset:1376
    ds_read_b64_tr_b16 a[196:197], v113 offset:128
    ds_read_b64_tr_b16 a[198:199], v113 offset:1408
    s_waitcnt lgkmcnt(11)
    v_mfma_f32_32x32x16_bf16 v[208:223], a[168:171], a[136:139], v[208:223]
    buffer_load_dwordx4 v18, s[32:35], s70 offen offset:1024 lds
    v_mfma_f32_32x32x16_bf16 v[224:239], a[172:175], a[136:139], v[224:239]
    s_mov_b32 s70, 1179648
    s_add_u32 m0, s91, 126976
    s_nop 0
    buffer_load_dwordx4 v17, s[32:35], s70 offen offset:0 lds
    v_mfma_f32_32x32x16_bf16 v[240:255], a[176:179], a[136:139], v[240:255]
    s_waitcnt vmcnt(13) lgkmcnt(0)
    s_barrier
    v_mfma_f32_32x32x16_bf16 v[176:191], a[180:183], a[140:143], v[176:191]
    ds_read_b128 a[144:147], v106 offset:36864
    ds_read_b64_tr_b16 a[160:161], v110 offset:36864
    ds_read_b64_tr_b16 a[162:163], v110 offset:38144
    ds_read_b64_tr_b16 a[164:165], v110 offset:36896
    ds_read_b64_tr_b16 a[166:167], v110 offset:38176
    ds_read_b64_tr_b16 a[168:169], v110 offset:36928
    v_mfma_f32_32x32x16_bf16 v[192:207], a[184:187], a[140:143], v[192:207]
    ds_read_b64_tr_b16 a[170:171], v110 offset:38208
    ds_read_b64_tr_b16 a[172:173], v110 offset:36960
    ds_read_b64_tr_b16 a[174:175], v110 offset:38240
    ds_read_b64_tr_b16 a[176:177], v110 offset:36992
    ds_read_b64_tr_b16 a[178:179], v110 offset:38272
    v_mfma_f32_32x32x16_bf16 v[208:223], a[188:191], a[140:143], v[208:223]
    buffer_load_dwordx4 v18, s[32:35], s70 offen offset:1024 lds
    buffer_store_dword v16, v115, s[36:39], 0 offen sc1
    v_lshlrev_b32 v74, 2, v15
    v_add_u32 v74, 159744, v74
    s_mul_i32 s63, s56, 640
    v_add_u32_e64 v75, s63, v74
    v_mfma_f32_32x32x16_bf16 v[224:239], a[192:195], a[140:143], v[224:239]
    s_mov_b32 s70, 1376256
    s_add_u32 m0, s91, 135168
    s_nop 0
    buffer_load_dwordx4 v17, s[32:35], s70 offen offset:0 lds
    v_mfma_f32_32x32x16_bf16 v[240:255], a[196:199], a[140:143], v[240:255]
    buffer_load_dwordx4 v18, s[32:35], s70 offen offset:1024 lds
    s_waitcnt lgkmcnt(6)
    v_mfma_f32_16x16x32_bf16 v[156:159], v[20:23], a[160:163], v[156:159]
    ds_read_b128 a[148:151], v107 offset:36864
    ds_read_b64_tr_b16 a[180:181], v111 offset:36864
    v_mfma_f32_16x16x32_bf16 v[160:163], v[20:23], a[164:167], v[160:163]
    ds_read_b64_tr_b16 a[182:183], v111 offset:38144
    s_waitcnt lgkmcnt(3)
    v_mfma_f32_16x16x32_bf16 v[164:167], v[20:23], a[168:171], v[164:167]
    ds_read_b64_tr_b16 a[184:185], v111 offset:36896
    ds_read_b64_tr_b16 a[186:187], v111 offset:38176
    v_mfma_f32_16x16x32_bf16 v[168:171], v[20:23], a[172:175], v[168:171]
    ds_read_b64_tr_b16 a[188:189], v111 offset:36928
    ds_read_b64_tr_b16 a[190:191], v111 offset:38208
    v_mfma_f32_16x16x32_bf16 v[172:175], v[20:23], a[176:179], v[172:175]
    ds_read_b64_tr_b16 a[192:193], v111 offset:36960
    ds_read_b64_tr_b16 a[194:195], v111 offset:38240
    v_mfma_f32_32x32x16_bf16 v[176:191], a[160:163], a[144:147], v[176:191]
    ds_read_b64_tr_b16 a[196:197], v111 offset:36992
    ds_read_b64_tr_b16 a[198:199], v111 offset:38272
    v_mfma_f32_32x32x16_bf16 v[192:207], a[164:167], a[144:147], v[192:207]
    v_mfma_f32_32x32x16_bf16 v[208:223], a[168:171], a[144:147], v[208:223]
    v_mfma_f32_32x32x16_bf16 v[224:239], a[172:175], a[144:147], v[224:239]
    v_mfma_f32_32x32x16_bf16 v[240:255], a[176:179], a[144:147], v[240:255]
    s_waitcnt lgkmcnt(6)
    v_mfma_f32_32x32x16_bf16 v[176:191], a[180:183], a[148:151], v[176:191]
    ds_read_b128 a[152:155], v108 offset:36864
    ds_read_b64_tr_b16 a[160:161], v112 offset:36864
    ds_read_b64_tr_b16 a[162:163], v112 offset:38144
    ds_read_b64_tr_b16 a[164:165], v112 offset:36896
    ds_read_b64_tr_b16 a[166:167], v112 offset:38176
    ds_read_b64_tr_b16 a[168:169], v112 offset:36928
    v_mfma_f32_32x32x16_bf16 v[192:207], a[184:187], a[148:151], v[192:207]
    ds_read_b64_tr_b16 a[170:171], v112 offset:38208
    ds_read_b64_tr_b16 a[172:173], v112 offset:36960
    ds_read_b64_tr_b16 a[174:175], v112 offset:38240
    ds_read_b64_tr_b16 a[176:177], v112 offset:36992
    ds_read_b64_tr_b16 a[178:179], v112 offset:38272
    s_waitcnt lgkmcnt(11)
    v_mfma_f32_32x32x16_bf16 v[208:223], a[188:191], a[148:151], v[208:223]
    ds_write_b32 v75, v156 offset:0
    ds_write_b32 v75, v160 offset:128
    ds_write_b32 v75, v164 offset:256
    ds_write_b32 v75, v168 offset:384
    ds_write_b32 v75, v172 offset:512
    v_mfma_f32_32x32x16_bf16 v[224:239], a[192:195], a[148:151], v[224:239]
    v_mfma_f32_32x32x16_bf16 v[240:255], a[196:199], a[148:151], v[240:255]
    s_waitcnt lgkmcnt(0)
    s_barrier
    v_mfma_f32_32x32x16_bf16 v[176:191], a[160:163], a[152:155], v[176:191]
    ds_read_b128 a[156:159], v109 offset:36864
    ds_read_b64_tr_b16 a[180:181], v113 offset:36864
    ds_read_b64_tr_b16 a[182:183], v113 offset:38144
    ds_read_b64_tr_b16 a[184:185], v113 offset:36896
    ds_read_b64_tr_b16 a[186:187], v113 offset:38176
    ds_read_b64_tr_b16 a[188:189], v113 offset:36928
    ds_read_b64_tr_b16 a[190:191], v113 offset:38208
    v_mfma_f32_32x32x16_bf16 v[192:207], a[164:167], a[152:155], v[192:207]
    ds_read_b64_tr_b16 a[192:193], v113 offset:36960
    ds_read_b64_tr_b16 a[194:195], v113 offset:38240
    ds_read_b64_tr_b16 a[196:197], v113 offset:36992
    ds_read_b64_tr_b16 a[198:199], v113 offset:38272
    ds_read_b32 v156, v74 offset:0
    ds_read_b32 v157, v74 offset:640
    v_mfma_f32_32x32x16_bf16 v[208:223], a[168:171], a[152:155], v[208:223]
    ds_read_b32 v158, v74 offset:1280
    ds_read_b32 v159, v74 offset:1920
    ds_read_b32 v160, v74 offset:128
    ds_read_b32 v161, v74 offset:768
    ds_read_b32 v162, v74 offset:1408
    ds_read_b32 v163, v74 offset:2048
    v_mfma_f32_32x32x16_bf16 v[224:239], a[172:175], a[152:155], v[224:239]
    ds_read_b32 v164, v74 offset:256
    ds_read_b32 v165, v74 offset:896
    ds_read_b32 v166, v74 offset:1536
    ds_read_b32 v167, v74 offset:2176
    ds_read_b32 v168, v74 offset:384
    ds_read_b32 v169, v74 offset:1024
    v_mfma_f32_32x32x16_bf16 v[240:255], a[176:179], a[152:155], v[240:255]
    ds_read_b32 v170, v74 offset:1664
    ds_read_b32 v171, v74 offset:2304
    ds_read_b32 v172, v74 offset:512
    ds_read_b32 v173, v74 offset:1152
    ds_read_b32 v174, v74 offset:1792
    ds_read_b32 v175, v74 offset:2432
    s_waitcnt lgkmcnt(15)
    v_mfma_f32_32x32x16_bf16 v[176:191], a[180:183], a[156:159], v[176:191]
    v_add_f32 v156, v156, v157
    s_waitcnt lgkmcnt(14)
    v_add_f32 v160, v160, v161
    s_waitcnt lgkmcnt(10)
    v_add_f32 v164, v164, v165
    s_waitcnt lgkmcnt(6)
    v_add_f32 v168, v168, v169
    s_waitcnt lgkmcnt(2)
    v_add_f32 v172, v172, v173
    v_add_f32 v158, v158, v159
    v_add_f32 v162, v162, v163
    v_add_f32 v166, v166, v167
    v_add_f32_e64 v170, v170, v171
    v_mfma_f32_32x32x16_bf16 v[192:207], a[184:187], a[156:159], v[192:207]
    s_waitcnt lgkmcnt(0)
    v_add_f32 v174, v174, v175
    v_add_f32 v158, v156, v158
    v_add_f32 v162, v160, v162
    v_add_f32 v166, v164, v166
    v_add_f32 v170, v168, v170
    v_add_f32_e64 v174, v172, v174
    v_cvt_pk_bf16_f32 v157, v158, 0
    v_cvt_pk_bf16_f32 v161, v162, 0
    v_cvt_pk_bf16_f32 v165, v166, 0
    v_mfma_f32_32x32x16_bf16 v[208:223], a[188:191], a[156:159], v[208:223]
    v_cvt_pk_bf16_f32 v169, v170, 0
    v_cvt_pk_bf16_f32 v173, v174, 0
    v_lshlrev_b32 v159, 16, v157
    v_lshlrev_b32 v163, 16, v161
    v_lshlrev_b32 v167, 16, v165
    v_lshlrev_b32 v171, 16, v169
    v_lshlrev_b32 v175, 16, v173
    v_sub_f32 v159, v158, v159
    v_sub_f32_e64 v163, v162, v163
    v_mfma_f32_32x32x16_bf16 v[224:239], a[192:195], a[156:159], v[224:239]
    v_sub_f32 v167, v166, v167
    v_sub_f32 v171, v170, v171
    v_sub_f32_e64 v175, v174, v175
    v_cvt_pk_bf16_f32 v156, v158, v159
    v_cvt_pk_bf16_f32 v160, v162, v163
    v_cvt_pk_bf16_f32 v164, v166, v167
    v_cvt_pk_bf16_f32 v168, v170, v171
    v_cvt_pk_bf16_f32 v172, v174, v175
    v_mov_b32_e64 v158, 0
    v_mfma_f32_32x32x16_bf16 v[240:255], a[196:199], a[156:159], v[240:255]
    v_mov_b32 v162, 0
    v_mov_b32 v166, 0
    v_mov_b32 v170, 0
    v_mov_b32 v174, 0
    v_mov_b32 v159, 0
    v_mov_b32 v163, 0
    v_mov_b32 v167, 0
    v_mov_b32 v171, 0
    v_mov_b32_e64 v175, 0
    v_mfma_f32_32x32x16_bf16 v[176:191], v[156:159], v[76:79], v[176:191]
    v_mfma_f32_32x32x16_bf16 v[192:207], v[160:163], v[76:79], v[192:207]
    v_mfma_f32_32x32x16_bf16 v[208:223], v[164:167], v[76:79], v[208:223]
    v_mfma_f32_32x32x16_bf16 v[224:239], v[168:171], v[76:79], v[224:239]
    v_mfma_f32_32x32x16_bf16 v[240:255], v[172:175], v[76:79], v[240:255]
    s_barrier
    s_nop 6
    v_cvt_pk_bf16_f32 v176, v176, v177
    v_cvt_pk_bf16_f32 v177, v178, v179
    v_cvt_pk_bf16_f32 v178, v180, v181
    v_cvt_pk_bf16_f32 v179, v182, v183
    v_cvt_pk_bf16_f32 v180, v184, v185
    v_cvt_pk_bf16_f32 v181, v186, v187
    v_cvt_pk_bf16_f32 v182, v188, v189
    v_cvt_pk_bf16_f32 v183, v190, v191
    v_cvt_pk_bf16_f32 v184, v192, v193
    v_cvt_pk_bf16_f32 v185, v194, v195
    v_cvt_pk_bf16_f32 v186, v196, v197
    v_cvt_pk_bf16_f32 v187, v198, v199
    v_cvt_pk_bf16_f32 v188, v200, v201
    v_cvt_pk_bf16_f32 v189, v202, v203
    v_cvt_pk_bf16_f32 v190, v204, v205
    v_cvt_pk_bf16_f32 v191, v206, v207
    v_cvt_pk_bf16_f32 v192, v208, v209
    v_cvt_pk_bf16_f32 v193, v210, v211
    v_cvt_pk_bf16_f32 v194, v212, v213
    v_cvt_pk_bf16_f32 v195, v214, v215
    v_mfma_f32_32x32x16_bf16 v[128:143], a[200:203], v[176:179], 0
    v_mfma_f32_32x32x16_bf16 v[144:159], a[212:215], v[176:179], 0
    v_mfma_f32_32x32x16_bf16 v[128:143], a[204:207], v[180:183], v[128:143]
    v_mfma_f32_32x32x16_bf16 v[144:159], a[216:219], v[180:183], v[144:159]
    v_mfma_f32_32x32x16_bf16 v[128:143], a[208:211], v[184:187], v[128:143]
    v_mfma_f32_32x32x16_bf16 v[144:159], a[220:223], v[184:187], v[144:159]
    v_mfma_f32_32x32x16_bf16 v[160:175], a[232:235], v[184:187], 0
    v_mfma_f32_32x32x16_bf16 v[144:159], a[224:227], v[188:191], v[144:159]
    v_mfma_f32_32x32x16_bf16 v[160:175], a[236:239], v[188:191], v[160:175]
    v_mfma_f32_32x32x16_bf16 v[144:159], a[228:231], v[192:195], v[144:159]
    v_mfma_f32_32x32x16_bf16 v[160:175], a[240:243], v[192:195], v[160:175]
    v_cvt_pk_bf16_f32 v204, v216, v217
    v_cvt_pk_bf16_f32 v205, v218, v219
    v_cvt_pk_bf16_f32 v206, v220, v221
    v_cvt_pk_bf16_f32 v207, v222, v223
    v_cvt_pk_bf16_f32 v208, v224, v225
    v_cvt_pk_bf16_f32 v209, v226, v227
    v_cvt_pk_bf16_f32 v210, v228, v229
    v_cvt_pk_bf16_f32 v211, v230, v231
    v_cvt_pk_bf16_f32 v212, v232, v233
    v_cvt_pk_bf16_f32 v213, v234, v235
    v_cvt_pk_bf16_f32 v214, v67, 0
    v_mov_b32_e64 v215, 0
    ds_write_b128 v28, v[204:207] offset:0
    ds_write_b128 v29, v[208:211] offset:0
    ds_write_b128 v30, v[212:215] offset:0
    buffer_load_dword v50, v49, s[36:39], 0 offen offset:0 sc1
    v_max3_f32 v74, v128, v129, v130
    v_min3_f32 v75, v128, v129, v130
    v_max3_f32 v74, v74, v131, v132
    v_min3_f32 v75, v75, v131, v132
    v_max3_f32 v74, v74, v133, v134
    v_min3_f32 v75, v75, v133, v134
    v_max3_f32 v74, v74, v135, v136
    v_min3_f32 v75, v75, v135, v136
    v_max3_f32 v74, v74, v137, v138
    v_min3_f32 v75, v75, v137, v138
    v_max3_f32 v74, v74, v139, v140
    v_min3_f32 v75, v75, v139, v140
    v_max3_f32 v74, v74, v141, v142
    v_min3_f32 v75, v75, v141, v142
    v_max3_f32 v74, v74, v143, v144
    v_min3_f32 v75, v75, v143, v144
    v_max3_f32 v74, v74, v145, v146
    v_min3_f32 v75, v75, v145, v146
    v_max_f32 v74, v74, v147
    v_min_f32 v75, v75, v147
    v_mul_f32_e64 v74, -v72, v74
    v_mul_f32_e64 v75, v72, v75
    v_pk_fma_f32 v[88:89], v[128:129], v[72:73], v[74:75] op_sel_hi:[1,1,0]
    v_pk_fma_f32 v[108:109], v[128:129], v[72:73], v[74:75] op_sel:[0,0,1] op_sel_hi:[1,1,1] neg_lo:[0,1,0] neg_hi:[0,1,0]
    v_pk_fma_f32 v[90:91], v[130:131], v[72:73], v[74:75] op_sel_hi:[1,1,0]
    v_pk_fma_f32 v[110:111], v[130:131], v[72:73], v[74:75] op_sel:[0,0,1] op_sel_hi:[1,1,1] neg_lo:[0,1,0] neg_hi:[0,1,0]
    v_pk_fma_f32 v[92:93], v[132:133], v[72:73], v[74:75] op_sel_hi:[1,1,0]
    v_pk_fma_f32 v[112:113], v[132:133], v[72:73], v[74:75] op_sel:[0,0,1] op_sel_hi:[1,1,1] neg_lo:[0,1,0] neg_hi:[0,1,0]
    v_pk_fma_f32 v[94:95], v[134:135], v[72:73], v[74:75] op_sel_hi:[1,1,0]
    v_pk_fma_f32 v[114:115], v[134:135], v[72:73], v[74:75] op_sel:[0,0,1] op_sel_hi:[1,1,1] neg_lo:[0,1,0] neg_hi:[0,1,0]
    v_pk_fma_f32 v[96:97], v[136:137], v[72:73], v[74:75] op_sel_hi:[1,1,0]
    v_pk_fma_f32 v[116:117], v[136:137], v[72:73], v[74:75] op_sel:[0,0,1] op_sel_hi:[1,1,1] neg_lo:[0,1,0] neg_hi:[0,1,0]
    v_pk_fma_f32 v[98:99], v[138:139], v[72:73], v[74:75] op_sel_hi:[1,1,0]
    v_pk_fma_f32 v[118:119], v[138:139], v[72:73], v[74:75] op_sel:[0,0,1] op_sel_hi:[1,1,1] neg_lo:[0,1,0] neg_hi:[0,1,0]
    v_pk_fma_f32 v[100:101], v[140:141], v[72:73], v[74:75] op_sel_hi:[1,1,0]
    v_pk_fma_f32 v[120:121], v[140:141], v[72:73], v[74:75] op_sel:[0,0,1] op_sel_hi:[1,1,1] neg_lo:[0,1,0] neg_hi:[0,1,0]
    v_pk_fma_f32 v[102:103], v[142:143], v[72:73], v[74:75] op_sel_hi:[1,1,0]
    v_pk_fma_f32 v[122:123], v[142:143], v[72:73], v[74:75] op_sel:[0,0,1] op_sel_hi:[1,1,1] neg_lo:[0,1,0] neg_hi:[0,1,0]
    v_pk_fma_f32 v[104:105], v[144:145], v[72:73], v[74:75] op_sel_hi:[1,1,0]
    v_pk_fma_f32 v[124:125], v[144:145], v[72:73], v[74:75] op_sel:[0,0,1] op_sel_hi:[1,1,1] neg_lo:[0,1,0] neg_hi:[0,1,0]
    v_pk_fma_f32 v[106:107], v[146:147], v[72:73], v[74:75] op_sel_hi:[1,1,0]
    v_pk_fma_f32 v[126:127], v[146:147], v[72:73], v[74:75] op_sel:[0,0,1] op_sel_hi:[1,1,1] neg_lo:[0,1,0] neg_hi:[0,1,0]
    v_exp_f32 v88, v88
    v_exp_f32 v89, v89
    v_exp_f32 v90, v90
    v_exp_f32 v91, v91
    v_exp_f32 v92, v92
    v_exp_f32 v93, v93
    v_exp_f32 v94, v94
    v_exp_f32 v95, v95
    v_exp_f32 v96, v96
    v_exp_f32 v97, v97
    v_exp_f32 v98, v98
    v_exp_f32 v99, v99
    v_exp_f32 v100, v100
    v_exp_f32 v101, v101
    v_exp_f32 v102, v102
    v_exp_f32 v103, v103
    v_exp_f32 v104, v104
    v_exp_f32 v105, v105
    v_exp_f32 v106, v106
    v_exp_f32 v107, v107
    v_exp_f32 v108, v108
    v_exp_f32 v109, v109
    v_exp_f32 v110, v110
    v_exp_f32 v111, v111
    v_exp_f32 v112, v112
    v_exp_f32 v113, v113
    v_exp_f32 v114, v114
    v_exp_f32 v115, v115
    v_exp_f32 v116, v116
    v_exp_f32 v117, v117
    v_exp_f32 v118, v118
    v_exp_f32 v119, v119
    v_exp_f32 v120, v120
    v_exp_f32 v121, v121
    v_exp_f32 v122, v122
    v_exp_f32 v123, v123
    v_exp_f32 v124, v124
    v_exp_f32 v125, v125
    v_exp_f32 v126, v126
    v_exp_f32 v127, v127
    v_pk_add_f32 v[80:81], v[88:89], v[90:91]
    v_pk_add_f32 v[82:83], v[108:109], v[110:111]
    v_pk_add_f32 v[80:81], v[80:81], v[92:93]
    v_pk_add_f32 v[82:83], v[82:83], v[112:113]
    v_pk_add_f32 v[80:81], v[80:81], v[94:95]
    v_pk_add_f32 v[82:83], v[82:83], v[114:115]
    v_pk_add_f32 v[80:81], v[80:81], v[96:97]
    v_pk_add_f32 v[82:83], v[82:83], v[116:117]
    v_pk_add_f32 v[80:81], v[80:81], v[98:99]
    v_pk_add_f32 v[82:83], v[82:83], v[118:119]
    v_pk_add_f32 v[80:81], v[80:81], v[100:101]
    v_pk_add_f32 v[82:83], v[82:83], v[120:121]
    v_pk_add_f32 v[80:81], v[80:81], v[102:103]
    v_pk_add_f32 v[82:83], v[82:83], v[122:123]
    v_pk_add_f32 v[80:81], v[80:81], v[104:105]
    v_pk_add_f32 v[82:83], v[82:83], v[124:125]
    v_pk_add_f32 v[80:81], v[80:81], v[106:107]
    v_pk_add_f32 v[82:83], v[82:83], v[126:127]
    v_add_f32 v80, v80, v81
    v_add_f32 v82, v82, v83
    v_rcp_f32 v80, v80
    v_rcp_f32 v82, v82
    v_mul_f32 v80, v66, v80
    v_mul_f32 v82, v66, v82
    v_pk_mul_f32 v[88:89], v[88:89], v[80:81] op_sel_hi:[1,0]
    v_pk_mul_f32 v[108:109], v[108:109], v[82:83] op_sel_hi:[1,0]
    v_pk_mul_f32 v[90:91], v[90:91], v[80:81] op_sel_hi:[1,0]
    v_pk_mul_f32 v[110:111], v[110:111], v[82:83] op_sel_hi:[1,0]
    v_pk_mul_f32 v[92:93], v[92:93], v[80:81] op_sel_hi:[1,0]
    v_pk_mul_f32 v[112:113], v[112:113], v[82:83] op_sel_hi:[1,0]
    v_pk_mul_f32 v[94:95], v[94:95], v[80:81] op_sel_hi:[1,0]
    v_pk_mul_f32 v[114:115], v[114:115], v[82:83] op_sel_hi:[1,0]
    v_pk_mul_f32 v[96:97], v[96:97], v[80:81] op_sel_hi:[1,0]
    v_pk_mul_f32 v[116:117], v[116:117], v[82:83] op_sel_hi:[1,0]
    v_pk_mul_f32 v[98:99], v[98:99], v[80:81] op_sel_hi:[1,0]
    v_pk_mul_f32 v[118:119], v[118:119], v[82:83] op_sel_hi:[1,0]
    v_pk_mul_f32 v[100:101], v[100:101], v[80:81] op_sel_hi:[1,0]
    v_pk_mul_f32 v[120:121], v[120:121], v[82:83] op_sel_hi:[1,0]
    v_pk_mul_f32 v[102:103], v[102:103], v[80:81] op_sel_hi:[1,0]
    v_pk_mul_f32 v[122:123], v[122:123], v[82:83] op_sel_hi:[1,0]
    v_pk_mul_f32 v[104:105], v[104:105], v[80:81] op_sel_hi:[1,0]
    v_pk_mul_f32 v[124:125], v[124:125], v[82:83] op_sel_hi:[1,0]
    v_pk_mul_f32 v[106:107], v[106:107], v[80:81] op_sel_hi:[1,0]
    v_pk_mul_f32 v[126:127], v[126:127], v[82:83] op_sel_hi:[1,0]
    v_cvt_pk_bf16_f32 v184, v88, v89
    v_cvt_pk_bf16_f32 v185, v90, v91
    v_cvt_pk_bf16_f32 v186, v92, v93
    v_cvt_pk_bf16_f32 v187, v94, v95
    v_cvt_pk_bf16_f32 v188, v96, v97
    v_cvt_pk_bf16_f32 v189, v98, v99
    v_cvt_pk_bf16_f32 v190, v100, v101
    v_cvt_pk_bf16_f32 v191, v102, v103
    v_cvt_pk_bf16_f32 v192, v104, v105
    v_cvt_pk_bf16_f32 v193, v106, v107
    v_cvt_pk_bf16_f32 v194, v108, v109
    v_cvt_pk_bf16_f32 v195, v110, v111
    v_cvt_pk_bf16_f32 v196, v112, v113
    v_cvt_pk_bf16_f32 v197, v114, v115
    v_cvt_pk_bf16_f32 v198, v116, v117
    v_cvt_pk_bf16_f32 v199, v118, v119
    v_cvt_pk_bf16_f32 v200, v120, v121
    v_cvt_pk_bf16_f32 v201, v122, v123
    v_cvt_pk_bf16_f32 v202, v124, v125
    v_cvt_pk_bf16_f32 v203, v126, v127
    ds_write_b128 v19, v[184:187] offset:0
    ds_write_b128 v24, v[188:191] offset:0
    ds_write_b128 v25, v[192:195] offset:0
    ds_write_b128 v26, v[196:199] offset:0
    ds_write_b128 v27, v[200:203] offset:0
    v_cvt_pk_bf16_f32 v204, v236, v237
    v_cvt_pk_bf16_f32 v205, v238, v239
    v_cvt_pk_bf16_f32 v206, v240, v241
    v_cvt_pk_bf16_f32 v207, v242, v243
    v_cvt_pk_bf16_f32 v208, v244, v245
    v_cvt_pk_bf16_f32 v209, v246, v247
    v_cvt_pk_bf16_f32 v210, v248, v249
    v_cvt_pk_bf16_f32 v211, v250, v251
    v_cvt_pk_bf16_f32 v212, v252, v253
    v_cvt_pk_bf16_f32 v213, v254, v255
    v_cvt_pk_bf16_f32 v214, v67, 0
    v_mov_b32_e64 v215, 0
    ds_write_b128 v28, v[204:207] offset:16384
    ds_write_b128 v29, v[208:211] offset:16384
    ds_write_b128 v30, v[212:215] offset:16384
    v_max3_f32 v74, v148, v149, v150
    v_min3_f32 v75, v148, v149, v150
    v_max3_f32 v74, v74, v151, v152
    v_min3_f32 v75, v75, v151, v152
    v_max3_f32 v74, v74, v153, v154
    v_min3_f32 v75, v75, v153, v154
    v_max3_f32 v74, v74, v155, v156
    v_min3_f32 v75, v75, v155, v156
    v_max3_f32 v74, v74, v157, v158
    v_min3_f32 v75, v75, v157, v158
    v_max3_f32 v74, v74, v159, v160
    v_min3_f32 v75, v75, v159, v160
    v_max3_f32 v74, v74, v161, v162
    v_min3_f32 v75, v75, v161, v162
    v_max3_f32 v74, v74, v163, v164
    v_min3_f32 v75, v75, v163, v164
    v_max3_f32 v74, v74, v165, v166
    v_min3_f32 v75, v75, v165, v166
    v_max_f32 v74, v74, v167
    v_min_f32 v75, v75, v167
    v_mul_f32_e64 v74, -v72, v74
    v_mul_f32_e64 v75, v72, v75
    v_pk_fma_f32 v[88:89], v[148:149], v[72:73], v[74:75] op_sel_hi:[1,1,0]
    v_pk_fma_f32 v[108:109], v[148:149], v[72:73], v[74:75] op_sel:[0,0,1] op_sel_hi:[1,1,1] neg_lo:[0,1,0] neg_hi:[0,1,0]
    v_pk_fma_f32 v[90:91], v[150:151], v[72:73], v[74:75] op_sel_hi:[1,1,0]
    v_pk_fma_f32 v[110:111], v[150:151], v[72:73], v[74:75] op_sel:[0,0,1] op_sel_hi:[1,1,1] neg_lo:[0,1,0] neg_hi:[0,1,0]
    v_pk_fma_f32 v[92:93], v[152:153], v[72:73], v[74:75] op_sel_hi:[1,1,0]
    v_pk_fma_f32 v[112:113], v[152:153], v[72:73], v[74:75] op_sel:[0,0,1] op_sel_hi:[1,1,1] neg_lo:[0,1,0] neg_hi:[0,1,0]
    v_pk_fma_f32 v[94:95], v[154:155], v[72:73], v[74:75] op_sel_hi:[1,1,0]
    v_pk_fma_f32 v[114:115], v[154:155], v[72:73], v[74:75] op_sel:[0,0,1] op_sel_hi:[1,1,1] neg_lo:[0,1,0] neg_hi:[0,1,0]
    v_pk_fma_f32 v[96:97], v[156:157], v[72:73], v[74:75] op_sel_hi:[1,1,0]
    v_pk_fma_f32 v[116:117], v[156:157], v[72:73], v[74:75] op_sel:[0,0,1] op_sel_hi:[1,1,1] neg_lo:[0,1,0] neg_hi:[0,1,0]
    v_pk_fma_f32 v[98:99], v[158:159], v[72:73], v[74:75] op_sel_hi:[1,1,0]
    v_pk_fma_f32 v[118:119], v[158:159], v[72:73], v[74:75] op_sel:[0,0,1] op_sel_hi:[1,1,1] neg_lo:[0,1,0] neg_hi:[0,1,0]
    v_pk_fma_f32 v[100:101], v[160:161], v[72:73], v[74:75] op_sel_hi:[1,1,0]
    v_pk_fma_f32 v[120:121], v[160:161], v[72:73], v[74:75] op_sel:[0,0,1] op_sel_hi:[1,1,1] neg_lo:[0,1,0] neg_hi:[0,1,0]
    v_pk_fma_f32 v[102:103], v[162:163], v[72:73], v[74:75] op_sel_hi:[1,1,0]
    v_pk_fma_f32 v[122:123], v[162:163], v[72:73], v[74:75] op_sel:[0,0,1] op_sel_hi:[1,1,1] neg_lo:[0,1,0] neg_hi:[0,1,0]
    v_pk_fma_f32 v[104:105], v[164:165], v[72:73], v[74:75] op_sel_hi:[1,1,0]
    v_pk_fma_f32 v[124:125], v[164:165], v[72:73], v[74:75] op_sel:[0,0,1] op_sel_hi:[1,1,1] neg_lo:[0,1,0] neg_hi:[0,1,0]
    v_pk_fma_f32 v[106:107], v[166:167], v[72:73], v[74:75] op_sel_hi:[1,1,0]
    v_pk_fma_f32 v[126:127], v[166:167], v[72:73], v[74:75] op_sel:[0,0,1] op_sel_hi:[1,1,1] neg_lo:[0,1,0] neg_hi:[0,1,0]
    v_exp_f32 v88, v88
    v_exp_f32 v89, v89
    v_exp_f32 v90, v90
    v_exp_f32 v91, v91
    v_exp_f32 v92, v92
    v_exp_f32 v93, v93
    v_exp_f32 v94, v94
    v_exp_f32 v95, v95
    v_exp_f32 v96, v96
    v_exp_f32 v97, v97
    v_exp_f32 v98, v98
    v_exp_f32 v99, v99
    v_exp_f32 v100, v100
    v_exp_f32 v101, v101
    v_exp_f32 v102, v102
    v_exp_f32 v103, v103
    v_exp_f32 v104, v104
    v_exp_f32 v105, v105
    v_exp_f32 v106, v106
    v_exp_f32 v107, v107
    v_exp_f32 v108, v108
    v_exp_f32 v109, v109
    v_exp_f32 v110, v110
    v_exp_f32 v111, v111
    v_exp_f32 v112, v112
    v_exp_f32 v113, v113
    v_exp_f32 v114, v114
    v_exp_f32 v115, v115
    v_exp_f32 v116, v116
    v_exp_f32 v117, v117
    v_exp_f32 v118, v118
    v_exp_f32 v119, v119
    v_exp_f32 v120, v120
    v_exp_f32 v121, v121
    v_exp_f32 v122, v122
    v_exp_f32 v123, v123
    v_exp_f32 v124, v124
    v_exp_f32 v125, v125
    v_exp_f32 v126, v126
    v_exp_f32 v127, v127
    v_pk_add_f32 v[80:81], v[88:89], v[90:91]
    v_pk_add_f32 v[82:83], v[108:109], v[110:111]
    v_pk_add_f32 v[80:81], v[80:81], v[92:93]
    v_pk_add_f32 v[82:83], v[82:83], v[112:113]
    v_pk_add_f32 v[80:81], v[80:81], v[94:95]
    v_pk_add_f32 v[82:83], v[82:83], v[114:115]
    v_pk_add_f32 v[80:81], v[80:81], v[96:97]
    v_pk_add_f32 v[82:83], v[82:83], v[116:117]
    v_pk_add_f32 v[80:81], v[80:81], v[98:99]
    v_pk_add_f32 v[82:83], v[82:83], v[118:119]
    v_pk_add_f32 v[80:81], v[80:81], v[100:101]
    v_pk_add_f32 v[82:83], v[82:83], v[120:121]
    v_pk_add_f32 v[80:81], v[80:81], v[102:103]
    v_pk_add_f32 v[82:83], v[82:83], v[122:123]
    v_pk_add_f32 v[80:81], v[80:81], v[104:105]
    v_pk_add_f32 v[82:83], v[82:83], v[124:125]
    v_pk_add_f32 v[80:81], v[80:81], v[106:107]
    v_pk_add_f32 v[82:83], v[82:83], v[126:127]
    v_add_f32 v80, v80, v81
    v_add_f32 v82, v82, v83
    v_rcp_f32 v80, v80
    v_rcp_f32 v82, v82
    v_mul_f32 v80, v66, v80
    v_mul_f32 v82, v66, v82
    v_pk_mul_f32 v[88:89], v[88:89], v[80:81] op_sel_hi:[1,0]
    v_pk_mul_f32 v[108:109], v[108:109], v[82:83] op_sel_hi:[1,0]
    v_pk_mul_f32 v[90:91], v[90:91], v[80:81] op_sel_hi:[1,0]
    v_pk_mul_f32 v[110:111], v[110:111], v[82:83] op_sel_hi:[1,0]
    v_pk_mul_f32 v[92:93], v[92:93], v[80:81] op_sel_hi:[1,0]
    v_pk_mul_f32 v[112:113], v[112:113], v[82:83] op_sel_hi:[1,0]
    v_pk_mul_f32 v[94:95], v[94:95], v[80:81] op_sel_hi:[1,0]
    v_pk_mul_f32 v[114:115], v[114:115], v[82:83] op_sel_hi:[1,0]
    v_pk_mul_f32 v[96:97], v[96:97], v[80:81] op_sel_hi:[1,0]
    v_pk_mul_f32 v[116:117], v[116:117], v[82:83] op_sel_hi:[1,0]
    v_pk_mul_f32 v[98:99], v[98:99], v[80:81] op_sel_hi:[1,0]
    v_pk_mul_f32 v[118:119], v[118:119], v[82:83] op_sel_hi:[1,0]
    v_pk_mul_f32 v[100:101], v[100:101], v[80:81] op_sel_hi:[1,0]
    v_pk_mul_f32 v[120:121], v[120:121], v[82:83] op_sel_hi:[1,0]
    v_pk_mul_f32 v[102:103], v[102:103], v[80:81] op_sel_hi:[1,0]
    v_pk_mul_f32 v[122:123], v[122:123], v[82:83] op_sel_hi:[1,0]
    v_pk_mul_f32 v[104:105], v[104:105], v[80:81] op_sel_hi:[1,0]
    v_pk_mul_f32 v[124:125], v[124:125], v[82:83] op_sel_hi:[1,0]
    v_pk_mul_f32 v[106:107], v[106:107], v[80:81] op_sel_hi:[1,0]
    v_pk_mul_f32 v[126:127], v[126:127], v[82:83] op_sel_hi:[1,0]
    v_cvt_pk_bf16_f32 v184, v88, v89
    v_cvt_pk_bf16_f32 v185, v90, v91
    v_cvt_pk_bf16_f32 v186, v92, v93
    v_cvt_pk_bf16_f32 v187, v94, v95
    v_cvt_pk_bf16_f32 v188, v96, v97
    v_cvt_pk_bf16_f32 v189, v98, v99
    v_cvt_pk_bf16_f32 v190, v100, v101
    v_cvt_pk_bf16_f32 v191, v102, v103
    v_cvt_pk_bf16_f32 v192, v104, v105
    v_cvt_pk_bf16_f32 v193, v106, v107
    v_cvt_pk_bf16_f32 v194, v108, v109
    v_cvt_pk_bf16_f32 v195, v110, v111
    v_cvt_pk_bf16_f32 v196, v112, v113
    v_cvt_pk_bf16_f32 v197, v114, v115
    v_cvt_pk_bf16_f32 v198, v116, v117
    v_cvt_pk_bf16_f32 v199, v118, v119
    v_cvt_pk_bf16_f32 v200, v120, v121
    v_cvt_pk_bf16_f32 v201, v122, v123
    v_cvt_pk_bf16_f32 v202, v124, v125
    v_cvt_pk_bf16_f32 v203, v126, v127
    ds_write_b128 v19, v[184:187] offset:16384
    ds_write_b128 v24, v[188:191] offset:16384
    ds_write_b128 v25, v[192:195] offset:16384
    ds_write_b128 v26, v[196:199] offset:16384
    ds_write_b128 v27, v[200:203] offset:16384
    s_waitcnt lgkmcnt(0)
    s_barrier
    ds_read_b64_tr_b16 v[176:177], v31 offset:0
    ds_read_b64_tr_b16 v[178:179], v32 offset:0
    ds_read_b64_tr_b16 v[180:181], v33 offset:0
    ds_read_b64_tr_b16 v[182:183], v34 offset:0
    ds_read_b64_tr_b16 v[184:185], v35 offset:0
    ds_read_b64_tr_b16 v[186:187], v36 offset:0
    ds_read_b64_tr_b16 v[188:189], v37 offset:0
    ds_read_b64_tr_b16 v[190:191], v38 offset:0
    ds_read_b64_tr_b16 v[192:193], v39 offset:0
    ds_read_b64_tr_b16 v[194:195], v40 offset:0
    ds_read_b64_tr_b16 v[196:197], v31 offset:4096
    ds_read_b64_tr_b16 v[198:199], v32 offset:4096
    ds_read_b64_tr_b16 v[200:201], v33 offset:4096
    ds_read_b64_tr_b16 v[202:203], v34 offset:4096
    ds_read_b64_tr_b16 v[204:205], v35 offset:4096
    ds_read_b64_tr_b16 v[206:207], v36 offset:4096
    ds_read_b64_tr_b16 v[208:209], v37 offset:4096
    ds_read_b64_tr_b16 v[210:211], v38 offset:4096
    ds_read_b64_tr_b16 v[212:213], v39 offset:4096
    ds_read_b64_tr_b16 v[214:215], v40 offset:4096
    ds_read_b64_tr_b16 v[216:217], v31 offset:8192
    ds_read_b64_tr_b16 v[218:219], v32 offset:8192
    ds_read_b64_tr_b16 v[220:221], v33 offset:8192
    ds_read_b64_tr_b16 v[222:223], v34 offset:8192
    ds_read_b64_tr_b16 v[224:225], v35 offset:8192
    ds_read_b64_tr_b16 v[226:227], v36 offset:8192
    ds_read_b64_tr_b16 v[228:229], v37 offset:8192
    ds_read_b64_tr_b16 v[230:231], v38 offset:8192
    ds_read_b64_tr_b16 v[232:233], v39 offset:8192
    ds_read_b64_tr_b16 v[234:235], v40 offset:8192
    ds_read_b64_tr_b16 v[236:237], v31 offset:12288
    ds_read_b64_tr_b16 v[238:239], v32 offset:12288
    ds_read_b64_tr_b16 v[240:241], v33 offset:12288
    ds_read_b64_tr_b16 v[242:243], v34 offset:12288
    ds_read_b64_tr_b16 v[244:245], v35 offset:12288
    ds_read_b64_tr_b16 v[246:247], v36 offset:12288
    ds_read_b64_tr_b16 v[248:249], v37 offset:12288
    ds_read_b64_tr_b16 v[250:251], v38 offset:12288
    ds_read_b64_tr_b16 v[252:253], v39 offset:12288
    ds_read_b64_tr_b16 v[254:255], v40 offset:12288
    s_waitcnt lgkmcnt(15)
    v_mfma_f32_16x16x32_bf16 v[152:155], v[176:179], v[188:191], 0
    v_mfma_f32_16x16x32_bf16 v[156:159], v[176:179], v[192:195], 0
    v_mfma_f32_16x16x32_bf16 v[160:163], v[180:183], v[188:191], 0
    v_mfma_f32_16x16x32_bf16 v[164:167], v[180:183], v[192:195], 0
    v_mfma_f32_16x16x32_bf16 v[168:171], v[184:187], v[188:191], 0
    v_mfma_f32_16x16x32_bf16 v[172:175], v[184:187], v[192:195], 0
    v_mfma_f32_16x16x32_bf16 v[152:155], v[196:199], v[208:211], v[152:155]
    v_mfma_f32_16x16x32_bf16 v[156:159], v[196:199], v[212:215], v[156:159]
    v_mfma_f32_16x16x32_bf16 v[160:163], v[200:203], v[208:211], v[160:163]
    v_mfma_f32_16x16x32_bf16 v[164:167], v[200:203], v[212:215], v[164:167]
    v_mfma_f32_16x16x32_bf16 v[168:171], v[204:207], v[208:211], v[168:171]
    v_mfma_f32_16x16x32_bf16 v[172:175], v[204:207], v[212:215], v[172:175]
    s_waitcnt lgkmcnt(12)
    v_mfma_f32_16x16x32_bf16 v[152:155], v[216:219], v[228:231], v[152:155]
    s_waitcnt lgkmcnt(10)
    v_mfma_f32_16x16x32_bf16 v[156:159], v[216:219], v[232:235], v[156:159]
    v_mfma_f32_16x16x32_bf16 v[160:163], v[220:223], v[228:231], v[160:163]
    v_mfma_f32_16x16x32_bf16 v[164:167], v[220:223], v[232:235], v[164:167]
    v_mfma_f32_16x16x32_bf16 v[168:171], v[224:227], v[228:231], v[168:171]
    v_mfma_f32_16x16x32_bf16 v[172:175], v[224:227], v[232:235], v[172:175]
    s_waitcnt lgkmcnt(2)
    v_mfma_f32_16x16x32_bf16 v[152:155], v[236:239], v[248:251], v[152:155]
    s_waitcnt lgkmcnt(0)
    v_mfma_f32_16x16x32_bf16 v[156:159], v[236:239], v[252:255], v[156:159]
    v_mfma_f32_16x16x32_bf16 v[160:163], v[240:243], v[248:251], v[160:163]
    v_mfma_f32_16x16x32_bf16 v[164:167], v[240:243], v[252:255], v[164:167]
    v_mfma_f32_16x16x32_bf16 v[168:171], v[244:247], v[248:251], v[168:171]
    v_mfma_f32_16x16x32_bf16 v[172:175], v[244:247], v[252:255], v[172:175]
    s_waitcnt vmcnt(1)
    s_barrier
    v_perm_b32 v152, v152, v16, s76
    v_perm_b32 v153, v153, v16, s77
    v_perm_b32 v154, v154, v16, s78
    v_perm_b32 v155, v155, v16, s79
    buffer_store_dwordx4 v[152:155], v44, s[36:39], 0 offen offset:0 sc1
    v_perm_b32 v156, v156, v16, s76
    v_perm_b32 v157, v157, v16, s77
    v_perm_b32 v158, v158, v16, s78
    v_perm_b32 v159, v159, v16, s79
    buffer_store_dwordx4 v[156:159], v45, s[36:39], 0 offen offset:256 sc1
    v_perm_b32 v160, v160, v16, s76
    v_perm_b32 v161, v161, v16, s77
    v_perm_b32 v162, v162, v16, s78
    v_perm_b32 v163, v163, v16, s79
    buffer_store_dwordx4 v[160:163], v44, s[36:39], 0 offen offset:1344 sc1
    v_perm_b32 v164, v164, v16, s76
    v_perm_b32 v165, v165, v16, s77
    v_perm_b32 v166, v166, v16, s78
    v_perm_b32 v167, v167, v16, s79
    buffer_store_dwordx4 v[164:167], v45, s[36:39], 0 offen offset:1600 sc1
    v_perm_b32 v168, v168, v16, s76
    v_perm_b32 v169, v169, v16, s77
    v_perm_b32 v170, v170, v16, s78
    v_perm_b32 v171, v171, v16, s79
    buffer_store_dwordx4 v[168:171], v46, s[36:39], 0 offen offset:2688 sc1
    v_perm_b32 v172, v172, v16, s76
    v_perm_b32 v173, v173, v16, s77
    v_perm_b32 v174, v174, v16, s78
    v_perm_b32 v175, v175, v16, s79
    buffer_store_dwordx4 v[172:175], v47, s[36:39], 0 offen offset:2944 sc1
    ds_read_b64_tr_b16 a[160:161], v58 offset:0
    ds_read_b64_tr_b16 a[162:163], v58 offset:512
    ds_read_b64_tr_b16 a[164:165], v59 offset:0
    ds_read_b64_tr_b16 a[166:167], v59 offset:512
    ds_read_b64_tr_b16 a[168:169], v60 offset:0
    ds_read_b64_tr_b16 a[170:171], v60 offset:512
    ds_read_b64_tr_b16 a[172:173], v61 offset:0
    ds_read_b64_tr_b16 a[174:175], v61 offset:512
    s_waitcnt lgkmcnt(4)
    v_mfma_f32_32x32x16_bf16 v[224:239], a[160:163], a[0:3], 0
    ds_read_b64_tr_b16 a[176:177], v62 offset:0
    ds_read_b64_tr_b16 a[178:179], v62 offset:512
    ds_read_b64_tr_b16 a[180:181], v63 offset:0
    ds_read_b64_tr_b16 a[182:183], v63 offset:512
    s_mov_b32 s70, 1572864
    s_add_u32 m0, s91, 49152
    v_mfma_f32_32x32x16_bf16 v[240:255], a[164:167], a[0:3], 0
    buffer_load_dwordx4 v17, s[32:35], s70 offen offset:0 lds
    s_mov_b32 s80, 0
    s_waitcnt vmcnt(7)
    v_cmp_ne_u32 vcc, v50, v16
    s_nop 0
    s_cbranch_vccz L_ok_fwA
L_retry_fwA:
    s_sleep 1
    buffer_load_dword v50, v49, s[36:39], 0 offen offset:0 sc1
    s_waitcnt vmcnt(0)
    v_cmp_ne_u32 vcc, v50, v16
    s_add_u32 s80, s80, 1
    s_cmp_lt_u32 s80, 100000
    s_cselect_b64 s[82:83], vcc, 0
    s_cmp_lg_u64 s[82:83], 0
    s_cbranch_scc1 L_retry_fwA
    s_nop 4
L_ok_fwA:
    v_mfma_f32_16x16x32_bf16 v[216:219], v[20:23], a[160:163], 0
    buffer_load_dwordx4 v18, s[32:35], s70 offen offset:1024 lds
    buffer_load_dword v50, v51, s[36:39], 0 offen offset:48 sc1
    v_mfma_f32_16x16x32_bf16 v[220:223], v[20:23], a[164:167], 0
    s_lshl_b32 s63, s57, 3
    s_waitcnt lgkmcnt(4)
    v_mfma_f32_32x32x16_bf16 v[224:239], a[168:171], a[4:7], v[224:239]
    ds_read_b64_tr_b16 a[160:161], v64 offset:0
    ds_read_b64_tr_b16 a[162:163], v64 offset:512
    ds_read_b64_tr_b16 a[164:165], v65 offset:0
    ds_read_b64_tr_b16 a[166:167], v65 offset:512
    s_mov_b32 s70, 1769472
    s_add_u32 m0, s91, 57344
    v_mfma_f32_32x32x16_bf16 v[240:255], a[172:175], a[4:7], v[240:255]
    buffer_load_dwordx4 v17, s[32:35], s70 offen offset:0 lds
    s_lshl_b32 s64, s56, 1
    s_add_u32 s63, s63, s64
    s_mul_i32 s63, s63, 49152
    s_lshl_b32 s64, s87, 5
    s_waitcnt lgkmcnt(4)
    v_mfma_f32_32x32x16_bf16 v[224:239], a[176:179], a[8:11], v[224:239]
    ds_read_b64_tr_b16 a[168:169], v58 offset:8192
    ds_read_b64_tr_b16 a[170:171], v58 offset:8704
    ds_read_b64_tr_b16 a[172:173], v59 offset:8192
    ds_read_b64_tr_b16 a[174:175], v59 offset:8704
    buffer_load_dwordx4 v18, s[32:35], s70 offen offset:1024 lds
    s_add_u32 s63, s63, s64
    v_mfma_f32_32x32x16_bf16 v[240:255], a[180:183], a[8:11], v[240:255]
    v_lshrrev_b32_e64 v2, 4, v15
    v_mul_u32_u24 v2, 49152, v2
    v_lshl_add_u32 v2, v14, 8, v2
    v_and_b32 v3, 15, v1
    s_waitcnt lgkmcnt(4)
    v_mfma_f32_32x32x16_bf16 v[224:239], a[160:163], a[12:15], v[224:239]
    ds_read_b64_tr_b16 a[176:177], v60 offset:8192
    ds_read_b64_tr_b16 a[178:179], v60 offset:8704
    ds_read_b64_tr_b16 a[180:181], v61 offset:8192
    ds_read_b64_tr_b16 a[182:183], v61 offset:8704
    s_mov_b32 s70, 0
    s_add_u32 m0, s74, 0
    v_mfma_f32_32x32x16_bf16 v[240:255], a[164:167], a[12:15], v[240:255]
    buffer_load_dwordx4 v41, s[36:39], s70 offen offset:0 sc1 lds
    v_lshl_add_u32 v2, v3, 4, v2
    v_add_u32 v19, s63, v2
    s_lshl_b32 s63, s57, 7
    s_lshl_b32 s64, s58, 2
    s_waitcnt lgkmcnt(4)
    v_mfma_f32_32x32x16_bf16 v[224:239], a[168:171], a[16:19], v[224:239]
    ds_read_b64_tr_b16 a[160:161], v62 offset:8192
    ds_read_b64_tr_b16 a[162:163], v62 offset:8704
    ds_read_b64_tr_b16 a[164:165], v63 offset:8192
    ds_read_b64_tr_b16 a[166:167], v63 offset:8704
    buffer_load_dwordx4 v41, s[36:39], s70 offen offset:1024 sc1 lds
    s_add_u32 s63, s63, s64
    v_mfma_f32_32x32x16_bf16 v[240:255], a[172:175], a[16:19], v[240:255]
    s_add_u32 s63, s63, 13543456
    v_cmp_eq_u32 vcc, 0, v0
    v_mov_b32_e64 v6, s63
    v_mov_b32 v24, 2130706432
    v_cndmask_b32_e64 v24, v24, v6, vcc
    v_mfma_f32_16x16x32_bf16 v[216:219], v[20:23], a[168:171], v[216:219]
    v_mfma_f32_16x16x32_bf16 v[220:223], v[20:23], a[172:175], v[220:223]
    buffer_load_dwordx4 v41, s[36:39], s70 offen offset:2048 sc1 lds
    s_waitcnt lgkmcnt(4)
    v_mfma_f32_32x32x16_bf16 v[224:239], a[176:179], a[20:23], v[224:239]
    ds_read_b64_tr_b16 a[168:169], v64 offset:8192
    ds_read_b64_tr_b16 a[170:171], v64 offset:8704
    ds_read_b64_tr_b16 a[172:173], v65 offset:8192
    ds_read_b64_tr_b16 a[174:175], v65 offset:8704
    v_mfma_f32_32x32x16_bf16 v[240:255], a[180:183], a[20:23], v[240:255]
    buffer_load_dwordx4 v41, s[36:39], s70 offen offset:3072 sc1 lds
    s_waitcnt lgkmcnt(4)
    v_mfma_f32_32x32x16_bf16 v[224:239], a[160:163], a[24:27], v[224:239]
    ds_read_b64_tr_b16 a[176:177], v58 offset:16384
    ds_read_b64_tr_b16 a[178:179], v58 offset:16896
    ds_read_b64_tr_b16 a[180:181], v59 offset:16384
    ds_read_b64_tr_b16 a[182:183], v59 offset:16896
    v_mfma_f32_32x32x16_bf16 v[240:255], a[164:167], a[24:27], v[240:255]
    s_mov_b32 s70, 4096
    s_add_u32 m0, s74, 4096
    s_nop 0
    buffer_load_dwordx4 v41, s[36:39], s70 offen sc1 lds
    s_waitcnt lgkmcnt(4)
    v_mfma_f32_32x32x16_bf16 v[224:239], a[168:171], a[28:31], v[224:239]
    ds_read_b64_tr_b16 a[160:161], v60 offset:16384
    ds_read_b64_tr_b16 a[162:163], v60 offset:16896
    ds_read_b64_tr_b16 a[164:165], v61 offset:16384
    ds_read_b64_tr_b16 a[166:167], v61 offset:16896
    v_mfma_f32_32x32x16_bf16 v[240:255], a[172:175], a[28:31], v[240:255]
    s_mov_b32 s70, 20480
    s_add_u32 m0, s74, 20480
    s_nop 0
    buffer_load_dwordx4 v41, s[36:39], s70 offen offset:0 sc1 lds
    s_waitcnt lgkmcnt(4)
    v_mfma_f32_32x32x16_bf16 v[224:239], a[176:179], a[32:35], v[224:239]
    ds_read_b64_tr_b16 a[168:169], v62 offset:16384
    ds_read_b64_tr_b16 a[170:171], v62 offset:16896
    ds_read_b64_tr_b16 a[172:173], v63 offset:16384
    ds_read_b64_tr_b16 a[174:175], v63 offset:16896
    v_mfma_f32_32x32x16_bf16 v[240:255], a[180:183], a[32:35], v[240:255]
    buffer_load_dwordx4 v41, s[36:39], s70 offen offset:1024 sc1 lds
    v_mfma_f32_16x16x32_bf16 v[216:219], v[20:23], a[176:179], v[216:219]
    v_mfma_f32_16x16x32_bf16 v[220:223], v[20:23], a[180:183], v[220:223]
    s_waitcnt lgkmcnt(4)
    v_mfma_f32_32x32x16_bf16 v[224:239], a[160:163], a[36:39], v[224:239]
    ds_read_b64_tr_b16 a[176:177], v64 offset:16384
    ds_read_b64_tr_b16 a[178:179], v64 offset:16896
    ds_read_b64_tr_b16 a[180:181], v65 offset:16384
    ds_read_b64_tr_b16 a[182:183], v65 offset:16896
    buffer_load_dwordx4 v41, s[36:39], s70 offen offset:2048 sc1 lds
    v_mfma_f32_32x32x16_bf16 v[240:255], a[164:167], a[36:39], v[240:255]
    s_waitcnt lgkmcnt(4)
    v_mfma_f32_32x32x16_bf16 v[224:239], a[168:171], a[40:43], v[224:239]
    ds_read_b64_tr_b16 a[160:161], v58 offset:24576
    ds_read_b64_tr_b16 a[162:163], v58 offset:25088
    ds_read_b64_tr_b16 a[164:165], v59 offset:24576
    ds_read_b64_tr_b16 a[166:167], v59 offset:25088
    buffer_load_dwordx4 v41, s[36:39], s70 offen offset:3072 sc1 lds
    v_mfma_f32_32x32x16_bf16 v[240:255], a[172:175], a[40:43], v[240:255]
    s_waitcnt lgkmcnt(4)
    v_mfma_f32_32x32x16_bf16 v[224:239], a[176:179], a[44:47], v[224:239]
    ds_read_b64_tr_b16 a[168:169], v60 offset:24576
    ds_read_b64_tr_b16 a[170:171], v60 offset:25088
    ds_read_b64_tr_b16 a[172:173], v61 offset:24576
    ds_read_b64_tr_b16 a[174:175], v61 offset:25088
    s_mov_b32 s70, 24576
    s_add_u32 m0, s74, 24576
    v_mfma_f32_32x32x16_bf16 v[240:255], a[180:183], a[44:47], v[240:255]
    buffer_load_dwordx4 v41, s[36:39], s70 offen sc1 lds
    s_waitcnt lgkmcnt(4)
    v_mfma_f32_32x32x16_bf16 v[224:239], a[160:163], a[48:51], v[224:239]
    ds_read_b64_tr_b16 a[176:177], v62 offset:24576
    ds_read_b64_tr_b16 a[178:179], v62 offset:25088
    ds_read_b64_tr_b16 a[180:181], v63 offset:24576
    ds_read_b64_tr_b16 a[182:183], v63 offset:25088
    v_mfma_f32_32x32x16_bf16 v[240:255], a[164:167], a[48:51], v[240:255]
    v_mfma_f32_16x16x32_bf16 v[216:219], v[20:23], a[160:163], v[216:219]
    v_mfma_f32_16x16x32_bf16 v[220:223], v[20:23], a[164:167], v[220:223]
    s_waitcnt lgkmcnt(4)
    v_mfma_f32_32x32x16_bf16 v[224:239], a[168:171], a[52:55], v[224:239]
    ds_read_b64_tr_b16 a[160:161], v64 offset:24576
    ds_read_b64_tr_b16 a[162:163], v64 offset:25088
    ds_read_b64_tr_b16 a[164:165], v65 offset:24576
    ds_read_b64_tr_b16 a[166:167], v65 offset:25088
    v_mfma_f32_32x32x16_bf16 v[240:255], a[172:175], a[52:55], v[240:255]
    s_waitcnt lgkmcnt(4)
    v_mfma_f32_32x32x16_bf16 v[224:239], a[176:179], a[56:59], v[224:239]
    ds_read_b64_tr_b16 a[168:169], v58 offset:36864
    ds_read_b64_tr_b16 a[170:171], v58 offset:37376
    ds_read_b64_tr_b16 a[172:173], v59 offset:36864
    ds_read_b64_tr_b16 a[174:175], v59 offset:37376
    v_mfma_f32_32x32x16_bf16 v[240:255], a[180:183], a[56:59], v[240:255]
    s_waitcnt lgkmcnt(4)
    v_mfma_f32_32x32x16_bf16 v[224:239], a[160:163], a[60:63], v[224:239]
    ds_read_b64_tr_b16 a[176:177], v60 offset:36864
    ds_read_b64_tr_b16 a[178:179], v60 offset:37376
    ds_read_b64_tr_b16 a[180:181], v61 offset:36864
    ds_read_b64_tr_b16 a[182:183], v61 offset:37376
    v_mfma_f32_32x32x16_bf16 v[240:255], a[164:167], a[60:63], v[240:255]
    s_waitcnt lgkmcnt(4)
    v_mfma_f32_32x32x16_bf16 v[224:239], a[168:171], a[64:67], v[224:239]
    ds_read_b64_tr_b16 a[160:161], v62 offset:36864
    ds_read_b64_tr_b16 a[162:163], v62 offset:37376
    ds_read_b64_tr_b16 a[164:165], v63 offset:36864
    ds_read_b64_tr_b16 a[166:167], v63 offset:37376
    v_mfma_f32_32x32x16_bf16 v[240:255], a[172:175], a[64:67], v[240:255]
    v_mfma_f32_16x16x32_bf16 v[216:219], v[20:23], a[168:171], v[216:219]
    v_mfma_f32_16x16x32_bf16 v[220:223], v[20:23], a[172:175], v[220:223]
    s_waitcnt lgkmcnt(4)
    v_mfma_f32_32x32x16_bf16 v[224:239], a[176:179], a[68:71], v[224:239]
    ds_read_b64_tr_b16 a[168:169], v64 offset:36864
    ds_read_b64_tr_b16 a[170:171], v64 offset:37376
    ds_read_b64_tr_b16 a[172:173], v65 offset:36864
    ds_read_b64_tr_b16 a[174:175], v65 offset:37376
    v_mfma_f32_32x32x16_bf16 v[240:255], a[180:183], a[68:71], v[240:255]
    s_barrier
    s_waitcnt lgkmcnt(4)
    v_mfma_f32_32x32x16_bf16 v[224:239], a[160:163], a[72:75], v[224:239]
    ds_read_b64_tr_b16 a[176:177], v58 offset:45056
    ds_read_b64_tr_b16 a[178:179], v58 offset:45568
    ds_read_b64_tr_b16 a[180:181], v59 offset:45056
    ds_read_b64_tr_b16 a[182:183], v59 offset:45568
    s_mov_b32 s70, 40960
    s_add_u32 m0, s74, 81920
    v_mfma_f32_32x32x16_bf16 v[240:255], a[164:167], a[72:75], v[240:255]
    buffer_load_dwordx4 v41, s[36:39], s70 offen offset:0 sc1 lds
    s_waitcnt lgkmcnt(4)
    v_mfma_f32_32x32x16_bf16 v[224:239], a[168:171], a[76:79], v[224:239]
    ds_read_b64_tr_b16 a[160:161], v60 offset:45056
    ds_read_b64_tr_b16 a[162:163], v60 offset:45568
    ds_read_b64_tr_b16 a[164:165], v61 offset:45056
    ds_read_b64_tr_b16 a[166:167], v61 offset:45568
    buffer_load_dwordx4 v41, s[36:39], s70 offen offset:1024 sc1 lds
    v_mfma_f32_32x32x16_bf16 v[240:255], a[172:175], a[76:79], v[240:255]
    buffer_load_dwordx4 v41, s[36:39], s70 offen offset:2048 sc1 lds
    s_waitcnt lgkmcnt(4)
    v_mfma_f32_32x32x16_bf16 v[224:239], a[176:179], a[80:83], v[224:239]
    ds_read_b64_tr_b16 a[168:169], v62 offset:45056
    ds_read_b64_tr_b16 a[170:171], v62 offset:45568
    ds_read_b64_tr_b16 a[172:173], v63 offset:45056
    ds_read_b64_tr_b16 a[174:175], v63 offset:45568
    s_mov_b32 s80, 0
    s_waitcnt vmcnt(15)
    v_cmp_ne_u32 vcc, v50, v16
    s_nop 0
    s_cbranch_vccz L_ok_fw2A
L_retry_fw2A:
    s_sleep 1
    buffer_load_dword v50, v51, s[36:39], 0 offen offset:48 sc1
    s_waitcnt vmcnt(0)
    v_cmp_ne_u32 vcc, v50, v16
    s_add_u32 s80, s80, 1
    s_cmp_lt_u32 s80, 100000
    s_cselect_b64 s[82:83], vcc, 0
    s_cmp_lg_u64 s[82:83], 0
    s_cbranch_scc1 L_retry_fw2A
    s_nop 4
L_ok_fw2A:
    v_mfma_f32_32x32x16_bf16 v[240:255], a[180:183], a[80:83], v[240:255]
    buffer_load_dwordx4 v41, s[36:39], s70 offen offset:3072 sc1 lds
    v_mfma_f32_16x16x32_bf16 v[216:219], v[20:23], a[176:179], v[216:219]
    v_mfma_f32_16x16x32_bf16 v[220:223], v[20:23], a[180:183], v[220:223]
    s_waitcnt lgkmcnt(4)
    v_mfma_f32_32x32x16_bf16 v[224:239], a[160:163], a[84:87], v[224:239]
    ds_read_b64_tr_b16 a[176:177], v64 offset:45056
    ds_read_b64_tr_b16 a[178:179], v64 offset:45568
    ds_read_b64_tr_b16 a[180:181], v65 offset:45056
    ds_read_b64_tr_b16 a[182:183], v65 offset:45568
    s_mov_b32 s70, 45056
    s_add_u32 m0, s74, 86016
    v_mfma_f32_32x32x16_bf16 v[240:255], a[164:167], a[84:87], v[240:255]
    buffer_load_dwordx4 v41, s[36:39], s70 offen sc1 lds
    s_waitcnt lgkmcnt(4)
    v_mfma_f32_32x32x16_bf16 v[224:239], a[168:171], a[88:91], v[224:239]
    ds_read_b64_tr_b16 a[160:161], v58 offset:53248
    ds_read_b64_tr_b16 a[162:163], v58 offset:53760
    ds_read_b64_tr_b16 a[164:165], v59 offset:53248
    ds_read_b64_tr_b16 a[166:167], v59 offset:53760
    v_mfma_f32_32x32x16_bf16 v[240:255], a[172:175], a[88:91], v[240:255]
    s_waitcnt lgkmcnt(4)
    v_mfma_f32_32x32x16_bf16 v[224:239], a[176:179], a[92:95], v[224:239]
    ds_read_b64_tr_b16 a[168:169], v60 offset:53248
    ds_read_b64_tr_b16 a[170:171], v60 offset:53760
    ds_read_b64_tr_b16 a[172:173], v61 offset:53248
    ds_read_b64_tr_b16 a[174:175], v61 offset:53760
    v_mfma_f32_32x32x16_bf16 v[240:255], a[180:183], a[92:95], v[240:255]
    s_waitcnt lgkmcnt(4)
    v_mfma_f32_32x32x16_bf16 v[224:239], a[160:163], a[96:99], v[224:239]
    ds_read_b64_tr_b16 a[176:177], v62 offset:53248
    ds_read_b64_tr_b16 a[178:179], v62 offset:53760
    ds_read_b64_tr_b16 a[180:181], v63 offset:53248
    ds_read_b64_tr_b16 a[182:183], v63 offset:53760
    v_mfma_f32_32x32x16_bf16 v[240:255], a[164:167], a[96:99], v[240:255]
    v_mfma_f32_16x16x32_bf16 v[216:219], v[20:23], a[160:163], v[216:219]
    v_mfma_f32_16x16x32_bf16 v[220:223], v[20:23], a[164:167], v[220:223]
    s_waitcnt lgkmcnt(4)
    v_mfma_f32_32x32x16_bf16 v[224:239], a[168:171], a[100:103], v[224:239]
    ds_read_b64_tr_b16 a[160:161], v64 offset:53248
    ds_read_b64_tr_b16 a[162:163], v64 offset:53760
    ds_read_b64_tr_b16 a[164:165], v65 offset:53248
    ds_read_b64_tr_b16 a[166:167], v65 offset:53760
    v_mfma_f32_32x32x16_bf16 v[240:255], a[172:175], a[100:103], v[240:255]
    s_waitcnt lgkmcnt(4)
    v_mfma_f32_32x32x16_bf16 v[224:239], a[176:179], a[104:107], v[224:239]
    ds_read_b64_tr_b16 a[168:169], v58 offset:61440
    ds_read_b64_tr_b16 a[170:171], v58 offset:61952
    ds_read_b64_tr_b16 a[172:173], v59 offset:61440
    ds_read_b64_tr_b16 a[174:175], v59 offset:61952
    v_subrev_u32 v58, 24576, v58
    v_subrev_u32 v59, 24576, v59
    v_mfma_f32_32x32x16_bf16 v[240:255], a[180:183], a[104:107], v[240:255]
    s_waitcnt lgkmcnt(4)
    v_mfma_f32_32x32x16_bf16 v[224:239], a[160:163], a[108:111], v[224:239]
    ds_read_b64_tr_b16 a[176:177], v60 offset:61440
    ds_read_b64_tr_b16 a[178:179], v60 offset:61952
    ds_read_b64_tr_b16 a[180:181], v61 offset:61440
    ds_read_b64_tr_b16 a[182:183], v61 offset:61952
    v_subrev_u32 v60, 24576, v60
    v_subrev_u32 v61, 24576, v61
    v_mfma_f32_32x32x16_bf16 v[240:255], a[164:167], a[108:111], v[240:255]
    s_waitcnt lgkmcnt(4)
    v_mfma_f32_32x32x16_bf16 v[224:239], a[168:171], a[112:115], v[224:239]
    ds_read_b64_tr_b16 a[160:161], v62 offset:61440
    ds_read_b64_tr_b16 a[162:163], v62 offset:61952
    ds_read_b64_tr_b16 a[164:165], v63 offset:61440
    ds_read_b64_tr_b16 a[166:167], v63 offset:61952
    v_subrev_u32 v62, 24576, v62
    v_subrev_u32 v63, 24576, v63
    v_mfma_f32_32x32x16_bf16 v[240:255], a[172:175], a[112:115], v[240:255]
    buffer_load_dword v50, v52, s[36:39], 0 offen offset:0 sc1
    v_mfma_f32_16x16x32_bf16 v[216:219], v[20:23], a[168:171], v[216:219]
    v_mfma_f32_16x16x32_bf16 v[220:223], v[20:23], a[172:175], v[220:223]
    s_waitcnt lgkmcnt(4)
    v_mfma_f32_32x32x16_bf16 v[224:239], a[176:179], a[116:119], v[224:239]
    ds_read_b64_tr_b16 a[168:169], v64 offset:61440
    ds_read_b64_tr_b16 a[170:171], v64 offset:61952
    ds_read_b64_tr_b16 a[172:173], v65 offset:61440
    ds_read_b64_tr_b16 a[174:175], v65 offset:61952
    v_subrev_u32 v64, 24576, v64
    v_subrev_u32 v65, 24576, v65
    v_mfma_f32_32x32x16_bf16 v[240:255], a[180:183], a[116:119], v[240:255]
    s_waitcnt vmcnt(16)
    s_barrier
    s_waitcnt lgkmcnt(4)
    v_mfma_f32_32x32x16_bf16 v[224:239], a[160:163], a[120:123], v[224:239]
    ds_read_b64_tr_b16 a[176:177], v58 offset:0
    ds_read_b64_tr_b16 a[178:179], v58 offset:512
    ds_read_b64_tr_b16 a[180:181], v59 offset:0
    ds_read_b64_tr_b16 a[182:183], v59 offset:512
    s_mov_b32 s70, 61440
    s_add_u32 m0, s74, 102400
    v_mfma_f32_32x32x16_bf16 v[240:255], a[164:167], a[120:123], v[240:255]
    buffer_load_dwordx4 v41, s[36:39], s70 offen offset:0 sc1 lds
    s_waitcnt lgkmcnt(4)
    v_mfma_f32_32x32x16_bf16 v[224:239], a[168:171], a[124:127], v[224:239]
    ds_read_b64_tr_b16 a[160:161], v60 offset:0
    ds_read_b64_tr_b16 a[162:163], v60 offset:512
    ds_read_b64_tr_b16 a[164:165], v61 offset:0
    ds_read_b64_tr_b16 a[166:167], v61 offset:512
    buffer_load_dwordx4 v41, s[36:39], s70 offen offset:1024 sc1 lds
    v_mfma_f32_32x32x16_bf16 v[240:255], a[172:175], a[124:127], v[240:255]
    buffer_load_dwordx4 v41, s[36:39], s70 offen offset:2048 sc1 lds
    s_waitcnt lgkmcnt(4)
    v_mfma_f32_32x32x16_bf16 v[224:239], a[176:179], a[128:131], v[224:239]
    ds_read_b64_tr_b16 a[168:169], v62 offset:0
    ds_read_b64_tr_b16 a[170:171], v62 offset:512
    ds_read_b64_tr_b16 a[172:173], v63 offset:0
    ds_read_b64_tr_b16 a[174:175], v63 offset:512
    v_mfma_f32_32x32x16_bf16 v[240:255], a[180:183], a[128:131], v[240:255]
    buffer_load_dwordx4 v41, s[36:39], s70 offen offset:3072 sc1 lds
    v_mfma_f32_16x16x32_bf16 v[216:219], v[20:23], a[176:179], v[216:219]
    v_mfma_f32_16x16x32_bf16 v[220:223], v[20:23], a[180:183], v[220:223]
    s_waitcnt lgkmcnt(4)
    v_mfma_f32_32x32x16_bf16 v[224:239], a[160:163], a[132:135], v[224:239]
    ds_read_b64_tr_b16 a[176:177], v64 offset:0
    ds_read_b64_tr_b16 a[178:179], v64 offset:512
    ds_read_b64_tr_b16 a[180:181], v65 offset:0
    ds_read_b64_tr_b16 a[182:183], v65 offset:512
    s_mov_b32 s70, 65536
    s_add_u32 m0, s74, 106496
    v_mfma_f32_32x32x16_bf16 v[240:255], a[164:167], a[132:135], v[240:255]
    buffer_load_dwordx4 v41, s[36:39], s70 offen sc1 lds
    s_waitcnt lgkmcnt(4)
    v_mfma_f32_32x32x16_bf16 v[224:239], a[168:171], a[136:139], v[224:239]
    ds_read_b64_tr_b16 a[160:161], v58 offset:8192
    ds_read_b64_tr_b16 a[162:163], v58 offset:8704
    ds_read_b64_tr_b16 a[164:165], v59 offset:8192
    ds_read_b64_tr_b16 a[166:167], v59 offset:8704
    v_mfma_f32_32x32x16_bf16 v[240:255], a[172:175], a[136:139], v[240:255]
    s_waitcnt lgkmcnt(4)
    v_mfma_f32_32x32x16_bf16 v[224:239], a[176:179], a[140:143], v[224:239]
    ds_read_b64_tr_b16 a[168:169], v60 offset:8192
    ds_read_b64_tr_b16 a[170:171], v60 offset:8704
    ds_read_b64_tr_b16 a[172:173], v61 offset:8192
    ds_read_b64_tr_b16 a[174:175], v61 offset:8704
    s_mov_b32 s80, 0
    s_waitcnt vmcnt(5)
    v_cmp_ne_u32 vcc, v50, v16
    s_nop 0
    s_cbranch_vccz L_ok_fbA
L_retry_fbA:
    s_sleep 1
    buffer_load_dword v50, v52, s[36:39], 0 offen offset:0 sc1
    s_waitcnt vmcnt(0)
    v_cmp_ne_u32 vcc, v50, v16
    s_add_u32 s80, s80, 1
    s_cmp_lt_u32 s80, 100000
    s_cselect_b64 s[82:83], vcc, 0
    s_cmp_lg_u64 s[82:83], 0
    s_cbranch_scc1 L_retry_fbA
    s_nop 4
L_ok_fbA:
    v_mfma_f32_32x32x16_bf16 v[240:255], a[180:183], a[140:143], v[240:255]
    v_lshlrev_b32_e64 v26, 2, v15
    v_add_u32 v26, 159744, v26
    s_mul_i32 s63, s56, 256
    v_add_u32 v27, s63, v26
    s_waitcnt lgkmcnt(4)
    v_mfma_f32_16x16x32_bf16 v[216:219], v[20:23], a[160:163], v[216:219]
    ds_read_b64_tr_b16 a[176:177], v62 offset:8192
    ds_read_b64_tr_b16 a[178:179], v62 offset:8704
    v_mfma_f32_16x16x32_bf16 v[220:223], v[20:23], a[164:167], v[220:223]
    ds_read_b64_tr_b16 a[180:181], v63 offset:8192
    ds_read_b64_tr_b16 a[182:183], v63 offset:8704
    v_mfma_f32_32x32x16_bf16 v[224:239], a[160:163], a[144:147], v[224:239]
    s_mov_b32 s69, 4096
    buffer_load_dwordx4 a[192:195], v42, s[36:39], s69 offen offset:0 sc1
    v_mfma_f32_32x32x16_bf16 v[240:255], a[164:167], a[144:147], v[240:255]
    buffer_load_dwordx4 a[196:199], v42, s[36:39], s69 offen offset:1024 sc1
    s_waitcnt lgkmcnt(4)
    v_mfma_f32_32x32x16_bf16 v[224:239], a[168:171], a[148:151], v[224:239]
    ds_read_b64_tr_b16 a[160:161], v64 offset:8192
    ds_read_b64_tr_b16 a[162:163], v64 offset:8704
    ds_read_b64_tr_b16 a[164:165], v65 offset:8192
    ds_read_b64_tr_b16 a[166:167], v65 offset:8704
    ds_write_b32 v27, v216 offset:0
    ds_write_b32 v27, v220 offset:128
    v_mfma_f32_32x32x16_bf16 v[240:255], a[172:175], a[148:151], v[240:255]
    buffer_load_dwordx4 a[200:203], v42, s[36:39], s69 offen offset:2048 sc1
    s_waitcnt lgkmcnt(0)
    s_barrier
    v_mfma_f32_32x32x16_bf16 v[224:239], a[176:179], a[152:155], v[224:239]
    ds_read_b32 v216, v26 offset:0
    ds_read_b32 v217, v26 offset:256
    ds_read_b32 v218, v26 offset:512
    ds_read_b32 v219, v26 offset:768
    ds_read_b32 v220, v26 offset:128
    ds_read_b32 v221, v26 offset:384
    v_mfma_f32_32x32x16_bf16 v[240:255], a[180:183], a[152:155], v[240:255]
    ds_read_b32 v222, v26 offset:640
    ds_read_b32 v223, v26 offset:896
    buffer_load_dwordx4 a[204:207], v42, s[36:39], s69 offen offset:3072 sc1
    v_mfma_f32_32x32x16_bf16 v[224:239], a[160:163], a[156:159], v[224:239]
    s_waitcnt lgkmcnt(6)
    v_add_f32 v216, v216, v217
    s_waitcnt lgkmcnt(2)
    v_add_f32 v220, v220, v221
    v_add_f32 v218, v218, v219
    s_waitcnt lgkmcnt(0)
    v_add_f32 v222, v222, v223
    v_add_f32 v218, v216, v218
    v_add_f32 v222, v220, v222
    v_cvt_pk_bf16_f32 v217, v218, 0
    v_cvt_pk_bf16_f32 v221, v222, 0
    v_lshlrev_b32_e64 v219, 16, v217
    v_mfma_f32_32x32x16_bf16 v[240:255], a[164:167], a[156:159], v[240:255]
    v_lshlrev_b32 v223, 16, v221
    v_sub_f32 v219, v218, v219
    v_sub_f32_e64 v223, v222, v223
    v_cvt_pk_bf16_f32 v216, v218, v219
    v_cvt_pk_bf16_f32 v220, v222, v223
    v_mov_b32 v218, 0
    v_mov_b32 v222, 0
    v_mov_b32 v219, 0
    v_mov_b32 v223, 0
    s_nop 0
    v_mfma_f32_32x32x16_bf16 v[224:239], v[216:219], v[76:79], v[224:239]
    v_mfma_f32_32x32x16_bf16 v[240:255], v[220:223], v[76:79], v[240:255]
    v_mov_b32 v26, v67
    s_mov_b32 s69, 8192
    buffer_load_dwordx4 a[208:211], v42, s[36:39], s69 offen offset:0 sc1
    s_nop 7
    v_pk_mul_f32 v[216:217], v[224:225], v[72:73] neg_lo:[0,1] neg_hi:[0,1]
    v_pk_mul_f32 v[218:219], v[226:227], v[72:73] neg_lo:[0,1] neg_hi:[0,1]
    v_pk_mul_f32 v[220:221], v[228:229], v[72:73] neg_lo:[0,1] neg_hi:[0,1]
    v_pk_mul_f32 v[222:223], v[230:231], v[72:73] neg_lo:[0,1] neg_hi:[0,1]
    v_exp_f32 v216, v216
    v_exp_f32 v217, v217
    v_exp_f32 v218, v218
    v_exp_f32_e64 v219, v219
    buffer_load_dwordx4 a[212:215], v42, s[36:39], s69 offen offset:1024 sc1
    v_exp_f32 v220, v220
    v_exp_f32 v221, v221
    v_exp_f32 v222, v222
    v_exp_f32 v223, v223
    v_pk_fma_f32 v[216:217], v[216:217], v[26:27], v[26:27] op_sel_hi:[1,0,0]
    v_pk_fma_f32 v[218:219], v[218:219], v[26:27], v[26:27] op_sel_hi:[1,0,0]
    v_pk_fma_f32 v[220:221], v[220:221], v[26:27], v[26:27] op_sel_hi:[1,0,0]
    v_pk_fma_f32 v[222:223], v[222:223], v[26:27], v[26:27] op_sel_hi:[1,0,0]
    buffer_load_dwordx4 a[216:219], v42, s[36:39], s69 offen offset:2048 sc1
    v_rcp_f32 v216, v216
    v_rcp_f32 v217, v217
    v_rcp_f32 v218, v218
    v_rcp_f32 v219, v219
    v_rcp_f32 v220, v220
    v_rcp_f32 v221, v221
    v_rcp_f32_e64 v222, v222
    buffer_load_dwordx4 a[220:223], v42, s[36:39], s69 offen offset:3072 sc1
    v_rcp_f32_e64 v223, v223
    v_pk_mul_f32 v[224:225], v[224:225], v[216:217]
    v_pk_mul_f32 v[226:227], v[226:227], v[218:219]
    v_pk_mul_f32 v[228:229], v[228:229], v[220:221]
    v_pk_mul_f32 v[230:231], v[230:231], v[222:223]
    v_cvt_pk_bf16_f32 v224, v224, v225
    v_cvt_pk_bf16_f32 v225, v226, v227
    v_cvt_pk_bf16_f32 v226, v228, v229
    v_cvt_pk_bf16_f32 v227, v230, v231
    buffer_store_dwordx4 v[224:227], v19, s[36:39], 0 offen offset:0 sc1
    v_pk_mul_f32 v[216:217], v[232:233], v[72:73] neg_lo:[0,1] neg_hi:[0,1]
    v_pk_mul_f32 v[218:219], v[234:235], v[72:73] neg_lo:[0,1] neg_hi:[0,1]
    v_pk_mul_f32 v[220:221], v[236:237], v[72:73] neg_lo:[0,1] neg_hi:[0,1]
    v_pk_mul_f32 v[222:223], v[238:239], v[72:73] neg_lo:[0,1] neg_hi:[0,1]
    v_exp_f32 v216, v216
    v_exp_f32 v217, v217
    v_exp_f32 v218, v218
    v_exp_f32 v219, v219
    s_mov_b32 s69, 16384
    buffer_load_dwordx4 a[224:227], v42, s[36:39], s69 offen offset:0 sc1
    v_exp_f32 v220, v220
    v_exp_f32 v221, v221
    v_exp_f32 v222, v222
    v_exp_f32 v223, v223
    v_pk_fma_f32 v[216:217], v[216:217], v[26:27], v[26:27] op_sel_hi:[1,0,0]
    v_pk_fma_f32 v[218:219], v[218:219], v[26:27], v[26:27] op_sel_hi:[1,0,0]
    v_pk_fma_f32 v[220:221], v[220:221], v[26:27], v[26:27] op_sel_hi:[1,0,0]
    v_pk_fma_f32 v[222:223], v[222:223], v[26:27], v[26:27] op_sel_hi:[1,0,0]
    buffer_load_dwordx4 a[228:231], v42, s[36:39], s69 offen offset:1024 sc1
    v_rcp_f32 v216, v216
    v_rcp_f32 v217, v217
    v_rcp_f32 v218, v218
    v_rcp_f32 v219, v219
    v_rcp_f32 v220, v220
    v_rcp_f32 v221, v221
    v_rcp_f32_e64 v222, v222
    buffer_load_dwordx4 a[232:235], v42, s[36:39], s69 offen offset:2048 sc1
    v_rcp_f32_e64 v223, v223
    v_pk_mul_f32 v[232:233], v[232:233], v[216:217]
    v_pk_mul_f32 v[234:235], v[234:235], v[218:219]
    v_pk_mul_f32 v[236:237], v[236:237], v[220:221]
    v_pk_mul_f32 v[238:239], v[238:239], v[222:223]
    v_cvt_pk_bf16_f32 v232, v232, v233
    v_cvt_pk_bf16_f32 v233, v234, v235
    v_cvt_pk_bf16_f32 v234, v236, v237
    v_cvt_pk_bf16_f32 v235, v238, v239
    buffer_store_dwordx4 v[232:235], v19, s[36:39], 0 offen offset:512 sc1
    s_barrier
    ds_read_b128 v[156:159], v48 offset:0
    ds_read_b128 v[160:163], v48 offset:1024
    ds_read_b128 v[164:167], v48 offset:2048
    ds_read_b128 v[168:171], v48 offset:3072
    ds_read_b128 v[172:175], v48 offset:4096
    ds_read_b128 v[176:179], v48 offset:5120
    ds_read_b128 v[180:183], v48 offset:6144
    ds_read_b128 v[184:187], v48 offset:7168
    ds_read_b128 v[188:191], v48 offset:8192
    ds_read_b128 v[192:195], v48 offset:9216
    s_waitcnt lgkmcnt(5)
    s_waitcnt vmcnt(12)
    v_mfma_f32_16x16x32_bf16 v[136:139], v[156:159], a[192:195], 0
    ds_read_b128 v[196:199], v48 offset:10240
    v_pk_mul_f32 v[216:217], v[240:241], v[72:73] neg_lo:[0,1] neg_hi:[0,1]
    v_pk_mul_f32 v[218:219], v[242:243], v[72:73] neg_lo:[0,1] neg_hi:[0,1]
    v_pk_mul_f32 v[220:221], v[244:245], v[72:73] neg_lo:[0,1] neg_hi:[0,1]
    v_mfma_f32_16x16x32_bf16 v[140:143], v[160:163], a[192:195], 0
    ds_read_b128 v[200:203], v48 offset:11264
    v_pk_mul_f32 v[222:223], v[246:247], v[72:73] neg_lo:[0,1] neg_hi:[0,1]
    v_exp_f32 v216, v216
    v_mfma_f32_16x16x32_bf16 v[144:147], v[164:167], a[192:195], 0
    ds_read_b128 v[204:207], v48 offset:12288
    buffer_load_dwordx4 a[236:239], v42, s[36:39], s69 offen offset:3072 sc1
    v_exp_f32_e64 v217, v217
    v_mfma_f32_16x16x32_bf16 v[148:151], v[168:171], a[192:195], 0
    ds_read_b128 v[208:211], v48 offset:13312
    v_exp_f32 v218, v218
    v_exp_f32 v219, v219
    v_mfma_f32_16x16x32_bf16 v[152:155], v[172:175], a[192:195], 0
    ds_read_b128 v[212:215], v48 offset:14336
    s_mov_b32 s69, 20480
    buffer_load_dwordx4 a[240:243], v42, s[36:39], s69 offen offset:0 sc1
    s_waitcnt lgkmcnt(5)
    s_waitcnt vmcnt(13)
    v_mfma_f32_16x16x32_bf16 v[136:139], v[176:179], a[196:199], v[136:139]
    ds_read_b128 v[156:159], v48 offset:15360
    v_exp_f32 v220, v220
    v_exp_f32 v221, v221
    v_mfma_f32_16x16x32_bf16 v[140:143], v[180:183], a[196:199], v[140:143]
    ds_read_b128 v[160:163], v48 offset:16384
    buffer_load_dwordx4 a[244:247], v42, s[36:39], s69 offen offset:1024 sc1
    v_exp_f32_e64 v222, v222
    v_mfma_f32_16x16x32_bf16 v[144:147], v[184:187], a[196:199], v[144:147]
    ds_read_b128 v[164:167], v48 offset:17408
    v_exp_f32_e64 v223, v223
    v_pk_fma_f32 v[216:217], v[216:217], v[26:27], v[26:27] op_sel_hi:[1,0,0]
    v_mfma_f32_16x16x32_bf16 v[148:151], v[188:191], a[196:199], v[148:151]
    ds_read_b128 v[168:171], v48 offset:18432
    buffer_load_dwordx4 a[248:251], v42, s[36:39], s69 offen offset:2048 sc1
    v_pk_fma_f32 v[218:219], v[218:219], v[26:27], v[26:27] op_sel_hi:[1,0,0]
    v_pk_fma_f32 v[220:221], v[220:221], v[26:27], v[26:27] op_sel_hi:[1,0,0]
    v_pk_fma_f32 v[222:223], v[222:223], v[26:27], v[26:27] op_sel_hi:[1,0,0]
    v_mfma_f32_16x16x32_bf16 v[152:155], v[192:195], a[196:199], v[152:155]
    ds_read_b128 v[172:175], v48 offset:19456
    v_rcp_f32 v216, v216
    s_barrier
    s_waitcnt lgkmcnt(5)
    s_waitcnt vmcnt(14)
    v_mfma_f32_16x16x32_bf16 v[136:139], v[196:199], a[200:203], v[136:139]
    ds_read_b128 v[176:179], v48 offset:20480
    v_rcp_f32 v217, v217
    v_rcp_f32 v218, v218
    v_mfma_f32_16x16x32_bf16 v[140:143], v[200:203], a[200:203], v[140:143]
    ds_read_b128 v[180:183], v48 offset:21504
    buffer_load_dwordx4 a[252:255], v42, s[36:39], s69 offen offset:3072 sc1
    v_rcp_f32_e64 v219, v219
    v_mfma_f32_16x16x32_bf16 v[144:147], v[204:207], a[200:203], v[144:147]
    ds_read_b128 v[184:187], v48 offset:22528
    v_rcp_f32 v220, v220
    v_rcp_f32 v221, v221
    v_mfma_f32_16x16x32_bf16 v[148:151], v[208:211], a[200:203], v[148:151]
    ds_read_b128 v[188:191], v48 offset:23552
    s_mov_b32 s70, 81920
    s_add_u32 m0, s74, 122880
    s_nop 0
    buffer_load_dwordx4 v41, s[36:39], s70 offen offset:0 sc1 lds
    v_mfma_f32_16x16x32_bf16 v[152:155], v[212:215], a[200:203], v[152:155]
    ds_read_b128 v[192:195], v48 offset:24576
    v_rcp_f32 v222, v222
    s_waitcnt lgkmcnt(5)
    s_waitcnt vmcnt(15)
    v_mfma_f32_16x16x32_bf16 v[136:139], v[156:159], a[204:207], v[136:139]
    ds_read_b128 v[196:199], v48 offset:25600
    buffer_load_dwordx4 v41, s[36:39], s70 offen offset:1024 sc1 lds
    v_rcp_f32_e64 v223, v223
    v_pk_mul_f32 v[240:241], v[240:241], v[216:217]
    v_mfma_f32_16x16x32_bf16 v[140:143], v[160:163], a[204:207], v[140:143]
    ds_read_b128 v[200:203], v48 offset:26624
    v_pk_mul_f32 v[242:243], v[242:243], v[218:219]
    v_pk_mul_f32 v[244:245], v[244:245], v[220:221]
    v_pk_mul_f32 v[246:247], v[246:247], v[222:223]
    v_mfma_f32_16x16x32_bf16 v[144:147], v[164:167], a[204:207], v[144:147]
    ds_read_b128 v[204:207], v48 offset:27648
    buffer_load_dwordx4 v41, s[36:39], s70 offen offset:2048 sc1 lds
    v_cvt_pk_bf16_f32 v240, v240, v241
    v_cvt_pk_bf16_f32 v241, v242, v243
    v_cvt_pk_bf16_f32 v242, v244, v245
    v_mfma_f32_16x16x32_bf16 v[148:151], v[168:171], a[204:207], v[148:151]
    ds_read_b128 v[208:211], v48 offset:28672
    v_cvt_pk_bf16_f32 v243, v246, v247
    buffer_store_dwordx4 v[240:243], v19, s[36:39], 0 offen offset:1024 sc1
    v_pk_mul_f32 v[216:217], v[248:249], v[72:73] neg_lo:[0,1] neg_hi:[0,1]
    v_pk_mul_f32 v[218:219], v[250:251], v[72:73] neg_lo:[0,1] neg_hi:[0,1]
    v_mfma_f32_16x16x32_bf16 v[152:155], v[172:175], a[204:207], v[152:155]
    ds_read_b128 v[212:215], v48 offset:29696
    v_pk_mul_f32 v[220:221], v[252:253], v[72:73] neg_lo:[0,1] neg_hi:[0,1]
    v_pk_mul_f32 v[222:223], v[254:255], v[72:73] neg_lo:[0,1] neg_hi:[0,1]
    s_waitcnt lgkmcnt(5)
    s_waitcnt vmcnt(17)
    v_mfma_f32_16x16x32_bf16 v[136:139], v[176:179], a[208:211], v[136:139]
    ds_read_b128 v[156:159], v48 offset:30720
    buffer_load_dwordx4 v41, s[36:39], s70 offen offset:3072 sc1 lds
    v_exp_f32_e64 v216, v216
    v_mfma_f32_16x16x32_bf16 v[140:143], v[180:183], a[208:211], v[140:143]
    ds_read_b128 v[160:163], v48 offset:31744
    v_exp_f32 v217, v217
    v_exp_f32 v218, v218
    v_mfma_f32_16x16x32_bf16 v[144:147], v[184:187], a[208:211], v[144:147]
    ds_read_b128 v[164:167], v48 offset:32768
    s_mov_b32 s70, 86016
    s_add_u32 m0, s74, 126976
    s_nop 0
    buffer_load_dwordx4 v41, s[36:39], s70 offen sc1 lds
    v_mfma_f32_16x16x32_bf16 v[148:151], v[188:191], a[208:211], v[148:151]
    ds_read_b128 v[168:171], v48 offset:33792
    v_exp_f32 v219, v219
    v_exp_f32_e64 v220, v220
    v_mfma_f32_16x16x32_bf16 v[152:155], v[192:195], a[208:211], v[152:155]
    ds_read_b128 v[172:175], v48 offset:34816
    s_mov_b32 s69, 28672
    buffer_load_dwordx4 a[0:3], v42, s[36:39], s69 offen offset:0 sc1
    s_waitcnt lgkmcnt(5)
    s_waitcnt vmcnt(19)
    v_mfma_f32_16x16x32_bf16 v[136:139], v[196:199], a[212:215], v[136:139]
    ds_read_b128 v[176:179], v48 offset:35840
    v_exp_f32 v221, v221
    v_exp_f32 v222, v222
    v_mfma_f32_16x16x32_bf16 v[140:143], v[200:203], a[212:215], v[140:143]
    ds_read_b128 v[180:183], v48 offset:36864
    buffer_load_dwordx4 a[4:7], v42, s[36:39], s69 offen offset:1024 sc1
    v_exp_f32_e64 v223, v223
    v_pk_fma_f32 v[216:217], v[216:217], v[26:27], v[26:27] op_sel_hi:[1,0,0]
    v_mfma_f32_16x16x32_bf16 v[144:147], v[204:207], a[212:215], v[144:147]
    ds_read_b128 v[184:187], v48 offset:37888
    v_pk_fma_f32 v[218:219], v[218:219], v[26:27], v[26:27] op_sel_hi:[1,0,0]
    v_pk_fma_f32 v[220:221], v[220:221], v[26:27], v[26:27] op_sel_hi:[1,0,0]
    v_pk_fma_f32 v[222:223], v[222:223], v[26:27], v[26:27] op_sel_hi:[1,0,0]
    v_mfma_f32_16x16x32_bf16 v[148:151], v[208:211], a[212:215], v[148:151]
    ds_read_b128 v[188:191], v48 offset:38912
    v_rcp_f32 v216, v216
    v_rcp_f32 v217, v217
    v_mfma_f32_16x16x32_bf16 v[152:155], v[212:215], a[212:215], v[152:155]
    ds_read_b128 v[192:195], v48 offset:39936
    buffer_load_dwordx4 a[8:11], v42, s[36:39], s69 offen offset:2048 sc1
    v_rcp_f32 v218, v218
    s_barrier
    s_waitcnt lgkmcnt(5)
    s_waitcnt vmcnt(20)
    v_mfma_f32_16x16x32_bf16 v[136:139], v[156:159], a[216:219], v[136:139]
    v_add_u32 v48, 81920, v48
    ds_read_b128 v[196:199], v48 offset:0
    v_rcp_f32_e64 v219, v219
    v_mfma_f32_16x16x32_bf16 v[140:143], v[160:163], a[216:219], v[140:143]
    ds_read_b128 v[200:203], v48 offset:1024
    buffer_load_dwordx4 a[12:15], v42, s[36:39], s69 offen offset:3072 sc1
    v_rcp_f32_e64 v220, v220
    v_mfma_f32_16x16x32_bf16 v[144:147], v[164:167], a[216:219], v[144:147]
    ds_read_b128 v[204:207], v48 offset:2048
    v_rcp_f32 v221, v221
    v_rcp_f32 v222, v222
    v_mfma_f32_16x16x32_bf16 v[148:151], v[168:171], a[216:219], v[148:151]
    ds_read_b128 v[208:211], v48 offset:3072
    s_mov_b32 s70, 102400
    s_add_u32 m0, s74, 40960
    s_nop 0
    buffer_load_dwordx4 v41, s[36:39], s70 offen offset:0 sc1 lds
    v_mfma_f32_16x16x32_bf16 v[152:155], v[172:175], a[216:219], v[152:155]
    ds_read_b128 v[212:215], v48 offset:4096
    v_rcp_f32 v223, v223
    v_pk_mul_f32 v[248:249], v[248:249], v[216:217]
    s_waitcnt lgkmcnt(5)
    s_waitcnt vmcnt(21)
    v_mfma_f32_16x16x32_bf16 v[136:139], v[176:179], a[220:223], v[136:139]
    ds_read_b128 v[156:159], v48 offset:5120
    buffer_load_dwordx4 v41, s[36:39], s70 offen offset:1024 sc1 lds
    v_pk_mul_f32 v[250:251], v[250:251], v[218:219]
    v_pk_mul_f32 v[252:253], v[252:253], v[220:221]
    v_pk_mul_f32 v[254:255], v[254:255], v[222:223]
    v_mfma_f32_16x16x32_bf16 v[140:143], v[180:183], a[220:223], v[140:143]
    ds_read_b128 v[160:163], v48 offset:6144
    v_cvt_pk_bf16_f32 v248, v248, v249
    v_cvt_pk_bf16_f32 v249, v250, v251
    v_cvt_pk_bf16_f32 v250, v252, v253
    v_mfma_f32_16x16x32_bf16 v[144:147], v[184:187], a[220:223], v[144:147]
    ds_read_b128 v[164:167], v48 offset:7168
    v_cvt_pk_bf16_f32 v251, v254, v255
    buffer_store_dwordx4 v[248:251], v19, s[36:39], 0 offen offset:1536 sc1
    v_mfma_f32_16x16x32_bf16 v[148:151], v[188:191], a[220:223], v[148:151]
    ds_read_b128 v[168:171], v48 offset:8192
    buffer_load_dwordx4 v41, s[36:39], s70 offen offset:2048 sc1 lds
    v_mfma_f32_16x16x32_bf16 v[152:155], v[192:195], a[220:223], v[152:155]
    ds_read_b128 v[172:175], v48 offset:9216
    s_waitcnt lgkmcnt(5)
    s_waitcnt vmcnt(22)
    v_mfma_f32_16x16x32_bf16 v[136:139], v[196:199], a[224:227], v[136:139]
    ds_read_b128 v[176:179], v48 offset:10240
    buffer_load_dwordx4 v41, s[36:39], s70 offen offset:3072 sc1 lds
    v_mfma_f32_16x16x32_bf16 v[140:143], v[200:203], a[224:227], v[140:143]
    ds_read_b128 v[180:183], v48 offset:11264
    v_mfma_f32_16x16x32_bf16 v[144:147], v[204:207], a[224:227], v[144:147]
    ds_read_b128 v[184:187], v48 offset:12288
    s_mov_b32 s70, 106496
    s_add_u32 m0, s74, 45056
    s_nop 0
    buffer_load_dwordx4 v41, s[36:39], s70 offen sc1 lds
    v_mfma_f32_16x16x32_bf16 v[148:151], v[208:211], a[224:227], v[148:151]
    ds_read_b128 v[188:191], v48 offset:13312
    v_mfma_f32_16x16x32_bf16 v[152:155], v[212:215], a[224:227], v[152:155]
    ds_read_b128 v[192:195], v48 offset:14336
    s_mov_b32 s69, 32768
    buffer_load_dwordx4 a[16:19], v42, s[36:39], s69 offen offset:0 sc1
    s_waitcnt lgkmcnt(5)
    s_waitcnt vmcnt(24)
    v_mfma_f32_16x16x32_bf16 v[136:139], v[156:159], a[228:231], v[136:139]
    ds_read_b128 v[196:199], v48 offset:15360
    v_mfma_f32_16x16x32_bf16 v[140:143], v[160:163], a[228:231], v[140:143]
    ds_read_b128 v[200:203], v48 offset:16384
    v_mfma_f32_16x16x32_bf16 v[144:147], v[164:167], a[228:231], v[144:147]
    ds_read_b128 v[204:207], v48 offset:17408
    buffer_load_dwordx4 a[20:23], v42, s[36:39], s69 offen offset:1024 sc1
    v_mfma_f32_16x16x32_bf16 v[148:151], v[168:171], a[228:231], v[148:151]
    ds_read_b128 v[208:211], v48 offset:18432
    v_mfma_f32_16x16x32_bf16 v[152:155], v[172:175], a[228:231], v[152:155]
    ds_read_b128 v[212:215], v48 offset:19456
    buffer_load_dwordx4 a[24:27], v42, s[36:39], s69 offen offset:2048 sc1
    s_barrier
    s_waitcnt lgkmcnt(5)
    s_waitcnt vmcnt(25)
    v_mfma_f32_16x16x32_bf16 v[136:139], v[176:179], a[232:235], v[136:139]
    ds_read_b128 v[156:159], v48 offset:20480
    v_mfma_f32_16x16x32_bf16 v[140:143], v[180:183], a[232:235], v[140:143]
    ds_read_b128 v[160:163], v48 offset:21504
    buffer_load_dwordx4 a[28:31], v42, s[36:39], s69 offen offset:3072 sc1
    v_mfma_f32_16x16x32_bf16 v[144:147], v[184:187], a[232:235], v[144:147]
    ds_read_b128 v[164:167], v48 offset:22528
    v_mfma_f32_16x16x32_bf16 v[148:151], v[188:191], a[232:235], v[148:151]
    ds_read_b128 v[168:171], v48 offset:23552
    s_mov_b32 s70, 122880
    s_add_u32 m0, s74, 61440
    s_nop 0
    buffer_load_dwordx4 v41, s[36:39], s70 offen offset:0 sc1 lds
    v_mfma_f32_16x16x32_bf16 v[152:155], v[192:195], a[232:235], v[152:155]
    ds_read_b128 v[172:175], v48 offset:24576
    s_waitcnt lgkmcnt(5)
    s_waitcnt vmcnt(25)
    v_mfma_f32_16x16x32_bf16 v[136:139], v[196:199], a[236:239], v[136:139]
    ds_read_b128 v[176:179], v48 offset:25600
    v_mfma_f32_16x16x32_bf16 v[140:143], v[200:203], a[236:239], v[140:143]
    ds_read_b128 v[180:183], v48 offset:26624
    buffer_load_dwordx4 v41, s[36:39], s70 offen offset:1024 sc1 lds
    v_mfma_f32_16x16x32_bf16 v[144:147], v[204:207], a[236:239], v[144:147]
    ds_read_b128 v[184:187], v48 offset:27648
    v_mfma_f32_16x16x32_bf16 v[148:151], v[208:211], a[236:239], v[148:151]
    ds_read_b128 v[188:191], v48 offset:28672
    buffer_load_dwordx4 v41, s[36:39], s70 offen offset:2048 sc1 lds
    v_mfma_f32_16x16x32_bf16 v[152:155], v[212:215], a[236:239], v[152:155]
    ds_read_b128 v[192:195], v48 offset:29696
    s_waitcnt lgkmcnt(5)
    s_waitcnt vmcnt(26)
    v_mfma_f32_16x16x32_bf16 v[136:139], v[156:159], a[240:243], v[136:139]
    ds_read_b128 v[196:199], v48 offset:30720
    buffer_load_dwordx4 v41, s[36:39], s70 offen offset:3072 sc1 lds
    v_mfma_f32_16x16x32_bf16 v[140:143], v[160:163], a[240:243], v[140:143]
    ds_read_b128 v[200:203], v48 offset:31744
    v_mfma_f32_16x16x32_bf16 v[144:147], v[164:167], a[240:243], v[144:147]
    ds_read_b128 v[204:207], v48 offset:32768
    s_mov_b32 s70, 126976
    s_add_u32 m0, s74, 65536
    s_nop 0
    buffer_load_dwordx4 v41, s[36:39], s70 offen sc1 lds
    v_mfma_f32_16x16x32_bf16 v[148:151], v[168:171], a[240:243], v[148:151]
    ds_read_b128 v[208:211], v48 offset:33792
    v_mfma_f32_16x16x32_bf16 v[152:155], v[172:175], a[240:243], v[152:155]
    ds_read_b128 v[212:215], v48 offset:34816
    s_waitcnt lgkmcnt(5)
    s_waitcnt vmcnt(27)
    v_mfma_f32_16x16x32_bf16 v[136:139], v[176:179], a[244:247], v[136:139]
    ds_read_b128 v[156:159], v48 offset:35840
    s_mov_b32 s69, 40960
    buffer_load_dwordx4 a[32:35], v42, s[36:39], s69 offen offset:0 sc1
    v_mfma_f32_16x16x32_bf16 v[140:143], v[180:183], a[244:247], v[140:143]
    ds_read_b128 v[160:163], v48 offset:36864
    v_mfma_f32_16x16x32_bf16 v[144:147], v[184:187], a[244:247], v[144:147]
    ds_read_b128 v[164:167], v48 offset:37888
    buffer_load_dwordx4 a[36:39], v42, s[36:39], s69 offen offset:1024 sc1
    v_mfma_f32_16x16x32_bf16 v[148:151], v[188:191], a[244:247], v[148:151]
    ds_read_b128 v[168:171], v48 offset:38912
    v_mfma_f32_16x16x32_bf16 v[152:155], v[192:195], a[244:247], v[152:155]
    ds_read_b128 v[172:175], v48 offset:39936
    buffer_load_dwordx4 a[40:43], v42, s[36:39], s69 offen offset:2048 sc1
    s_waitcnt vmcnt(15)
    s_barrier
    s_waitcnt lgkmcnt(5)
    v_mfma_f32_16x16x32_bf16 v[136:139], v[196:199], a[248:251], v[136:139]
    ds_read_b128 v[176:179], v48 offset:40960
    buffer_store_dword v16, v24, s[36:39], 0 offen sc1
    v_mfma_f32_16x16x32_bf16 v[140:143], v[200:203], a[248:251], v[140:143]
    ds_read_b128 v[180:183], v48 offset:41984
    buffer_load_dwordx4 a[44:47], v42, s[36:39], s69 offen offset:3072 sc1
    v_mfma_f32_16x16x32_bf16 v[144:147], v[204:207], a[248:251], v[144:147]
    ds_read_b128 v[184:187], v48 offset:43008
    v_mfma_f32_16x16x32_bf16 v[148:151], v[208:211], a[248:251], v[148:151]
    ds_read_b128 v[188:191], v48 offset:44032
    v_mfma_f32_16x16x32_bf16 v[152:155], v[212:215], a[248:251], v[152:155]
    ds_read_b128 v[192:195], v48 offset:45056
    s_mov_b32 s70, 143360
    s_add_u32 m0, s74, 0
    s_nop 0
    buffer_load_dwordx4 v41, s[36:39], s70 offen offset:0 sc1 lds
    s_waitcnt lgkmcnt(5)
    v_mfma_f32_16x16x32_bf16 v[136:139], v[156:159], a[252:255], v[136:139]
    ds_read_b128 v[196:199], v48 offset:46080
    v_mfma_f32_16x16x32_bf16 v[140:143], v[160:163], a[252:255], v[140:143]
    ds_read_b128 v[200:203], v48 offset:47104
    buffer_load_dwordx4 v41, s[36:39], s70 offen offset:1024 sc1 lds
    v_mfma_f32_16x16x32_bf16 v[144:147], v[164:167], a[252:255], v[144:147]
    ds_read_b128 v[204:207], v48 offset:48128
    v_mfma_f32_16x16x32_bf16 v[148:151], v[168:171], a[252:255], v[148:151]
    ds_read_b128 v[208:211], v48 offset:49152
    buffer_load_dwordx4 v41, s[36:39], s70 offen offset:2048 sc1 lds
    v_mfma_f32_16x16x32_bf16 v[152:155], v[172:175], a[252:255], v[152:155]
    ds_read_b128 v[212:215], v48 offset:50176
    s_waitcnt lgkmcnt(5)
    v_mfma_f32_16x16x32_bf16 v[136:139], v[176:179], a[0:3], v[136:139]
    ds_read_b128 v[156:159], v48 offset:51200
    buffer_load_dwordx4 v41, s[36:39], s70 offen offset:3072 sc1 lds
    v_mfma_f32_16x16x32_bf16 v[140:143], v[180:183], a[0:3], v[140:143]
    ds_read_b128 v[160:163], v48 offset:52224
    v_mfma_f32_16x16x32_bf16 v[144:147], v[184:187], a[0:3], v[144:147]
    ds_read_b128 v[164:167], v48 offset:53248
    v_mfma_f32_16x16x32_bf16 v[148:151], v[188:191], a[0:3], v[148:151]
    ds_read_b128 v[168:171], v48 offset:54272
    s_mov_b32 s70, 147456
    s_add_u32 m0, s74, 4096
    s_nop 0
    buffer_load_dwordx4 v41, s[36:39], s70 offen sc1 lds
    v_mfma_f32_16x16x32_bf16 v[152:155], v[192:195], a[0:3], v[152:155]
    ds_read_b128 v[172:175], v48 offset:55296
    s_waitcnt lgkmcnt(5)
    v_mfma_f32_16x16x32_bf16 v[136:139], v[196:199], a[4:7], v[136:139]
    ds_read_b128 v[176:179], v48 offset:56320
    s_mov_b32 s69, 45056
    buffer_load_dwordx4 a[48:51], v42, s[36:39], s69 offen offset:0 sc1
    v_mfma_f32_16x16x32_bf16 v[140:143], v[200:203], a[4:7], v[140:143]
    ds_read_b128 v[180:183], v48 offset:57344
    v_mfma_f32_16x16x32_bf16 v[144:147], v[204:207], a[4:7], v[144:147]
    ds_read_b128 v[184:187], v48 offset:58368
    buffer_load_dwordx4 a[52:55], v42, s[36:39], s69 offen offset:1024 sc1
    v_mfma_f32_16x16x32_bf16 v[148:151], v[208:211], a[4:7], v[148:151]
    ds_read_b128 v[188:191], v48 offset:59392
    v_mfma_f32_16x16x32_bf16 v[152:155], v[212:215], a[4:7], v[152:155]
    ds_read_b128 v[192:195], v48 offset:60416
    buffer_load_dwordx4 a[56:59], v42, s[36:39], s69 offen offset:2048 sc1
    s_waitcnt vmcnt(22)
    s_barrier
    s_waitcnt lgkmcnt(5)
    v_mfma_f32_16x16x32_bf16 v[136:139], v[156:159], a[8:11], v[136:139]
    v_subrev_u32 v48, 40960, v48
    ds_read_b128 v[196:199], v48 offset:0
    v_mfma_f32_16x16x32_bf16 v[140:143], v[160:163], a[8:11], v[140:143]
    ds_read_b128 v[200:203], v48 offset:1024
    v_mfma_f32_16x16x32_bf16 v[144:147], v[164:167], a[8:11], v[144:147]
    ds_read_b128 v[204:207], v48 offset:2048
    buffer_load_dwordx4 a[60:63], v42, s[36:39], s69 offen offset:3072 sc1
    v_mfma_f32_16x16x32_bf16 v[148:151], v[168:171], a[8:11], v[148:151]
    ds_read_b128 v[208:211], v48 offset:3072
    v_mfma_f32_16x16x32_bf16 v[152:155], v[172:175], a[8:11], v[152:155]
    ds_read_b128 v[212:215], v48 offset:4096
    s_mov_b32 s70, 163840
    s_add_u32 m0, s74, 20480
    s_nop 0
    buffer_load_dwordx4 v41, s[36:39], s70 offen offset:0 sc1 lds
    s_waitcnt lgkmcnt(5)
    v_mfma_f32_16x16x32_bf16 v[136:139], v[176:179], a[12:15], v[136:139]
    ds_read_b128 v[156:159], v48 offset:5120
    v_mfma_f32_16x16x32_bf16 v[140:143], v[180:183], a[12:15], v[140:143]
    ds_read_b128 v[160:163], v48 offset:6144
    buffer_load_dwordx4 v41, s[36:39], s70 offen offset:1024 sc1 lds
    v_mfma_f32_16x16x32_bf16 v[144:147], v[184:187], a[12:15], v[144:147]
    ds_read_b128 v[164:167], v48 offset:7168
    v_mfma_f32_16x16x32_bf16 v[148:151], v[188:191], a[12:15], v[148:151]
    ds_read_b128 v[168:171], v48 offset:8192
    buffer_load_dwordx4 v41, s[36:39], s70 offen offset:2048 sc1 lds
    v_mfma_f32_16x16x32_bf16 v[152:155], v[192:195], a[12:15], v[152:155]
    ds_read_b128 v[172:175], v48 offset:9216
    s_waitcnt lgkmcnt(5)
    s_waitcnt vmcnt(25)
    v_mfma_f32_16x16x32_bf16 v[136:139], v[196:199], a[16:19], v[136:139]
    ds_read_b128 v[176:179], v48 offset:10240
    v_mfma_f32_16x16x32_bf16 v[140:143], v[200:203], a[16:19], v[140:143]
    ds_read_b128 v[180:183], v48 offset:11264
    buffer_load_dwordx4 v41, s[36:39], s70 offen offset:3072 sc1 lds
    v_mfma_f32_16x16x32_bf16 v[144:147], v[204:207], a[16:19], v[144:147]
    ds_read_b128 v[184:187], v48 offset:12288
    v_mfma_f32_16x16x32_bf16 v[148:151], v[208:211], a[16:19], v[148:151]
    ds_read_b128 v[188:191], v48 offset:13312
    s_mov_b32 s70, 167936
    s_add_u32 m0, s74, 24576
    s_nop 0
    buffer_load_dwordx4 v41, s[36:39], s70 offen sc1 lds
    v_mfma_f32_16x16x32_bf16 v[152:155], v[212:215], a[16:19], v[152:155]
    ds_read_b128 v[192:195], v48 offset:14336
    s_waitcnt lgkmcnt(5)
    s_waitcnt vmcnt(26)
    v_mfma_f32_16x16x32_bf16 v[136:139], v[156:159], a[20:23], v[136:139]
    ds_read_b128 v[196:199], v48 offset:15360
    s_mov_b32 s70, 184320
    s_add_u32 m0, s74, 81920
    s_nop 0
    buffer_load_dwordx4 v41, s[36:39], s70 offen offset:0 sc1 lds
    buffer_load_dword v50, v52, s[36:39], 0 offen offset:32 sc1
    v_mfma_f32_16x16x32_bf16 v[140:143], v[160:163], a[20:23], v[140:143]
    ds_read_b128 v[200:203], v48 offset:16384
    v_mfma_f32_16x16x32_bf16 v[144:147], v[164:167], a[20:23], v[144:147]
    ds_read_b128 v[204:207], v48 offset:17408
    buffer_load_dwordx4 v41, s[36:39], s70 offen offset:1024 sc1 lds
    v_mfma_f32_16x16x32_bf16 v[148:151], v[168:171], a[20:23], v[148:151]
    ds_read_b128 v[208:211], v48 offset:18432
    v_mfma_f32_16x16x32_bf16 v[152:155], v[172:175], a[20:23], v[152:155]
    ds_read_b128 v[212:215], v48 offset:19456
    s_waitcnt vmcnt(22)
    s_barrier
    s_waitcnt lgkmcnt(5)
    v_mfma_f32_16x16x32_bf16 v[136:139], v[176:179], a[24:27], v[136:139]
    ds_read_b128 v[156:159], v48 offset:20480
    buffer_load_dwordx4 v41, s[36:39], s70 offen offset:2048 sc1 lds
    v_mfma_f32_16x16x32_bf16 v[140:143], v[180:183], a[24:27], v[140:143]
    ds_read_b128 v[160:163], v48 offset:21504
    v_mfma_f32_16x16x32_bf16 v[144:147], v[184:187], a[24:27], v[144:147]
    ds_read_b128 v[164:167], v48 offset:22528
    buffer_load_dwordx4 v41, s[36:39], s70 offen offset:3072 sc1 lds
    v_mfma_f32_16x16x32_bf16 v[148:151], v[188:191], a[24:27], v[148:151]
    ds_read_b128 v[168:171], v48 offset:23552
    v_mfma_f32_16x16x32_bf16 v[152:155], v[192:195], a[24:27], v[152:155]
    ds_read_b128 v[172:175], v48 offset:24576
    s_mov_b32 s70, 188416
    s_add_u32 m0, s74, 86016
    s_nop 0
    buffer_load_dwordx4 v41, s[36:39], s70 offen sc1 lds
    s_waitcnt lgkmcnt(5)
    v_mfma_f32_16x16x32_bf16 v[136:139], v[196:199], a[28:31], v[136:139]
    ds_read_b128 v[176:179], v48 offset:25600
    v_mfma_f32_16x16x32_bf16 v[140:143], v[200:203], a[28:31], v[140:143]
    ds_read_b128 v[180:183], v48 offset:26624
    s_mov_b32 s70, 204800
    s_add_u32 m0, s74, 102400
    s_nop 0
    buffer_load_dwordx4 v41, s[36:39], s70 offen offset:0 sc1 lds
    v_mfma_f32_16x16x32_bf16 v[144:147], v[204:207], a[28:31], v[144:147]
    ds_read_b128 v[184:187], v48 offset:27648
    v_mfma_f32_16x16x32_bf16 v[148:151], v[208:211], a[28:31], v[148:151]
    ds_read_b128 v[188:191], v48 offset:28672
    v_mfma_f32_16x16x32_bf16 v[152:155], v[212:215], a[28:31], v[152:155]
    ds_read_b128 v[192:195], v48 offset:29696
    buffer_load_dwordx4 v41, s[36:39], s70 offen offset:1024 sc1 lds
    s_waitcnt lgkmcnt(5)
    s_waitcnt vmcnt(26)
    v_mfma_f32_16x16x32_bf16 v[136:139], v[156:159], a[32:35], v[136:139]
    ds_read_b128 v[196:199], v48 offset:30720
    v_mfma_f32_16x16x32_bf16 v[140:143], v[160:163], a[32:35], v[140:143]
    ds_read_b128 v[200:203], v48 offset:31744
    buffer_load_dwordx4 v41, s[36:39], s70 offen offset:2048 sc1 lds
    v_mfma_f32_16x16x32_bf16 v[144:147], v[164:167], a[32:35], v[144:147]
    ds_read_b128 v[204:207], v48 offset:32768
    v_mfma_f32_16x16x32_bf16 v[148:151], v[168:171], a[32:35], v[148:151]
    ds_read_b128 v[208:211], v48 offset:33792
    buffer_load_dwordx4 v41, s[36:39], s70 offen offset:3072 sc1 lds
    v_mfma_f32_16x16x32_bf16 v[152:155], v[172:175], a[32:35], v[152:155]
    ds_read_b128 v[212:215], v48 offset:34816
    s_waitcnt lgkmcnt(5)
    s_waitcnt vmcnt(27)
    v_mfma_f32_16x16x32_bf16 v[136:139], v[176:179], a[36:39], v[136:139]
    ds_read_b128 v[156:159], v48 offset:35840
    s_mov_b32 s70, 208896
    s_add_u32 m0, s74, 106496
    s_nop 0
    buffer_load_dwordx4 v41, s[36:39], s70 offen sc1 lds
    s_mov_b32 s80, 0
    s_waitcnt vmcnt(9)
    v_cmp_ne_u32 vcc, v50, v16
    s_nop 0
    s_cbranch_vccz L_ok_faA
L_retry_faA:
    s_sleep 1
    buffer_load_dword v50, v52, s[36:39], 0 offen offset:32 sc1
    s_waitcnt vmcnt(0)
    v_cmp_ne_u32 vcc, v50, v16
    s_add_u32 s80, s80, 1
    s_cmp_lt_u32 s80, 100000
    s_cselect_b64 s[82:83], vcc, 0
    s_cmp_lg_u64 s[82:83], 0
    s_cbranch_scc1 L_retry_faA
    s_nop 4
L_ok_faA:
    v_mfma_f32_16x16x32_bf16 v[140:143], v[180:183], a[36:39], v[140:143]
    ds_read_b128 v[160:163], v48 offset:36864
    s_mul_i32 s63, s85, 20480
    s_mul_i32 s64, s84, 160
    s_add_u32 s63, s63, s64
    s_mul_i32 s65, s56, 5376
    v_mfma_f32_16x16x32_bf16 v[144:147], v[184:187], a[36:39], v[144:147]
    ds_read_b128 v[164:167], v48 offset:37888
    s_add_u32 s65, s65, 40960
    v_add_u32 v2, 0, v1
    v_mul_u32_u24 v3, 6554, v2
    v_lshrrev_b32_e64 v3, 16, v3
    v_mfma_f32_16x16x32_bf16 v[148:151], v[188:191], a[36:39], v[148:151]
    ds_read_b128 v[168:171], v48 offset:38912
    s_mov_b32 s70, 225280
    s_add_u32 m0, s74, 122880
    s_nop 0
    buffer_load_dwordx4 v41, s[36:39], s70 offen offset:0 sc1 lds
    v_mul_u32_u24 v4, 10, v3
    v_mfma_f32_16x16x32_bf16 v[152:155], v[192:195], a[36:39], v[152:155]
    ds_read_b128 v[172:175], v48 offset:39936
    v_sub_u32_e64 v4, v2, v4
    v_mul_u32_u24 v5, 1280, v3
    v_lshl_add_u32 v5, v4, 4, v5
    s_barrier
    s_waitcnt lgkmcnt(5)
    v_mfma_f32_16x16x32_bf16 v[136:139], v[196:199], a[40:43], v[136:139]
    v_subrev_u32 v48, 40960, v48
    ds_read_b128 v[176:179], v48 offset:0
    s_mov_b32 s69, 0
    buffer_load_dwordx4 a[64:67], v42, s[36:39], s69 offen offset:0 sc1
    v_add_u32 v28, s63, v5
    v_mfma_f32_16x16x32_bf16 v[140:143], v[200:203], a[40:43], v[140:143]
    ds_read_b128 v[180:183], v48 offset:1024
    v_mul_u32_u24 v5, 336, v3
    v_lshl_add_u32 v5, v4, 5, v5
    v_add_u32_e64 v32, s65, v5
    v_mfma_f32_16x16x32_bf16 v[144:147], v[204:207], a[40:43], v[144:147]
    ds_read_b128 v[184:187], v48 offset:2048
    buffer_load_dwordx4 a[68:71], v42, s[36:39], s69 offen offset:1024 sc1
    v_add_u32_e64 v2, 64, v1
    v_mul_u32_u24 v3, 6554, v2
    v_lshrrev_b32_e64 v3, 16, v3
    v_mfma_f32_16x16x32_bf16 v[148:151], v[208:211], a[40:43], v[148:151]
    ds_read_b128 v[188:191], v48 offset:3072
    v_mul_u32_u24 v4, 10, v3
    v_sub_u32 v4, v2, v4
    v_mul_u32_u24 v5, 1280, v3
    v_mfma_f32_16x16x32_bf16 v[152:155], v[212:215], a[40:43], v[152:155]
    ds_read_b128 v[192:195], v48 offset:4096
    buffer_load_dwordx4 a[72:75], v42, s[36:39], s69 offen offset:2048 sc1
    v_lshl_add_u32 v5, v4, 4, v5
    v_add_u32 v29, s63, v5
    s_waitcnt lgkmcnt(5)
    v_mfma_f32_16x16x32_bf16 v[136:139], v[156:159], a[44:47], v[136:139]
    ds_read_b128 v[196:199], v48 offset:5120
    v_mul_u32_u24 v5, 336, v3
    v_lshl_add_u32 v5, v4, 5, v5
    v_add_u32_e64 v33, s65, v5
    v_mfma_f32_16x16x32_bf16 v[140:143], v[160:163], a[44:47], v[140:143]
    ds_read_b128 v[200:203], v48 offset:6144
    v_add_u32 v2, 128, v1
    v_mul_u32_u24 v3, 6554, v2
    v_lshrrev_b32_e64 v3, 16, v3
    v_mfma_f32_16x16x32_bf16 v[144:147], v[164:167], a[44:47], v[144:147]
    ds_read_b128 v[204:207], v48 offset:7168
    buffer_load_dwordx4 a[76:79], v42, s[36:39], s69 offen offset:3072 sc1
    v_mul_u32_u24 v4, 10, v3
    v_sub_u32 v4, v2, v4
    v_mul_u32_u24 v5, 1280, v3
    v_mfma_f32_16x16x32_bf16 v[148:151], v[168:171], a[44:47], v[148:151]
    ds_read_b128 v[208:211], v48 offset:8192
    v_lshl_add_u32 v5, v4, 4, v5
    v_add_u32_e64 v30, s63, v5
    v_mul_u32_u24 v5, 336, v3
    v_mfma_f32_16x16x32_bf16 v[152:155], v[172:175], a[44:47], v[152:155]
    ds_read_b128 v[212:215], v48 offset:9216
    s_mov_b32 s69, 12288
    buffer_load_dwordx4 a[80:83], v42, s[36:39], s69 offen offset:0 sc1
    v_lshl_add_u32 v5, v4, 5, v5
    s_waitcnt lgkmcnt(5)
    v_mfma_f32_16x16x32_bf16 v[136:139], v[176:179], a[48:51], v[136:139]
    ds_read_b128 v[156:159], v48 offset:10240
    v_add_u32 v34, s65, v5
    v_cmp_gt_u32_e64 vcc, 32, v1
    v_mov_b32 v2, 2130706432
    v_mfma_f32_16x16x32_bf16 v[140:143], v[180:183], a[48:51], v[140:143]
    ds_read_b128 v[160:163], v48 offset:11264
    buffer_load_dwordx4 a[84:87], v42, s[36:39], s69 offen offset:1024 sc1
    v_cndmask_b32 v30, v2, v30, vcc
    v_cndmask_b32 v34, v32, v34, vcc
    v_and_b32_e64 v2, 15, v1
    v_mfma_f32_16x16x32_bf16 v[144:147], v[184:187], a[48:51], v[144:147]
    ds_read_b128 v[164:167], v48 offset:12288
    v_mul_u32_u24 v2, 336, v2
    v_lshl_add_u32 v2, v11, 4, v2
    v_add_u32_e64 v17, s65, v2
    buffer_load_dwordx4 v[124:127], v28, s[24:27], 0 offen
    v_mfma_f32_16x16x32_bf16 v[148:151], v[188:191], a[48:51], v[148:151]
    ds_read_b128 v[168:171], v48 offset:13312
    buffer_load_dwordx4 a[88:91], v42, s[36:39], s69 offen offset:2048 sc1
    buffer_load_dwordx4 v[128:131], v29, s[24:27], 0 offen
    buffer_load_dwordx4 v[132:135], v30, s[24:27], 0 offen
    v_mfma_f32_16x16x32_bf16 v[152:155], v[192:195], a[48:51], v[152:155]
    ds_read_b128 v[172:175], v48 offset:14336
    s_waitcnt lgkmcnt(5)
    v_mfma_f32_16x16x32_bf16 v[136:139], v[196:199], a[52:55], v[136:139]
    ds_read_b128 v[176:179], v48 offset:15360
    v_mfma_f32_16x16x32_bf16 v[140:143], v[200:203], a[52:55], v[140:143]
    ds_read_b128 v[180:183], v48 offset:16384
    buffer_load_dwordx4 a[92:95], v42, s[36:39], s69 offen offset:3072 sc1
    v_mfma_f32_16x16x32_bf16 v[144:147], v[204:207], a[52:55], v[144:147]
    ds_read_b128 v[184:187], v48 offset:17408
    v_mfma_f32_16x16x32_bf16 v[148:151], v[208:211], a[52:55], v[148:151]
    ds_read_b128 v[188:191], v48 offset:18432
    s_mov_b32 s69, 24576
    buffer_load_dwordx4 a[96:99], v42, s[36:39], s69 offen offset:0 sc1
    v_mfma_f32_16x16x32_bf16 v[152:155], v[212:215], a[52:55], v[152:155]
    ds_read_b128 v[192:195], v48 offset:19456
    s_barrier
    s_waitcnt lgkmcnt(5)
    v_mfma_f32_16x16x32_bf16 v[136:139], v[156:159], a[56:59], v[136:139]
    ds_read_b128 v[196:199], v48 offset:20480
    buffer_load_dwordx4 a[100:103], v42, s[36:39], s69 offen offset:1024 sc1
    v_mfma_f32_16x16x32_bf16 v[140:143], v[160:163], a[56:59], v[140:143]
    ds_read_b128 v[200:203], v48 offset:21504
    v_mfma_f32_16x16x32_bf16 v[144:147], v[164:167], a[56:59], v[144:147]
    ds_read_b128 v[204:207], v48 offset:22528
    buffer_load_dwordx4 a[104:107], v42, s[36:39], s69 offen offset:2048 sc1
    v_mfma_f32_16x16x32_bf16 v[148:151], v[168:171], a[56:59], v[148:151]
    ds_read_b128 v[208:211], v48 offset:23552
    v_mfma_f32_16x16x32_bf16 v[152:155], v[172:175], a[56:59], v[152:155]
    ds_read_b128 v[212:215], v48 offset:24576
    s_waitcnt lgkmcnt(5)
    v_mfma_f32_16x16x32_bf16 v[136:139], v[176:179], a[60:63], v[136:139]
    ds_read_b128 v[156:159], v48 offset:25600
    buffer_load_dwordx4 a[108:111], v42, s[36:39], s69 offen offset:3072 sc1
    v_mfma_f32_16x16x32_bf16 v[140:143], v[180:183], a[60:63], v[140:143]
    ds_read_b128 v[160:163], v48 offset:26624
    v_mfma_f32_16x16x32_bf16 v[144:147], v[184:187], a[60:63], v[144:147]
    ds_read_b128 v[164:167], v48 offset:27648
    buffer_load_dwordx4 v41, s[36:39], s70 offen offset:1024 sc1 lds
    v_mfma_f32_16x16x32_bf16 v[148:151], v[188:191], a[60:63], v[148:151]
    ds_read_b128 v[168:171], v48 offset:28672
    v_mfma_f32_16x16x32_bf16 v[152:155], v[192:195], a[60:63], v[152:155]
    ds_read_b128 v[172:175], v48 offset:29696
    buffer_load_dwordx4 v41, s[36:39], s70 offen offset:2048 sc1 lds
    s_waitcnt lgkmcnt(5)
    s_waitcnt vmcnt(16)
    v_mfma_f32_16x16x32_bf16 v[136:139], v[196:199], a[64:67], v[136:139]
    ds_read_b128 v[176:179], v48 offset:30720
    v_mfma_f32_16x16x32_bf16 v[140:143], v[200:203], a[64:67], v[140:143]
    ds_read_b128 v[180:183], v48 offset:31744
    buffer_load_dwordx4 v41, s[36:39], s70 offen offset:3072 sc1 lds
    v_mfma_f32_16x16x32_bf16 v[144:147], v[204:207], a[64:67], v[144:147]
    ds_read_b128 v[184:187], v48 offset:32768
    v_mfma_f32_16x16x32_bf16 v[148:151], v[208:211], a[64:67], v[148:151]
    ds_read_b128 v[188:191], v48 offset:33792
    v_mfma_f32_16x16x32_bf16 v[152:155], v[212:215], a[64:67], v[152:155]
    ds_read_b128 v[192:195], v48 offset:34816
    s_mov_b32 s70, 229376
    s_add_u32 m0, s74, 126976
    s_nop 0
    buffer_load_dwordx4 v41, s[36:39], s70 offen sc1 lds
    s_waitcnt lgkmcnt(5)
    s_waitcnt vmcnt(17)
    v_mfma_f32_16x16x32_bf16 v[136:139], v[156:159], a[68:71], v[136:139]
    ds_read_b128 v[196:199], v48 offset:35840
    v_mfma_f32_16x16x32_bf16 v[140:143], v[160:163], a[68:71], v[140:143]
    ds_read_b128 v[200:203], v48 offset:36864
    s_mov_b32 s69, 36864
    buffer_load_dwordx4 a[112:115], v42, s[36:39], s69 offen offset:0 sc1
    v_mfma_f32_16x16x32_bf16 v[144:147], v[164:167], a[68:71], v[144:147]
    ds_read_b128 v[204:207], v48 offset:37888
    v_mfma_f32_16x16x32_bf16 v[148:151], v[168:171], a[68:71], v[148:151]
    ds_read_b128 v[208:211], v48 offset:38912
    buffer_load_dwordx4 a[116:119], v42, s[36:39], s69 offen offset:1024 sc1
    v_mfma_f32_16x16x32_bf16 v[152:155], v[172:175], a[68:71], v[152:155]
    ds_read_b128 v[212:215], v48 offset:39936
    s_barrier
    s_waitcnt lgkmcnt(5)
    s_waitcnt vmcnt(18)
    v_mfma_f32_16x16x32_bf16 v[136:139], v[176:179], a[72:75], v[136:139]
    v_add_u32 v48, 81920, v48
    ds_read_b128 v[156:159], v48 offset:0
    buffer_load_dwordx4 a[120:123], v42, s[36:39], s69 offen offset:2048 sc1
    buffer_load_dword v50, v52, s[36:39], 0 offen offset:2048 sc1
    v_mfma_f32_16x16x32_bf16 v[140:143], v[180:183], a[72:75], v[140:143]
    ds_read_b128 v[160:163], v48 offset:1024
    v_mfma_f32_16x16x32_bf16 v[144:147], v[184:187], a[72:75], v[144:147]
    ds_read_b128 v[164:167], v48 offset:2048
    v_mfma_f32_16x16x32_bf16 v[148:151], v[188:191], a[72:75], v[148:151]
    ds_read_b128 v[168:171], v48 offset:3072
    buffer_load_dwordx4 a[124:127], v42, s[36:39], s69 offen offset:3072 sc1
    v_mfma_f32_16x16x32_bf16 v[152:155], v[192:195], a[72:75], v[152:155]
    ds_read_b128 v[172:175], v48 offset:4096
    s_waitcnt lgkmcnt(5)
    s_waitcnt vmcnt(20)
    v_mfma_f32_16x16x32_bf16 v[136:139], v[196:199], a[76:79], v[136:139]
    ds_read_b128 v[176:179], v48 offset:5120
    s_mov_b32 s70, 245760
    s_add_u32 m0, s74, 40960
    s_nop 0
    buffer_load_dwordx4 v41, s[36:39], s70 offen offset:0 sc1 lds
    v_mfma_f32_16x16x32_bf16 v[140:143], v[200:203], a[76:79], v[140:143]
    ds_read_b128 v[180:183], v48 offset:6144
    v_mfma_f32_16x16x32_bf16 v[144:147], v[204:207], a[76:79], v[144:147]
    ds_read_b128 v[184:187], v48 offset:7168
    buffer_load_dwordx4 v41, s[36:39], s70 offen offset:1024 sc1 lds
    v_mfma_f32_16x16x32_bf16 v[148:151], v[208:211], a[76:79], v[148:151]
    ds_read_b128 v[188:191], v48 offset:8192
    v_mfma_f32_16x16x32_bf16 v[152:155], v[212:215], a[76:79], v[152:155]
    ds_read_b128 v[192:195], v48 offset:9216
    buffer_load_dwordx4 v41, s[36:39], s70 offen offset:2048 sc1 lds
    s_waitcnt lgkmcnt(5)
    s_waitcnt vmcnt(22)
    v_mfma_f32_16x16x32_bf16 v[136:139], v[156:159], a[80:83], v[136:139]
    ds_read_b128 v[196:199], v48 offset:10240
    v_mfma_f32_16x16x32_bf16 v[140:143], v[160:163], a[80:83], v[140:143]
    ds_read_b128 v[200:203], v48 offset:11264
    v_mfma_f32_16x16x32_bf16 v[144:147], v[164:167], a[80:83], v[144:147]
    ds_read_b128 v[204:207], v48 offset:12288
    buffer_load_dwordx4 v41, s[36:39], s70 offen offset:3072 sc1 lds
    v_mfma_f32_16x16x32_bf16 v[148:151], v[168:171], a[80:83], v[148:151]
    ds_read_b128 v[208:211], v48 offset:13312
    v_mfma_f32_16x16x32_bf16 v[152:155], v[172:175], a[80:83], v[152:155]
    ds_read_b128 v[212:215], v48 offset:14336
    s_mov_b32 s70, 249856
    s_add_u32 m0, s74, 45056
    s_nop 0
    buffer_load_dwordx4 v41, s[36:39], s70 offen sc1 lds
    s_waitcnt lgkmcnt(5)
    s_waitcnt vmcnt(23)
    v_mfma_f32_16x16x32_bf16 v[136:139], v[176:179], a[84:87], v[136:139]
    ds_read_b128 v[156:159], v48 offset:15360
    v_mfma_f32_16x16x32_bf16 v[140:143], v[180:183], a[84:87], v[140:143]
    ds_read_b128 v[160:163], v48 offset:16384
    s_mov_b32 s70, 266240
    s_add_u32 m0, s74, 61440
    s_nop 0
    buffer_load_dwordx4 v41, s[36:39], s70 offen offset:0 sc1 lds
    v_mfma_f32_16x16x32_bf16 v[144:147], v[184:187], a[84:87], v[144:147]
    ds_read_b128 v[164:167], v48 offset:17408
    v_mfma_f32_16x16x32_bf16 v[148:151], v[188:191], a[84:87], v[148:151]
    ds_read_b128 v[168:171], v48 offset:18432
    buffer_load_dwordx4 v41, s[36:39], s70 offen offset:1024 sc1 lds
    v_mfma_f32_16x16x32_bf16 v[152:155], v[192:195], a[84:87], v[152:155]
    ds_read_b128 v[172:175], v48 offset:19456
    s_barrier
    s_waitcnt lgkmcnt(5)
    s_waitcnt vmcnt(23)
    v_mfma_f32_16x16x32_bf16 v[136:139], v[196:199], a[88:91], v[136:139]
    ds_read_b128 v[176:179], v48 offset:20480
    v_mfma_f32_16x16x32_bf16 v[140:143], v[200:203], a[88:91], v[140:143]
    ds_read_b128 v[180:183], v48 offset:21504
    buffer_load_dwordx4 v41, s[36:39], s70 offen offset:2048 sc1 lds
    v_mfma_f32_16x16x32_bf16 v[144:147], v[204:207], a[88:91], v[144:147]
    ds_read_b128 v[184:187], v48 offset:22528
    v_mfma_f32_16x16x32_bf16 v[148:151], v[208:211], a[88:91], v[148:151]
    ds_read_b128 v[188:191], v48 offset:23552
    buffer_load_dwordx4 v41, s[36:39], s70 offen offset:3072 sc1 lds
    v_mfma_f32_16x16x32_bf16 v[152:155], v[212:215], a[88:91], v[152:155]
    ds_read_b128 v[192:195], v48 offset:24576
    s_waitcnt lgkmcnt(5)
    s_waitcnt vmcnt(22)
    v_mfma_f32_16x16x32_bf16 v[136:139], v[156:159], a[92:95], v[136:139]
    ds_read_b128 v[196:199], v48 offset:25600
    s_mov_b32 s70, 270336
    s_add_u32 m0, s74, 65536
    s_nop 0
    buffer_load_dwordx4 v41, s[36:39], s70 offen sc1 lds
    v_mfma_f32_16x16x32_bf16 v[140:143], v[160:163], a[92:95], v[140:143]
    ds_read_b128 v[200:203], v48 offset:26624
    v_mfma_f32_16x16x32_bf16 v[144:147], v[164:167], a[92:95], v[144:147]
    ds_read_b128 v[204:207], v48 offset:27648
    s_mov_b32 s70, 286720
    s_add_u32 m0, s74, 0
    s_nop 0
    buffer_load_dwordx4 v41, s[36:39], s70 offen offset:0 sc1 lds
    v_mfma_f32_16x16x32_bf16 v[148:151], v[168:171], a[92:95], v[148:151]
    ds_read_b128 v[208:211], v48 offset:28672
    v_mfma_f32_16x16x32_bf16 v[152:155], v[172:175], a[92:95], v[152:155]
    ds_read_b128 v[212:215], v48 offset:29696
    s_waitcnt lgkmcnt(5)
    s_waitcnt vmcnt(23)
    v_mfma_f32_16x16x32_bf16 v[136:139], v[176:179], a[96:99], v[136:139]
    ds_read_b128 v[156:159], v48 offset:30720
    buffer_load_dwordx4 v41, s[36:39], s70 offen offset:1024 sc1 lds
    v_mfma_f32_16x16x32_bf16 v[140:143], v[180:183], a[96:99], v[140:143]
    ds_read_b128 v[160:163], v48 offset:31744
    v_mfma_f32_16x16x32_bf16 v[144:147], v[184:187], a[96:99], v[144:147]
    ds_read_b128 v[164:167], v48 offset:32768
    buffer_load_dwordx4 v41, s[36:39], s70 offen offset:2048 sc1 lds
    v_mfma_f32_16x16x32_bf16 v[148:151], v[188:191], a[96:99], v[148:151]
    ds_read_b128 v[168:171], v48 offset:33792
    v_mfma_f32_16x16x32_bf16 v[152:155], v[192:195], a[96:99], v[152:155]
    ds_read_b128 v[172:175], v48 offset:34816
    buffer_load_dwordx4 v41, s[36:39], s70 offen offset:3072 sc1 lds
    s_waitcnt lgkmcnt(5)
    s_waitcnt vmcnt(25)
    v_mfma_f32_16x16x32_bf16 v[136:139], v[196:199], a[100:103], v[136:139]
    ds_read_b128 v[176:179], v48 offset:35840
    s_mov_b32 s80, 0
    s_waitcnt vmcnt(15)
    v_cmp_ne_u32 vcc, v50, v16
    s_nop 0
    s_cbranch_vccz L_ok_foA
L_retry_foA:
    s_sleep 1
    buffer_load_dword v50, v52, s[36:39], 0 offen offset:2048 sc1
    s_waitcnt vmcnt(0)
    v_cmp_ne_u32 vcc, v50, v16
    s_add_u32 s80, s80, 1
    s_cmp_lt_u32 s80, 100000
    s_cselect_b64 s[82:83], vcc, 0
    s_cmp_lg_u64 s[82:83], 0
    s_cbranch_scc1 L_retry_foA
    s_nop 4
L_ok_foA:
    v_mfma_f32_16x16x32_bf16 v[140:143], v[200:203], a[100:103], v[140:143]
    ds_read_b128 v[180:183], v48 offset:36864
    s_mov_b32 s70, 290816
    s_add_u32 m0, s74, 4096
    s_nop 0
    buffer_load_dwordx4 v41, s[36:39], s70 offen sc1 lds
    v_mfma_f32_16x16x32_bf16 v[144:147], v[204:207], a[100:103], v[144:147]
    ds_read_b128 v[184:187], v48 offset:37888
    v_mfma_f32_16x16x32_bf16 v[148:151], v[208:211], a[100:103], v[148:151]
    ds_read_b128 v[188:191], v48 offset:38912
    v_mfma_f32_16x16x32_bf16 v[152:155], v[212:215], a[100:103], v[152:155]
    ds_read_b128 v[192:195], v48 offset:39936
    s_mov_b32 s70, 307200
    s_add_u32 m0, s74, 20480
    s_nop 0
    buffer_load_dwordx4 v41, s[36:39], s70 offen offset:0 sc1 lds
    s_barrier
    s_waitcnt lgkmcnt(5)
    v_mfma_f32_16x16x32_bf16 v[136:139], v[156:159], a[104:107], v[136:139]
    ds_read_b128 v[196:199], v48 offset:40960
    v_mfma_f32_16x16x32_bf16 v[140:143], v[160:163], a[104:107], v[140:143]
    ds_read_b128 v[200:203], v48 offset:41984
    s_mov_b32 s69, 0
    buffer_load_dwordx4 a[128:131], v43, s[36:39], s69 offen offset:0 sc1
    v_mfma_f32_16x16x32_bf16 v[144:147], v[164:167], a[104:107], v[144:147]
    ds_read_b128 v[204:207], v48 offset:43008
    v_mfma_f32_16x16x32_bf16 v[148:151], v[168:171], a[104:107], v[148:151]
    ds_read_b128 v[208:211], v48 offset:44032
    buffer_load_dwordx4 a[132:135], v43, s[36:39], s69 offen offset:1024 sc1
    v_mfma_f32_16x16x32_bf16 v[152:155], v[172:175], a[104:107], v[152:155]
    ds_read_b128 v[212:215], v48 offset:45056
    s_waitcnt lgkmcnt(5)
    v_mfma_f32_16x16x32_bf16 v[136:139], v[176:179], a[108:111], v[136:139]
    ds_read_b128 v[156:159], v48 offset:46080
    buffer_load_dwordx4 a[136:139], v43, s[36:39], s69 offen offset:2048 sc1
    v_mfma_f32_16x16x32_bf16 v[140:143], v[180:183], a[108:111], v[140:143]
    ds_read_b128 v[160:163], v48 offset:47104
    v_mfma_f32_16x16x32_bf16 v[144:147], v[184:187], a[108:111], v[144:147]
    ds_read_b128 v[164:167], v48 offset:48128
    v_mfma_f32_16x16x32_bf16 v[148:151], v[188:191], a[108:111], v[148:151]
    ds_read_b128 v[168:171], v48 offset:49152
    buffer_load_dwordx4 a[140:143], v43, s[36:39], s69 offen offset:3072 sc1
    v_mfma_f32_16x16x32_bf16 v[152:155], v[192:195], a[108:111], v[152:155]
    ds_read_b128 v[172:175], v48 offset:50176
    s_waitcnt lgkmcnt(5)
    v_mfma_f32_16x16x32_bf16 v[136:139], v[196:199], a[112:115], v[136:139]
    ds_read_b128 v[176:179], v48 offset:51200
    s_mov_b32 s69, 4096
    buffer_load_dwordx4 a[144:147], v43, s[36:39], s69 offen offset:0 sc1
    v_mfma_f32_16x16x32_bf16 v[140:143], v[200:203], a[112:115], v[140:143]
    ds_read_b128 v[180:183], v48 offset:52224
    v_mfma_f32_16x16x32_bf16 v[144:147], v[204:207], a[112:115], v[144:147]
    ds_read_b128 v[184:187], v48 offset:53248
    buffer_load_dwordx4 a[148:151], v43, s[36:39], s69 offen offset:1024 sc1
    v_mfma_f32_16x16x32_bf16 v[148:151], v[208:211], a[112:115], v[148:151]
    ds_read_b128 v[188:191], v48 offset:54272
    v_mfma_f32_16x16x32_bf16 v[152:155], v[212:215], a[112:115], v[152:155]
    ds_read_b128 v[192:195], v48 offset:55296
    buffer_load_dwordx4 a[152:155], v43, s[36:39], s69 offen offset:2048 sc1
    s_waitcnt lgkmcnt(5)
    v_mfma_f32_16x16x32_bf16 v[136:139], v[156:159], a[116:119], v[136:139]
    ds_read_b128 v[196:199], v48 offset:56320
    v_mfma_f32_16x16x32_bf16 v[140:143], v[160:163], a[116:119], v[140:143]
    ds_read_b128 v[200:203], v48 offset:57344
    v_mfma_f32_16x16x32_bf16 v[144:147], v[164:167], a[116:119], v[144:147]
    ds_read_b128 v[204:207], v48 offset:58368
    buffer_load_dwordx4 a[156:159], v43, s[36:39], s69 offen offset:3072 sc1
    v_mfma_f32_16x16x32_bf16 v[148:151], v[168:171], a[116:119], v[148:151]
    ds_read_b128 v[208:211], v48 offset:59392
    v_mfma_f32_16x16x32_bf16 v[152:155], v[172:175], a[116:119], v[152:155]
    ds_read_b128 v[212:215], v48 offset:60416
    s_mov_b32 s69, 8192
    buffer_load_dwordx4 a[160:163], v43, s[36:39], s69 offen offset:0 sc1
    s_waitcnt vmcnt(20)
    s_barrier
    s_waitcnt lgkmcnt(5)
    v_mfma_f32_16x16x32_bf16 v[136:139], v[176:179], a[120:123], v[136:139]
    v_subrev_u32 v48, 40960, v48
    ds_read_b128 v[156:159], v48 offset:0
    v_mfma_f32_16x16x32_bf16 v[140:143], v[180:183], a[120:123], v[140:143]
    ds_read_b128 v[160:163], v48 offset:1024
    buffer_load_dwordx4 a[164:167], v43, s[36:39], s69 offen offset:1024 sc1
    v_mfma_f32_16x16x32_bf16 v[144:147], v[184:187], a[120:123], v[144:147]
    ds_read_b128 v[164:167], v48 offset:2048
    v_mfma_f32_16x16x32_bf16 v[148:151], v[188:191], a[120:123], v[148:151]
    ds_read_b128 v[168:171], v48 offset:3072
    buffer_load_dwordx4 a[168:171], v43, s[36:39], s69 offen offset:2048 sc1
    v_mfma_f32_16x16x32_bf16 v[152:155], v[192:195], a[120:123], v[152:155]
    ds_read_b128 v[172:175], v48 offset:4096
    s_waitcnt lgkmcnt(5)
    v_mfma_f32_16x16x32_bf16 v[136:139], v[196:199], a[124:127], v[136:139]
    ds_read_b128 v[176:179], v48 offset:5120
    v_mfma_f32_16x16x32_bf16 v[140:143], v[200:203], a[124:127], v[140:143]
    ds_read_b128 v[180:183], v48 offset:6144
    buffer_load_dwordx4 a[172:175], v43, s[36:39], s69 offen offset:3072 sc1
    v_mfma_f32_16x16x32_bf16 v[144:147], v[204:207], a[124:127], v[144:147]
    ds_read_b128 v[184:187], v48 offset:7168
    v_mfma_f32_16x16x32_bf16 v[148:151], v[208:211], a[124:127], v[148:151]
    ds_read_b128 v[188:191], v48 offset:8192
    buffer_load_dwordx4 v41, s[36:39], s70 offen offset:1024 sc1 lds
    v_mfma_f32_16x16x32_bf16 v[152:155], v[212:215], a[124:127], v[152:155]
    ds_read_b128 v[192:195], v48 offset:9216
    s_waitcnt lgkmcnt(5)
    s_waitcnt vmcnt(12)
    v_mfma_f32_16x16x32_bf16 v[236:239], v[156:159], a[128:131], 0
    ds_read_b128 v[196:199], v48 offset:10240
    buffer_load_dwordx4 v41, s[36:39], s70 offen offset:2048 sc1 lds
    v_mfma_f32_16x16x32_bf16 v[240:243], v[160:163], a[128:131], 0
    ds_read_b128 v[200:203], v48 offset:11264
    v_mfma_f32_16x16x32_bf16 v[244:247], v[164:167], a[128:131], 0
    ds_read_b128 v[204:207], v48 offset:12288
    buffer_load_dwordx4 v41, s[36:39], s70 offen offset:3072 sc1 lds
    v_mfma_f32_16x16x32_bf16 v[248:251], v[168:171], a[128:131], 0
    ds_read_b128 v[208:211], v48 offset:13312
    v_mfma_f32_16x16x32_bf16 v[252:255], v[172:175], a[128:131], 0
    ds_read_b128 v[212:215], v48 offset:14336
    s_waitcnt lgkmcnt(5)
    s_waitcnt vmcnt(13)
    v_mfma_f32_16x16x32_bf16 v[236:239], v[176:179], a[132:135], v[236:239]
    ds_read_b128 v[156:159], v48 offset:15360
    s_mov_b32 s70, 311296
    s_add_u32 m0, s74, 24576
    s_nop 0
    buffer_load_dwordx4 v41, s[36:39], s70 offen sc1 lds
    v_mov_b32 v36, 0xbfb8aa3b
    v_mfma_f32_16x16x32_bf16 v[240:243], v[180:183], a[132:135], v[240:243]
    ds_read_b128 v[160:163], v48 offset:16384
    v_pk_mul_f32 v[104:105], v[136:137], v[36:37] op_sel_hi:[1,0]
    v_pk_mul_f32 v[106:107], v[138:139], v[36:37] op_sel_hi:[1,0]
    v_mfma_f32_16x16x32_bf16 v[244:247], v[184:187], a[132:135], v[244:247]
    ds_read_b128 v[164:167], v48 offset:17408
    s_mov_b32 s69, 12288
    buffer_load_dwordx4 a[176:179], v43, s[36:39], s69 offen offset:0 sc1
    v_pk_mul_f32 v[108:109], v[140:141], v[36:37] op_sel_hi:[1,0]
    v_pk_mul_f32 v[110:111], v[142:143], v[36:37] op_sel_hi:[1,0]
    v_mfma_f32_16x16x32_bf16 v[248:251], v[188:191], a[132:135], v[248:251]
    ds_read_b128 v[168:171], v48 offset:18432
    v_pk_mul_f32 v[112:113], v[144:145], v[36:37] op_sel_hi:[1,0]
    v_pk_mul_f32 v[114:115], v[146:147], v[36:37] op_sel_hi:[1,0]
    v_mfma_f32_16x16x32_bf16 v[252:255], v[192:195], a[132:135], v[252:255]
    ds_read_b128 v[172:175], v48 offset:19456
    buffer_load_dwordx4 a[180:183], v43, s[36:39], s69 offen offset:1024 sc1
    v_pk_mul_f32 v[116:117], v[148:149], v[36:37] op_sel_hi:[1,0]
    v_pk_mul_f32 v[118:119], v[150:151], v[36:37] op_sel_hi:[1,0]
    s_barrier
    s_waitcnt lgkmcnt(5)
    s_waitcnt vmcnt(15)
    v_mfma_f32_16x16x32_bf16 v[236:239], v[196:199], a[136:139], v[236:239]
    ds_read_b128 v[176:179], v48 offset:20480
    v_pk_mul_f32 v[120:121], v[152:153], v[36:37] op_sel_hi:[1,0]
    v_pk_mul_f32 v[122:123], v[154:155], v[36:37] op_sel_hi:[1,0]
    v_mfma_f32_16x16x32_bf16 v[240:243], v[200:203], a[136:139], v[240:243]
    ds_read_b128 v[180:183], v48 offset:21504
    buffer_load_dwordx4 a[184:187], v43, s[36:39], s69 offen offset:2048 sc1
    v_exp_f32_e64 v104, v104
    v_mfma_f32_16x16x32_bf16 v[244:247], v[204:207], a[136:139], v[244:247]
    ds_read_b128 v[184:187], v48 offset:22528
    v_exp_f32_e64 v105, v105
    v_mfma_f32_16x16x32_bf16 v[248:251], v[208:211], a[136:139], v[248:251]
    ds_read_b128 v[188:191], v48 offset:23552
    v_exp_f32_e64 v106, v106
    v_mfma_f32_16x16x32_bf16 v[252:255], v[212:215], a[136:139], v[252:255]
    ds_read_b128 v[192:195], v48 offset:24576
    buffer_load_dwordx4 a[188:191], v43, s[36:39], s69 offen offset:3072 sc1
    v_exp_f32 v107, v107
    s_waitcnt lgkmcnt(5)
    s_waitcnt vmcnt(16)
    v_mfma_f32_16x16x32_bf16 v[236:239], v[156:159], a[140:143], v[236:239]
    ds_read_b128 v[196:199], v48 offset:25600
    v_exp_f32 v108, v108
    v_mfma_f32_16x16x32_bf16 v[240:243], v[160:163], a[140:143], v[240:243]
    ds_read_b128 v[200:203], v48 offset:26624
    s_mov_b32 s70, 327680
    s_add_u32 m0, s74, 81920
    s_nop 0
    buffer_load_dwordx4 v41, s[36:39], s70 offen offset:0 sc1 lds
    v_mfma_f32_16x16x32_bf16 v[244:247], v[164:167], a[140:143], v[244:247]
    ds_read_b128 v[204:207], v48 offset:27648
    v_exp_f32 v109, v109
    v_mfma_f32_16x16x32_bf16 v[248:251], v[168:171], a[140:143], v[248:251]
    ds_read_b128 v[208:211], v48 offset:28672
    buffer_load_dwordx4 v41, s[36:39], s70 offen offset:1024 sc1 lds
    v_exp_f32_e64 v110, v110
    v_mfma_f32_16x16x32_bf16 v[252:255], v[172:175], a[140:143], v[252:255]
    ds_read_b128 v[212:215], v48 offset:29696
    v_exp_f32 v111, v111
    s_waitcnt lgkmcnt(5)
    s_waitcnt vmcnt(17)
    v_mfma_f32_16x16x32_bf16 v[236:239], v[176:179], a[144:147], v[236:239]
    ds_read_b128 v[156:159], v48 offset:30720
    buffer_load_dwordx4 v41, s[36:39], s70 offen offset:2048 sc1 lds
    v_exp_f32 v112, v112
    v_mfma_f32_16x16x32_bf16 v[240:243], v[180:183], a[144:147], v[240:243]
    ds_read_b128 v[160:163], v48 offset:31744
    v_exp_f32_e64 v113, v113
    v_mfma_f32_16x16x32_bf16 v[244:247], v[184:187], a[144:147], v[244:247]
    ds_read_b128 v[164:167], v48 offset:32768
    v_exp_f32_e64 v114, v114
    v_mfma_f32_16x16x32_bf16 v[248:251], v[188:191], a[144:147], v[248:251]
    ds_read_b128 v[168:171], v48 offset:33792
    buffer_load_dwordx4 v41, s[36:39], s70 offen offset:3072 sc1 lds
    v_exp_f32_e64 v115, v115
    v_mfma_f32_16x16x32_bf16 v[252:255], v[192:195], a[144:147], v[252:255]
    ds_read_b128 v[172:175], v48 offset:34816
    v_exp_f32 v116, v116
    s_waitcnt lgkmcnt(5)
    s_waitcnt vmcnt(18)
    v_mfma_f32_16x16x32_bf16 v[236:239], v[196:199], a[148:151], v[236:239]
    ds_read_b128 v[176:179], v48 offset:35840
    s_mov_b32 s70, 331776
    s_add_u32 m0, s74, 86016
    s_nop 0
    buffer_load_dwordx4 v41, s[36:39], s70 offen sc1 lds
    v_mfma_f32_16x16x32_bf16 v[240:243], v[200:203], a[148:151], v[240:243]
    ds_read_b128 v[180:183], v48 offset:36864
    v_exp_f32_e64 v117, v117
    v_mfma_f32_16x16x32_bf16 v[244:247], v[204:207], a[148:151], v[244:247]
    ds_read_b128 v[184:187], v48 offset:37888
    s_mov_b32 s69, 16384
    buffer_load_dwordx4 a[192:195], v43, s[36:39], s69 offen offset:0 sc1
    v_exp_f32_e64 v118, v118
    v_mfma_f32_16x16x32_bf16 v[248:251], v[208:211], a[148:151], v[248:251]
    ds_read_b128 v[188:191], v48 offset:38912
    v_exp_f32_e64 v119, v119
    v_mfma_f32_16x16x32_bf16 v[252:255], v[212:215], a[148:151], v[252:255]
    ds_read_b128 v[192:195], v48 offset:39936
    buffer_load_dwordx4 a[196:199], v43, s[36:39], s69 offen offset:1024 sc1
    v_exp_f32 v120, v120
    s_barrier
    s_waitcnt lgkmcnt(5)
    s_waitcnt vmcnt(20)
    v_mfma_f32_16x16x32_bf16 v[236:239], v[156:159], a[152:155], v[236:239]
    v_subrev_u32 v48, 40960, v48
    ds_read_b128 v[196:199], v48 offset:0
    v_exp_f32_e64 v121, v121
    v_mfma_f32_16x16x32_bf16 v[240:243], v[160:163], a[152:155], v[240:243]
    ds_read_b128 v[200:203], v48 offset:1024
    v_exp_f32_e64 v122, v122
    v_mfma_f32_16x16x32_bf16 v[244:247], v[164:167], a[152:155], v[244:247]
    ds_read_b128 v[204:207], v48 offset:2048
    buffer_load_dwordx4 a[200:203], v43, s[36:39], s69 offen offset:2048 sc1
    v_exp_f32_e64 v123, v123
    v_mfma_f32_16x16x32_bf16 v[248:251], v[168:171], a[152:155], v[248:251]
    ds_read_b128 v[208:211], v48 offset:3072
    v_pk_add_f32 v[104:105], v[104:105], 1.0 op_sel_hi:[1,0]
    v_pk_add_f32 v[106:107], v[106:107], 1.0 op_sel_hi:[1,0]
    v_mfma_f32_16x16x32_bf16 v[252:255], v[172:175], a[152:155], v[252:255]
    ds_read_b128 v[212:215], v48 offset:4096
    buffer_load_dwordx4 a[204:207], v43, s[36:39], s69 offen offset:3072 sc1
    v_pk_add_f32 v[108:109], v[108:109], 1.0 op_sel_hi:[1,0]
    v_pk_add_f32 v[110:111], v[110:111], 1.0 op_sel_hi:[1,0]
    s_waitcnt lgkmcnt(5)
    s_waitcnt vmcnt(21)
    v_mfma_f32_16x16x32_bf16 v[236:239], v[176:179], a[156:159], v[236:239]
    ds_read_b128 v[156:159], v48 offset:5120
    v_pk_add_f32 v[112:113], v[112:113], 1.0 op_sel_hi:[1,0]
    v_pk_add_f32 v[114:115], v[114:115], 1.0 op_sel_hi:[1,0]
    v_mfma_f32_16x16x32_bf16 v[240:243], v[180:183], a[156:159], v[240:243]
    ds_read_b128 v[160:163], v48 offset:6144
    v_pk_add_f32 v[116:117], v[116:117], 1.0 op_sel_hi:[1,0]
    v_pk_add_f32 v[118:119], v[118:119], 1.0 op_sel_hi:[1,0]
    v_mfma_f32_16x16x32_bf16 v[244:247], v[184:187], a[156:159], v[244:247]
    ds_read_b128 v[164:167], v48 offset:7168
    v_pk_add_f32 v[120:121], v[120:121], 1.0 op_sel_hi:[1,0]
    v_pk_add_f32 v[122:123], v[122:123], 1.0 op_sel_hi:[1,0]
    v_mfma_f32_16x16x32_bf16 v[248:251], v[188:191], a[156:159], v[248:251]
    ds_read_b128 v[168:171], v48 offset:8192
    v_rcp_f32_e64 v104, v104
    v_mfma_f32_16x16x32_bf16 v[252:255], v[192:195], a[156:159], v[252:255]
    ds_read_b128 v[172:175], v48 offset:9216
    v_rcp_f32 v105, v105
    s_waitcnt lgkmcnt(5)
    s_waitcnt vmcnt(20)
    v_mfma_f32_16x16x32_bf16 v[236:239], v[196:199], a[160:163], v[236:239]
    ds_read_b128 v[176:179], v48 offset:10240
    v_rcp_f32 v106, v106
    v_mfma_f32_16x16x32_bf16 v[240:243], v[200:203], a[160:163], v[240:243]
    ds_read_b128 v[180:183], v48 offset:11264
    v_rcp_f32_e64 v107, v107
    v_mfma_f32_16x16x32_bf16 v[244:247], v[204:207], a[160:163], v[244:247]
    ds_read_b128 v[184:187], v48 offset:12288
    v_rcp_f32_e64 v108, v108
    v_mfma_f32_16x16x32_bf16 v[248:251], v[208:211], a[160:163], v[248:251]
    ds_read_b128 v[188:191], v48 offset:13312
    v_rcp_f32_e64 v109, v109
    v_mfma_f32_16x16x32_bf16 v[252:255], v[212:215], a[160:163], v[252:255]
    ds_read_b128 v[192:195], v48 offset:14336
    v_rcp_f32 v110, v110
    s_waitcnt lgkmcnt(5)
    s_waitcnt vmcnt(19)
    v_mfma_f32_16x16x32_bf16 v[236:239], v[156:159], a[164:167], v[236:239]
    ds_read_b128 v[196:199], v48 offset:15360
    v_rcp_f32 v111, v111
    v_mfma_f32_16x16x32_bf16 v[240:243], v[160:163], a[164:167], v[240:243]
    ds_read_b128 v[200:203], v48 offset:16384
    v_rcp_f32_e64 v112, v112
    v_mfma_f32_16x16x32_bf16 v[244:247], v[164:167], a[164:167], v[244:247]
    ds_read_b128 v[204:207], v48 offset:17408
    v_rcp_f32_e64 v113, v113
    v_mfma_f32_16x16x32_bf16 v[248:251], v[168:171], a[164:167], v[248:251]
    ds_read_b128 v[208:211], v48 offset:18432
    v_rcp_f32_e64 v114, v114
    v_mfma_f32_16x16x32_bf16 v[252:255], v[172:175], a[164:167], v[252:255]
    ds_read_b128 v[212:215], v48 offset:19456
    v_rcp_f32 v115, v115
    s_waitcnt vmcnt(13)
    s_barrier
    s_waitcnt lgkmcnt(5)
    v_mfma_f32_16x16x32_bf16 v[236:239], v[176:179], a[168:171], v[236:239]
    ds_read_b128 v[156:159], v48 offset:20480
    v_rcp_f32_e64 v116, v116
    v_mfma_f32_16x16x32_bf16 v[240:243], v[180:183], a[168:171], v[240:243]
    ds_read_b128 v[160:163], v48 offset:21504
    v_rcp_f32_e64 v117, v117
    v_mfma_f32_16x16x32_bf16 v[244:247], v[184:187], a[168:171], v[244:247]
    ds_read_b128 v[164:167], v48 offset:22528
    v_rcp_f32_e64 v118, v118
    v_mfma_f32_16x16x32_bf16 v[248:251], v[188:191], a[168:171], v[248:251]
    ds_read_b128 v[168:171], v48 offset:23552
    v_rcp_f32_e64 v119, v119
    v_mfma_f32_16x16x32_bf16 v[252:255], v[192:195], a[168:171], v[252:255]
    ds_read_b128 v[172:175], v48 offset:24576
    v_rcp_f32 v120, v120
    s_waitcnt lgkmcnt(5)
    v_mfma_f32_16x16x32_bf16 v[236:239], v[196:199], a[172:175], v[236:239]
    ds_read_b128 v[176:179], v48 offset:25600
    v_rcp_f32_e64 v121, v121
    v_mfma_f32_16x16x32_bf16 v[240:243], v[200:203], a[172:175], v[240:243]
    ds_read_b128 v[180:183], v48 offset:26624
    v_rcp_f32_e64 v122, v122
    v_mfma_f32_16x16x32_bf16 v[244:247], v[204:207], a[172:175], v[244:247]
    ds_read_b128 v[184:187], v48 offset:27648
    v_rcp_f32_e64 v123, v123
    v_mfma_f32_16x16x32_bf16 v[248:251], v[208:211], a[172:175], v[248:251]
    ds_read_b128 v[188:191], v48 offset:28672
    v_pk_mul_f32 v[104:105], v[136:137], v[104:105]
    v_pk_mul_f32 v[106:107], v[138:139], v[106:107]
    v_mfma_f32_16x16x32_bf16 v[252:255], v[212:215], a[172:175], v[252:255]
    ds_read_b128 v[192:195], v48 offset:29696
    v_pk_mul_f32 v[108:109], v[140:141], v[108:109]
    v_pk_mul_f32 v[110:111], v[142:143], v[110:111]
    s_waitcnt lgkmcnt(5)
    s_waitcnt vmcnt(12)
    v_mfma_f32_16x16x32_bf16 v[236:239], v[156:159], a[176:179], v[236:239]
    ds_read_b128 v[196:199], v48 offset:30720
    v_pk_mul_f32 v[112:113], v[144:145], v[112:113]
    v_pk_mul_f32 v[114:115], v[146:147], v[114:115]
    v_mfma_f32_16x16x32_bf16 v[240:243], v[160:163], a[176:179], v[240:243]
    ds_read_b128 v[200:203], v48 offset:31744
    v_pk_mul_f32 v[116:117], v[148:149], v[116:117]
    v_pk_mul_f32 v[118:119], v[150:151], v[118:119]
    v_mfma_f32_16x16x32_bf16 v[244:247], v[164:167], a[176:179], v[244:247]
    ds_read_b128 v[204:207], v48 offset:32768
    v_pk_mul_f32 v[120:121], v[152:153], v[120:121]
    v_pk_mul_f32 v[122:123], v[154:155], v[122:123]
    v_mfma_f32_16x16x32_bf16 v[248:251], v[168:171], a[176:179], v[248:251]
    ds_read_b128 v[208:211], v48 offset:33792
    v_lshlrev_b32_e64 v228, 16, v124
    v_and_b32 v229, 0xffff0000, v124
    v_mfma_f32_16x16x32_bf16 v[252:255], v[172:175], a[176:179], v[252:255]
    ds_read_b128 v[212:215], v48 offset:34816
    v_lshlrev_b32_e64 v230, 16, v125
    v_and_b32 v231, 0xffff0000, v125
    s_waitcnt lgkmcnt(5)
    s_waitcnt vmcnt(11)
    v_mfma_f32_16x16x32_bf16 v[236:239], v[176:179], a[180:183], v[236:239]
    ds_read_b128 v[156:159], v48 offset:35840
    v_lshlrev_b32_e64 v232, 16, v126
    v_and_b32 v233, 0xffff0000, v126
    v_mfma_f32_16x16x32_bf16 v[240:243], v[180:183], a[180:183], v[240:243]
    ds_read_b128 v[160:163], v48 offset:36864
    v_lshlrev_b32_e64 v234, 16, v127
    v_and_b32 v235, 0xffff0000, v127
    v_mfma_f32_16x16x32_bf16 v[244:247], v[184:187], a[180:183], v[244:247]
    ds_read_b128 v[164:167], v48 offset:37888
    v_lshlrev_b32_e64 v96, 16, v128
    v_and_b32 v97, 0xffff0000, v128
    v_mfma_f32_16x16x32_bf16 v[248:251], v[188:191], a[180:183], v[248:251]
    ds_read_b128 v[168:171], v48 offset:38912
    v_lshlrev_b32_e64 v98, 16, v129
    v_and_b32 v99, 0xffff0000, v129
    v_mfma_f32_16x16x32_bf16 v[252:255], v[192:195], a[180:183], v[252:255]
    ds_read_b128 v[172:175], v48 offset:39936
    v_lshlrev_b32_e64 v100, 16, v130
    v_and_b32 v101, 0xffff0000, v130
    s_waitcnt vmcnt(4)
    s_barrier
    s_waitcnt lgkmcnt(5)
    v_mfma_f32_16x16x32_bf16 v[236:239], v[196:199], a[184:187], v[236:239]
    v_add_u32 v48, 81920, v48
    ds_read_b128 v[176:179], v48 offset:0
    v_lshlrev_b32 v102, 16, v131
    v_and_b32 v103, 0xffff0000, v131
    v_mfma_f32_16x16x32_bf16 v[240:243], v[200:203], a[184:187], v[240:243]
    ds_read_b128 v[180:183], v48 offset:1024
    v_lshlrev_b32_e64 v88, 16, v132
    v_and_b32 v89, 0xffff0000, v132
    v_mfma_f32_16x16x32_bf16 v[244:247], v[204:207], a[184:187], v[244:247]
    ds_read_b128 v[184:187], v48 offset:2048
    v_lshlrev_b32_e64 v90, 16, v133
    v_and_b32 v91, 0xffff0000, v133
    v_mfma_f32_16x16x32_bf16 v[248:251], v[208:211], a[184:187], v[248:251]
    ds_read_b128 v[188:191], v48 offset:3072
    v_lshlrev_b32_e64 v92, 16, v134
    v_and_b32 v93, 0xffff0000, v134
    v_mfma_f32_16x16x32_bf16 v[252:255], v[212:215], a[184:187], v[252:255]
    ds_read_b128 v[192:195], v48 offset:4096
    v_lshlrev_b32_e64 v94, 16, v135
    v_and_b32 v95, 0xffff0000, v135
    s_waitcnt lgkmcnt(5)
    v_mfma_f32_16x16x32_bf16 v[236:239], v[156:159], a[188:191], v[236:239]
    ds_read_b128 v[196:199], v48 offset:5120
    v_mfma_f32_16x16x32_bf16 v[240:243], v[160:163], a[188:191], v[240:243]
    ds_read_b128 v[200:203], v48 offset:6144
    v_mfma_f32_16x16x32_bf16 v[244:247], v[164:167], a[188:191], v[244:247]
    ds_read_b128 v[204:207], v48 offset:7168
    v_mfma_f32_16x16x32_bf16 v[248:251], v[168:171], a[188:191], v[248:251]
    ds_read_b128 v[208:211], v48 offset:8192
    v_mfma_f32_16x16x32_bf16 v[252:255], v[172:175], a[188:191], v[252:255]
    ds_read_b128 v[212:215], v48 offset:9216
    s_waitcnt lgkmcnt(5)
    s_waitcnt vmcnt(3)
    v_mfma_f32_16x16x32_bf16 v[236:239], v[176:179], a[192:195], v[236:239]
    ds_read_b128 v[156:159], v48 offset:10240
    v_mfma_f32_16x16x32_bf16 v[240:243], v[180:183], a[192:195], v[240:243]
    ds_read_b128 v[160:163], v48 offset:11264
    v_mfma_f32_16x16x32_bf16 v[244:247], v[184:187], a[192:195], v[244:247]
    ds_read_b128 v[164:167], v48 offset:12288
    v_mfma_f32_16x16x32_bf16 v[248:251], v[188:191], a[192:195], v[248:251]
    ds_read_b128 v[168:171], v48 offset:13312
    v_mfma_f32_16x16x32_bf16 v[252:255], v[192:195], a[192:195], v[252:255]
    ds_read_b128 v[172:175], v48 offset:14336
    s_waitcnt lgkmcnt(5)
    s_waitcnt vmcnt(2)
    v_mfma_f32_16x16x32_bf16 v[236:239], v[196:199], a[196:199], v[236:239]
    ds_read_b128 v[176:179], v48 offset:15360
    v_mfma_f32_16x16x32_bf16 v[240:243], v[200:203], a[196:199], v[240:243]
    ds_read_b128 v[180:183], v48 offset:16384
    v_mfma_f32_16x16x32_bf16 v[244:247], v[204:207], a[196:199], v[244:247]
    ds_read_b128 v[184:187], v48 offset:17408
    v_mfma_f32_16x16x32_bf16 v[248:251], v[208:211], a[196:199], v[248:251]
    ds_read_b128 v[188:191], v48 offset:18432
    v_mfma_f32_16x16x32_bf16 v[252:255], v[212:215], a[196:199], v[252:255]
    ds_read_b128 v[192:195], v48 offset:19456
    s_waitcnt lgkmcnt(5)
    s_waitcnt vmcnt(1)
    v_mfma_f32_16x16x32_bf16 v[236:239], v[156:159], a[200:203], v[236:239]
    v_mfma_f32_16x16x32_bf16 v[240:243], v[160:163], a[200:203], v[240:243]
    v_mfma_f32_16x16x32_bf16 v[244:247], v[164:167], a[200:203], v[244:247]
    v_mfma_f32_16x16x32_bf16 v[248:251], v[168:171], a[200:203], v[248:251]
    v_mfma_f32_16x16x32_bf16 v[252:255], v[172:175], a[200:203], v[252:255]
    s_waitcnt lgkmcnt(0)
    s_waitcnt vmcnt(0)
    v_mfma_f32_16x16x32_bf16 v[236:239], v[176:179], a[204:207], v[236:239]
    v_mfma_f32_16x16x32_bf16 v[240:243], v[180:183], a[204:207], v[240:243]
    v_mfma_f32_16x16x32_bf16 v[244:247], v[184:187], a[204:207], v[244:247]
    v_mfma_f32_16x16x32_bf16 v[248:251], v[188:191], a[204:207], v[248:251]
    v_mfma_f32_16x16x32_bf16 v[252:255], v[192:195], a[204:207], v[252:255]
    s_nop 3
    v_pk_mul_f32 v[104:105], v[236:237], v[104:105]
    v_pk_mul_f32 v[106:107], v[238:239], v[106:107]
    ds_write_b128 v17, v[104:107] offset:0
    v_pk_mul_f32 v[108:109], v[240:241], v[108:109]
    v_pk_mul_f32 v[110:111], v[242:243], v[110:111]
    ds_write_b128 v17, v[108:111] offset:64
    v_pk_mul_f32 v[112:113], v[244:245], v[112:113]
    v_pk_mul_f32 v[114:115], v[246:247], v[114:115]
    ds_write_b128 v17, v[112:115] offset:128
    v_pk_mul_f32 v[116:117], v[248:249], v[116:117]
    v_pk_mul_f32 v[118:119], v[250:251], v[118:119]
    ds_write_b128 v17, v[116:119] offset:192
    v_pk_mul_f32 v[120:121], v[252:253], v[120:121]
    v_pk_mul_f32 v[122:123], v[254:255], v[122:123]
    ds_write_b128 v17, v[120:123] offset:256
    ds_read_b128 v[156:159], v32
    ds_read_b128 v[160:163], v32 offset:16
    ds_read_b128 v[164:167], v33
    ds_read_b128 v[168:171], v33 offset:16
    ds_read_b128 v[172:175], v34
    ds_read_b128 v[176:179], v34 offset:16
    s_waitcnt lgkmcnt(5)
    v_pk_add_f32 v[228:229], v[228:229], v[156:157]
    v_pk_add_f32 v[230:231], v[230:231], v[158:159]
    s_waitcnt lgkmcnt(4)
    v_pk_add_f32 v[232:233], v[232:233], v[160:161]
    v_pk_add_f32 v[234:235], v[234:235], v[162:163]
    v_cvt_pk_bf16_f32 v124, v228, v229
    v_cvt_pk_bf16_f32 v125, v230, v231
    v_cvt_pk_bf16_f32 v126, v232, v233
    v_cvt_pk_bf16_f32 v127, v234, v235
    buffer_store_dwordx4 v[124:127], v28, s[48:51], 0 offen
    s_waitcnt lgkmcnt(3)
    v_pk_add_f32 v[96:97], v[96:97], v[164:165]
    v_pk_add_f32 v[98:99], v[98:99], v[166:167]
    s_waitcnt lgkmcnt(2)
    v_pk_add_f32 v[100:101], v[100:101], v[168:169]
    v_pk_add_f32 v[102:103], v[102:103], v[170:171]
    v_cvt_pk_bf16_f32 v128, v96, v97
    v_cvt_pk_bf16_f32 v129, v98, v99
    v_cvt_pk_bf16_f32 v130, v100, v101
    v_cvt_pk_bf16_f32 v131, v102, v103
    buffer_store_dwordx4 v[128:131], v29, s[48:51], 0 offen
    s_waitcnt lgkmcnt(1)
    v_pk_add_f32 v[88:89], v[88:89], v[172:173]
    v_pk_add_f32 v[90:91], v[90:91], v[174:175]
    s_waitcnt lgkmcnt(0)
    v_pk_add_f32 v[92:93], v[92:93], v[176:177]
    v_pk_add_f32 v[94:95], v[94:95], v[178:179]
    v_cvt_pk_bf16_f32 v132, v88, v89
    v_cvt_pk_bf16_f32 v133, v90, v91
    v_cvt_pk_bf16_f32 v134, v92, v93
    v_cvt_pk_bf16_f32 v135, v94, v95
    buffer_store_dwordx4 v[132:135], v30, s[48:51], 0 offen
    s_endpgm
.p2align 6
L_typeB:
    s_mul_i32 s73, s56, 3072
    s_mul_i32 s87, s59, 384
    s_lshl_b32 s63, s60, 7
    s_add_u32 s87, s87, s63
    s_sub_u32 s87, s87, 128
    s_lshl_b32 s63, s56, 4
    v_lshrrev_b32 v6, 3, v1
    v_add_u32_e64 v6, s63, v6
    v_mul_u32_u24 v6, 3072, v6
    v_lshrrev_b32 v7, 2, v1
    v_and_b32 v7, 4, v7
    v_xor_b32 v7, v7, v1
    v_and_b32 v7, 7, v7
    v_lshl_add_u32 v6, v7, 4, v6
    s_lshl_b32 s63, s87, 1
    v_add_u32 v94, s63, v6
    v_add_u32 v95, 23552, v94
    v_add_u32 v96, 128, v94
    v_add_u32 v97, 128, v95
    s_waitcnt lgkmcnt(0)
    s_mov_b32 s24, s4
    s_and_b32 s25, s5, 0xffff
    s_mov_b32 s26, 2621440
    s_mov_b32 s27, 0x20000
    s_add_u32 m0, s72, 0
    s_movk_i32 s69, 0
    buffer_load_dwordx4 v90, s[24:27], s69 offen offset:0 lds
    buffer_load_dwordx4 v91, s[24:27], s69 offen offset:1024 lds
    buffer_load_dwordx4 v92, s[24:27], s69 offen offset:2048 lds
    buffer_load_dwordx4 v93, s[24:27], s69 offen offset:3072 lds
    s_mov_b32 s32, s14
    s_and_b32 s33, s15, 0xffff
    s_mov_b32 s34, 1966080
    s_mov_b32 s35, 0x20000
    s_mov_b32 s70, 0
    s_add_u32 m0, s91, 16384
    s_nop 0
    buffer_load_dwordx4 v94, s[32:35], s70 offen offset:0 lds
    buffer_load_dwordx4 v95, s[32:35], s70 offen offset:1024 lds
    s_add_u32 m0, s91, 24576
    s_nop 0
    buffer_load_dwordx4 v96, s[32:35], s70 offen offset:0 lds
    buffer_load_dwordx4 v97, s[32:35], s70 offen offset:1024 lds
    v_lshrrev_b32_e64 v11, 4, v1
    v_bfe_u32 v12, v1, 2, 2
    v_and_b32 v13, 3, v1
    v_lshrrev_b32 v14, 5, v1
    v_and_b32 v15, 31, v1
    s_mov_b32 s36, s22
    s_and_b32 s37, s23, 0xffff
    s_mov_b32 s38, 14630912
    s_mov_b32 s39, 0x20000
    s_mov_b32 s52, s20
    s_and_b32 s53, s21, 0xffff
    s_mov_b32 s54, 256
    s_mov_b32 s55, 0x20000
    s_memrealtime s[82:83]
    s_mov_b32 s44, s8
    s_and_b32 s45, s9, 0xffff
    s_mov_b32 s46, 25600
    s_mov_b32 s47, 0x20000
    s_cmp_eq_u32 s2, 0
    s_cselect_b32 s63, 0, 2130706432
    v_lshlrev_b32 v7, 8, v0
    v_add_u32 v7, s63, v7
    s_waitcnt lgkmcnt(0)
    s_or_b32 s82, s82, 1
    v_mov_b32 v6, s82
    buffer_store_dword v6, v7, s[52:55], 0 offen sc1
    s_mul_i32 s63, s58, 3200
    v_lshlrev_b32_e64 v2, 3, v0
    v_add_u32 v3, 2048, v2
    v_cmp_gt_u32 vcc, 3200, v3
    v_mov_b32 v4, 2130706432
    buffer_load_dwordx2 v[100:101], v2, s[44:47], s63 offen
    v_cndmask_b32_e64 v3, v4, v3, vcc
    buffer_load_dwordx2 v[102:103], v3, s[44:47], s63 offen
    s_cmp_eq_u32 s56, 1
    s_cselect_b32 s44, s6, s4
    s_cselect_b32 s45, s7, s5
    s_mov_b32 s46, 2621440
    s_cselect_b32 s46, 2457600, s46
    s_mov_b32 s101, 128
    s_cselect_b32 s101, 245760, s101
    s_cmp_eq_u32 s56, 2
    s_cselect_b32 s44, s14, s44
    s_cselect_b32 s45, s15, s45
    s_cselect_b32 s46, 1966080, s46
    s_cselect_b32 s101, 196608, s101
    s_and_b32 s45, s45, 0xffff
    s_lshl_b32 s63, s57, 2
    s_add_u32 s63, s63, s60
    s_lshl_b32 s63, s63, 5
    v_add_u32 v2, s63, v15
    v_mul_u32_u24 v2, 1280, v2
    v_mul_u32_u24 v3, 7282, v15
    v_lshrrev_b32 v3, 16, v3
    v_mul_u32_u24 v4, 9, v3
    v_sub_u32_e64 v4, v15, v4
    v_mul_u32_u24 v5, 21846, v4
    v_lshrrev_b32 v5, 16, v5
    v_mul_u32_u24 v6, 3, v5
    v_sub_u32 v6, v4, v6
    s_lshl_b32 s63, s61, 1
    v_add_u32 v3, s63, v3
    v_mul_u32_u24 v3, 30, v3
    v_mad_u32_u24 v3, v5, 10, v3
    s_mul_i32 s64, s59, 5
    s_lshr_b32 s64, s64, 1
    v_add3_u32 v3, v3, v6, s64
    v_lshlrev_b32_e64 v3, 7, v3
    v_mul_u32_u24 v4, 10923, v15
    v_lshrrev_b32 v4, 16, v4
    v_mul_u32_u24 v5, 6, v4
    v_sub_u32 v5, v15, v5
    v_add_u32 v4, s63, v4
    v_mul_u32_u24 v4, 24, v4
    s_mul_i32 s64, s59, 6
    v_add3_u32 v4, v4, v5, s64
    v_lshlrev_b32 v4, 7, v4
    s_cmp_eq_u32 s56, 1
    s_cselect_b64 vcc, -1, 0
    s_cselect_b32 s64, 18, 32
    v_cndmask_b32 v2, v2, v3, vcc
    s_cmp_eq_u32 s56, 2
    s_cselect_b64 vcc, -1, 0
    s_cselect_b32 s64, 12, s64
    v_cndmask_b32 v2, v2, v4, vcc
    s_cmp_eq_u32 s56, 3
    s_cselect_b32 s64, 0, s64
    v_mul_u32_u24 v3, s101, v14
    v_add_u32 v2, v2, v3
    v_cmp_gt_u32 vcc, s64, v15
    v_mov_b32 v3, 2130706432
    s_add_u32 m0, s72, 32768
    s_movk_i32 s69, 128
    buffer_load_dwordx4 v90, s[24:27], s69 offen offset:0 lds
    v_cndmask_b32 v104, v3, v2, vcc
    s_mul_i32 s100, s101, 1
    s_waitcnt vmcnt(12)
    buffer_load_dword v10, v104, s[44:47], s100 offen
    v_and_b32 v6, 1, v11
    v_lshlrev_b32 v6, 2, v6
    v_and_b32 v7, 7, v1
    v_cmp_eq_u32 vcc, v6, v7
    v_mov_b32 v6, 0x3f803f80
    s_nop 0
    v_cndmask_b32 v20, 0, v6, vcc
    v_cndmask_b32 v21, 0, v6, vcc
    v_cndmask_b32 v22, 0, v6, vcc
    v_cndmask_b32 v23, 0, v6, vcc
    v_lshlrev_b32 v6, 7, v15
    v_add_u32_e64 v6, s72, v6
    v_bfe_u32 v7, v15, 1, 3
    v_xor_b32 v7, v7, v14
    s_xor_b32 s63, s56, 0
    s_lshl_b32 s63, s63, 1
    v_xor_b32 v8, s63, v7
    v_lshl_add_u32 v105, v8, 4, v6
    s_xor_b32 s63, s56, 1
    s_lshl_b32 s63, s63, 1
    v_xor_b32_e64 v8, s63, v7
    v_lshl_add_u32 v106, v8, 4, v6
    s_xor_b32 s63, s56, 2
    s_lshl_b32 s63, s63, 1
    buffer_load_dwordx4 v91, s[24:27], s69 offen offset:1024 lds
    v_xor_b32_e64 v8, s63, v7
    v_lshl_add_u32 v107, v8, 4, v6
    s_xor_b32 s63, s56, 3
    s_lshl_b32 s63, s63, 1
    v_xor_b32_e64 v8, s63, v7
    v_lshl_add_u32 v108, v8, 4, v6
    v_lshl_add_u32 v6, v14, 3, v12
    v_mul_u32_u24 v6, 128, v6
    v_lshrrev_b32_e64 v7, 1, v12
    v_lshl_add_u32 v6, v7, 6, v6
    v_and_b32_e64 v7, 1, v11
    v_lshl_add_u32 v7, v7, 2, v13
    v_lshl_add_u32 v6, v7, 3, v6
    s_xor_b32 s63, s56, 0
    s_lshl_b32 s63, s63, 11
    v_add_u32 v109, s63, v6
    v_xor_b32 v110, 64, v109
    s_xor_b32 s63, s56, 1
    s_lshl_b32 s63, s63, 11
    v_add_u32 v111, s63, v6
    v_xor_b32 v112, 64, v111
    s_xor_b32 s63, s56, 2
    s_lshl_b32 s63, s63, 11
    v_add_u32 v113, s63, v6
    v_xor_b32 v114, 64, v113
    s_xor_b32 s63, s56, 3
    buffer_load_dwordx4 v92, s[24:27], s69 offen offset:2048 lds
    s_lshl_b32 s63, s63, 11
    v_add_u32 v115, s63, v6
    v_xor_b32 v116, 64, v115
    v_mov_b32_e64 v2, v0
    v_mul_u32_u24 v3, 656, v2
    v_lshrrev_b32_e64 v3, 16, v3
    v_mul_u32_u24 v4, 100, v3
    v_sub_u32_e64 v4, v2, v4
    v_mul_u32_u24 v5, 13108, v4
    v_lshrrev_b32 v5, 16, v5
    v_mul_u32_u24 v6, 5, v5
    v_sub_u32 v6, v4, v6
    v_and_b32 v7, 1, v3
    v_mul_u32_u24 v7, 1960, v7
    v_lshrrev_b32_e64 v3, 1, v3
    v_mul_u32_u24 v3, 3840, v3
    v_mul_u32_u24 v5, 96, v5
    v_lshl_add_u32 v5, v6, 3, v5
    v_add3_u32 v3, v3, v5, v7
    v_add_u32 v98, 147456, v3
    v_add_u32 v2, 256, v0
    v_mul_u32_u24 v3, 656, v2
    v_lshrrev_b32_e64 v3, 16, v3
    v_mul_u32_u24 v4, 100, v3
    v_sub_u32_e64 v4, v2, v4
    v_mul_u32_u24 v5, 13108, v4
    buffer_load_dwordx4 v93, s[24:27], s69 offen offset:3072 lds
    v_lshrrev_b32 v5, 16, v5
    v_mul_u32_u24 v6, 5, v5
    v_sub_u32 v6, v4, v6
    v_and_b32 v7, 1, v3
    v_mul_u32_u24 v7, 1960, v7
    v_lshrrev_b32_e64 v3, 1, v3
    v_mul_u32_u24 v3, 3840, v3
    v_mul_u32_u24 v5, 96, v5
    v_lshl_add_u32 v5, v6, 3, v5
    v_add3_u32 v3, v3, v5, v7
    v_add_u32 v99, 147456, v3
    v_cmp_gt_u32 vcc, 144, v0
    v_mov_b32 v3, 155136
    s_nop 0
    v_cndmask_b32 v99, v3, v99, vcc
    s_lshr_b32 s63, s61, 2
    s_lshl_b32 s63, s63, 4
    s_and_b32 s64, s60, 1
    s_lshl_b32 s64, s64, 3
    s_add_u32 s63, s63, s64
    s_add_u32 s63, s63, s62
    s_mul_i32 s90, s63, 6554
    s_lshr_b32 s90, s90, 16
    s_mul_i32 s64, s90, 10
    s_sub_u32 s89, s63, s64
    s_cmp_lt_u32 s90, 17
    s_cselect_b32 s68, 0, 2130706432
    s_cmp_lt_u32 s90, 12
    s_cselect_b32 s40, s16, s10
    s_cselect_b32 s41, s17, s11
    s_mov_b32 s42, 819200
    s_cselect_b32 s42, 1966080, s42
    s_cselect_b32 s64, 0, 48
    s_cselect_b32 s65, 1, 0
    s_mov_b32 s70, 196608
    s_add_u32 m0, s91, 49152
    s_nop 0
    buffer_load_dwordx4 v94, s[32:35], s70 offen offset:0 lds
    s_and_b32 s41, s41, 0xffff
    s_mov_b32 s43, 0x20000
    s_lshl_b32 s66, s90, 2
    s_add_u32 s66, s66, s56
    s_sub_u32 s64, s66, s64
    s_mul_i32 s63, s90, 86
    s_lshr_b32 s63, s63, 8
    s_sub_u32 s67, s90, s63
    s_sub_u32 s67, s67, 1
    s_mul_i32 s66, s63, 3
    s_add_u32 s63, s63, 8
    s_cmp_eq_u32 s66, s90
    s_cselect_b32 s67, s63, s67
    s_cmp_lt_u32 s90, 12
    s_cselect_b32 s67, s67, s90
    s_lshl_b32 s66, s67, 2
    s_add_u32 s66, s66, s56
    s_mul_i32 s64, s64, 40960
    s_lshl_b32 s63, s89, 7
    s_add_u32 s64, s64, s63
    buffer_load_dwordx4 v95, s[32:35], s70 offen offset:1024 lds
    s_add_u32 s64, s64, s68
    v_lshrrev_b32 v6, 3, v1
    v_mul_u32_u24 v6, 1280, v6
    v_and_b32_e64 v7, 7, v1
    v_lshl_add_u32 v6, v7, 4, v6
    v_add_u32 v117, s64, v6
    v_and_b32 v6, 1, v11
    v_lshlrev_b32_e64 v6, 2, v6
    v_lshl_add_u32 v6, v14, 4, v6
    v_lshlrev_b32 v7, 3, v11
    s_cmp_eq_u32 s65, 1
    s_cselect_b64 vcc, -1, 0
    s_cselect_b32 s63, 2, 1
    s_lshl_b32 s63, s63, 9
    v_cndmask_b32 v6, v7, v6, vcc
    v_add_u32 v6, v6, v12
    v_lshlrev_b32 v6, 7, v6
    v_lshl_add_u32 v6, v13, 3, v6
    s_add_u32 s64, s72, 147456
    v_add_u32 v118, s64, v6
    v_add_u32 v119, s63, v118
    v_lshlrev_b32 v6, 4, v1
    s_lshl_b32 s63, s89, 2
    s_add_u32 s63, s63, 0
    s_mul_i32 s64, s63, 13108
    s_lshr_b32 s64, s64, 16
    s_add_u32 m0, s91, 57344
    s_nop 0
    buffer_load_dwordx4 v96, s[32:35], s70 offen offset:0 lds
    s_mul_i32 s65, s64, 335
    s_add_u32 s63, s63, s65
    s_mul_i32 s65, s66, 5
    s_add_u32 s63, s63, s65
    s_lshl_b32 s63, s63, 10
    s_add_u32 s63, s63, 8912896
    s_add_u32 s63, s63, s68
    v_add_u32 v120, s63, v6
    s_lshl_b32 s63, s89, 2
    s_add_u32 s63, s63, 1
    s_mul_i32 s64, s63, 13108
    s_lshr_b32 s64, s64, 16
    s_mul_i32 s65, s64, 335
    s_add_u32 s63, s63, s65
    s_mul_i32 s65, s66, 5
    s_add_u32 s63, s63, s65
    s_lshl_b32 s63, s63, 10
    s_add_u32 s63, s63, 8912896
    s_add_u32 s63, s63, s68
    v_add_u32 v121, s63, v6
    s_lshl_b32 s63, s89, 2
    s_add_u32 s63, s63, 2
    s_mul_i32 s64, s63, 13108
    s_lshr_b32 s64, s64, 16
    s_mul_i32 s65, s64, 335
    s_add_u32 s63, s63, s65
    buffer_load_dwordx4 v97, s[32:35], s70 offen offset:1024 lds
    s_mul_i32 s65, s66, 5
    s_add_u32 s63, s63, s65
    s_lshl_b32 s63, s63, 10
    s_add_u32 s63, s63, 8912896
    s_add_u32 s63, s63, s68
    v_add_u32 v122, s63, v6
    s_lshl_b32 s63, s89, 2
    s_add_u32 s63, s63, 3
    s_mul_i32 s64, s63, 13108
    s_lshr_b32 s64, s64, 16
    s_mul_i32 s65, s64, 335
    s_add_u32 s63, s63, s65
    s_mul_i32 s65, s66, 5
    s_add_u32 s63, s63, s65
    s_lshl_b32 s63, s63, 10
    s_add_u32 s63, s63, 8912896
    s_add_u32 s63, s63, s68
    v_add_u32 v123, s63, v6
    s_lshl_b32 s63, s89, 7
    s_lshl_b32 s64, s90, 2
    s_add_u32 s63, s63, s64
    s_add_u32 s63, s63, 13547520
    s_add_u32 s63, s63, s68
    v_cmp_eq_u32 vcc, 0, v0
    v_mov_b32 v6, s63
    v_mov_b32 v124, 2130706432
    v_cndmask_b32 v124, v124, v6, vcc
    s_lshl_b32 s63, s59, 2
    s_add_u32 s63, s63, s60
    s_lshl_b32 s63, s63, 2
    s_add_u32 s63, s63, s56
    s_lshl_b32 s64, s57, 6
    s_add_u32 s63, s63, s64
    s_lshl_b32 s63, s63, 1
    v_lshrrev_b32 v2, 5, v1
    v_add_u32 v125, s63, v2
    v_mul_u32_u24 v2, 1280, v125
    v_and_b32_e64 v3, 31, v1
    v_lshl_add_u32 v2, v3, 4, v2
    v_cmp_gt_u32_e64 vcc, 16, v3
    v_mov_b32 v4, 2130706432
    buffer_load_dwordx4 v[128:131], v2, s[24:27], 0 offen
    v_cndmask_b32_e64 v4, v4, v2, vcc
    buffer_load_dwordx4 v[132:135], v2, s[24:27], 0 offen offset:512
    buffer_load_dwordx4 v[136:139], v4, s[24:27], 0 offen offset:1024
    s_mul_i32 s100, s101, 3
    s_waitcnt vmcnt(10)
    buffer_load_dword v10, v104, s[44:47], s100 offen
    s_barrier
    ds_read_b128 a[0:3], v105 offset:0
    ds_read_b64_tr_b16 a[160:161], v109 offset:16384
    ds_read_b64_tr_b16 a[162:163], v109 offset:16896
    ds_read_b64_tr_b16 a[164:165], v110 offset:16384
    ds_read_b64_tr_b16 a[166:167], v110 offset:16896
    ds_read_b64_tr_b16 a[168:169], v109 offset:24576
    ds_read_b64_tr_b16 a[170:171], v109 offset:25088
    ds_read_b64_tr_b16 a[172:173], v110 offset:24576
    ds_read_b64_tr_b16 a[174:175], v110 offset:25088
    s_waitcnt lgkmcnt(4)
    v_mfma_f32_32x32x16_bf16 v[192:207], a[160:163], a[0:3], 0
    ds_read_b128 a[4:7], v106 offset:0
    ds_read_b64_tr_b16 a[176:177], v111 offset:16384
    ds_read_b64_tr_b16 a[178:179], v111 offset:16896
    ds_read_b64_tr_b16 a[180:181], v112 offset:16384
    ds_read_b64_tr_b16 a[182:183], v112 offset:16896
    ds_read_b64_tr_b16 a[184:185], v111 offset:24576
    s_add_u32 m0, s72, 65536
    s_movk_i32 s69, 256
    v_mfma_f32_32x32x16_bf16 v[208:223], a[164:167], a[0:3], 0
    ds_read_b64_tr_b16 a[186:187], v111 offset:25088
    ds_read_b64_tr_b16 a[188:189], v112 offset:24576
    ds_read_b64_tr_b16 a[190:191], v112 offset:25088
    buffer_load_dwordx4 v90, s[24:27], s69 offen offset:0 lds
    v_mov_b32 v140, 0
    v_mov_b32 v141, 0
    v_mov_b32 v142, 0
    s_waitcnt lgkmcnt(9)
    v_mfma_f32_32x32x16_bf16 v[224:239], a[168:171], a[0:3], 0
    buffer_load_dwordx4 v91, s[24:27], s69 offen offset:1024 lds
    v_mov_b32 v143, 0
    v_lshlrev_b32_e64 v2, 4, v0
    v_add_u32 v2, 147456, v2
    ds_write_b128 v2, v[140:143] offset:0
    ds_write_b128 v2, v[140:143] offset:4096
    ds_write_b128 v2, v[140:143] offset:8192
    s_mov_b32 s88, 0xffffff00
    v_mfma_f32_32x32x16_bf16 v[240:255], a[172:175], a[0:3], 0
    buffer_load_dwordx4 v92, s[24:27], s69 offen offset:2048 lds
    s_mov_b32 s76, 0x7060500
    s_mov_b32 s77, 0x7060501
    s_mov_b32 s78, 0x7060502
    s_mov_b32 s79, 0x7060503
    s_mov_b32 s48, s18
    s_and_b32 s49, s19, 0xffff
    s_mov_b32 s50, 2621440
    v_mfma_f32_16x16x32_bf16 v[176:179], v[20:23], a[160:163], 0
    s_mov_b32 s51, 0x20000
    v_mfma_f32_16x16x32_bf16 v[180:183], v[20:23], a[164:167], 0
    v_mfma_f32_16x16x32_bf16 v[184:187], v[20:23], a[168:171], 0
    buffer_load_dwordx4 v93, s[24:27], s69 offen offset:3072 lds
    v_mfma_f32_16x16x32_bf16 v[188:191], v[20:23], a[172:175], 0
    s_waitcnt lgkmcnt(7)
    v_mfma_f32_32x32x16_bf16 v[192:207], a[176:179], a[4:7], v[192:207]
    ds_read_b128 a[8:11], v107 offset:0
    ds_read_b64_tr_b16 a[160:161], v113 offset:16384
    ds_read_b64_tr_b16 a[162:163], v113 offset:16896
    ds_read_b64_tr_b16 a[164:165], v114 offset:16384
    ds_read_b64_tr_b16 a[166:167], v114 offset:16896
    ds_read_b64_tr_b16 a[168:169], v113 offset:24576
    v_mfma_f32_32x32x16_bf16 v[208:223], a[180:183], a[4:7], v[208:223]
    ds_read_b64_tr_b16 a[170:171], v113 offset:25088
    ds_read_b64_tr_b16 a[172:173], v114 offset:24576
    ds_read_b64_tr_b16 a[174:175], v114 offset:25088
    s_mov_b32 s70, 393216
    s_add_u32 m0, s91, 81920
    s_nop 0
    buffer_load_dwordx4 v94, s[32:35], s70 offen offset:0 lds
    s_waitcnt lgkmcnt(12)
    v_mfma_f32_32x32x16_bf16 v[224:239], a[184:187], a[4:7], v[224:239]
    buffer_load_dwordx4 v95, s[32:35], s70 offen offset:1024 lds
    v_mfma_f32_32x32x16_bf16 v[240:255], a[188:191], a[4:7], v[240:255]
    s_waitcnt lgkmcnt(4)
    v_mfma_f32_32x32x16_bf16 v[192:207], a[160:163], a[8:11], v[192:207]
    ds_read_b128 a[12:15], v108 offset:0
    ds_read_b64_tr_b16 a[176:177], v115 offset:16384
    ds_read_b64_tr_b16 a[178:179], v115 offset:16896
    ds_read_b64_tr_b16 a[180:181], v116 offset:16384
    ds_read_b64_tr_b16 a[182:183], v116 offset:16896
    ds_read_b64_tr_b16 a[184:185], v115 offset:24576
    s_add_u32 m0, s91, 90112
    s_nop 0
    buffer_load_dwordx4 v96, s[32:35], s70 offen offset:0 lds
    v_mfma_f32_32x32x16_bf16 v[208:223], a[164:167], a[8:11], v[208:223]
    ds_read_b64_tr_b16 a[186:187], v115 offset:25088
    ds_read_b64_tr_b16 a[188:189], v116 offset:24576
    ds_read_b64_tr_b16 a[190:191], v116 offset:25088
    s_waitcnt lgkmcnt(9)
    v_mfma_f32_32x32x16_bf16 v[224:239], a[168:171], a[8:11], v[224:239]
    buffer_load_dwordx4 v97, s[32:35], s70 offen offset:1024 lds
    v_mfma_f32_32x32x16_bf16 v[240:255], a[172:175], a[8:11], v[240:255]
    s_waitcnt vmcnt(12) lgkmcnt(0)
    s_barrier
    v_mfma_f32_32x32x16_bf16 v[192:207], a[176:179], a[12:15], v[192:207]
    ds_read_b128 a[16:19], v105 offset:32768
    ds_read_b64_tr_b16 a[160:161], v109 offset:49152
    ds_read_b64_tr_b16 a[162:163], v109 offset:49664
    ds_read_b64_tr_b16 a[164:165], v110 offset:49152
    ds_read_b64_tr_b16 a[166:167], v110 offset:49664
    ds_read_b64_tr_b16 a[168:169], v109 offset:57344
    s_mul_i32 s100, s101, 5
    s_waitcnt vmcnt(8)
    buffer_load_dword v10, v104, s[44:47], s100 offen
    v_mfma_f32_32x32x16_bf16 v[208:223], a[180:183], a[12:15], v[208:223]
    ds_read_b64_tr_b16 a[170:171], v109 offset:57856
    ds_read_b64_tr_b16 a[172:173], v110 offset:57344
    ds_read_b64_tr_b16 a[174:175], v110 offset:57856
    v_add_u32 v105, 65536, v105
    v_add_u32 v109, 81920, v109
    v_add_u32 v110, 81920, v110
    s_add_u32 m0, s72, 98304
    v_mfma_f32_32x32x16_bf16 v[224:239], a[184:187], a[12:15], v[224:239]
    s_movk_i32 s69, 384
    buffer_load_dwordx4 v90, s[24:27], s69 offen offset:0 lds
    buffer_load_dword v16, off, s[52:55], 0 sc1
    ds_write_b64 v98, v[100:101]
    ds_write_b64 v99, v[102:103]
    v_mfma_f32_32x32x16_bf16 v[240:255], a[188:191], a[12:15], v[240:255]
    buffer_load_dwordx4 v91, s[24:27], s69 offen offset:1024 lds
    s_waitcnt lgkmcnt(6)
    v_mfma_f32_32x32x16_bf16 v[192:207], a[160:163], a[16:19], v[192:207]
    ds_read_b128 a[20:23], v106 offset:32768
    ds_read_b64_tr_b16 a[176:177], v111 offset:49152
    ds_read_b64_tr_b16 a[178:179], v111 offset:49664
    ds_read_b64_tr_b16 a[180:181], v112 offset:49152
    ds_read_b64_tr_b16 a[182:183], v112 offset:49664
    ds_read_b64_tr_b16 a[184:185], v111 offset:57344
    v_mfma_f32_32x32x16_bf16 v[208:223], a[164:167], a[16:19], v[208:223]
    ds_read_b64_tr_b16 a[186:187], v111 offset:57856
    ds_read_b64_tr_b16 a[188:189], v112 offset:57344
    ds_read_b64_tr_b16 a[190:191], v112 offset:57856
    v_add_u32 v106, 65536, v106
    v_add_u32 v111, 81920, v111
    v_add_u32 v112, 81920, v112
    buffer_load_dwordx4 v92, s[24:27], s69 offen offset:2048 lds
    s_waitcnt lgkmcnt(11)
    v_mfma_f32_32x32x16_bf16 v[224:239], a[168:171], a[16:19], v[224:239]
    v_mfma_f32_32x32x16_bf16 v[240:255], a[172:175], a[16:19], v[240:255]
    buffer_load_dwordx4 v93, s[24:27], s69 offen offset:3072 lds
    v_mfma_f32_16x16x32_bf16 v[176:179], v[20:23], a[160:163], v[176:179]
    v_mfma_f32_16x16x32_bf16 v[180:183], v[20:23], a[164:167], v[180:183]
    s_mov_b32 s70, 589824
    s_add_u32 m0, s91, 114688
    v_mfma_f32_16x16x32_bf16 v[184:187], v[20:23], a[168:171], v[184:187]
    buffer_load_dwordx4 v94, s[32:35], s70 offen offset:0 lds
    v_mfma_f32_16x16x32_bf16 v[188:191], v[20:23], a[172:175], v[188:191]
    s_waitcnt lgkmcnt(4)
    v_mfma_f32_32x32x16_bf16 v[192:207], a[176:179], a[20:23], v[192:207]
    ds_read_b128 a[24:27], v107 offset:32768
    ds_read_b64_tr_b16 a[160:161], v113 offset:49152
    ds_read_b64_tr_b16 a[162:163], v113 offset:49664
    ds_read_b64_tr_b16 a[164:165], v114 offset:49152
    ds_read_b64_tr_b16 a[166:167], v114 offset:49664
    ds_read_b64_tr_b16 a[168:169], v113 offset:57344
    buffer_load_dwordx4 v95, s[32:35], s70 offen offset:1024 lds
    v_mfma_f32_32x32x16_bf16 v[208:223], a[180:183], a[20:23], v[208:223]
    ds_read_b64_tr_b16 a[170:171], v113 offset:57856
    ds_read_b64_tr_b16 a[172:173], v114 offset:57344
    ds_read_b64_tr_b16 a[174:175], v114 offset:57856
    v_add_u32 v107, 65536, v107
    v_add_u32 v113, 81920, v113
    v_add_u32 v114, 81920, v114
    s_waitcnt lgkmcnt(9)
    v_mfma_f32_32x32x16_bf16 v[224:239], a[184:187], a[20:23], v[224:239]
    s_add_u32 m0, s91, 122880
    s_nop 0
    buffer_load_dwordx4 v96, s[32:35], s70 offen offset:0 lds
    v_mfma_f32_32x32x16_bf16 v[240:255], a[188:191], a[20:23], v[240:255]
    s_waitcnt lgkmcnt(4)
    v_mfma_f32_32x32x16_bf16 v[192:207], a[160:163], a[24:27], v[192:207]
    ds_read_b128 a[28:31], v108 offset:32768
    ds_read_b64_tr_b16 a[176:177], v115 offset:49152
    ds_read_b64_tr_b16 a[178:179], v115 offset:49664
    ds_read_b64_tr_b16 a[180:181], v116 offset:49152
    ds_read_b64_tr_b16 a[182:183], v116 offset:49664
    ds_read_b64_tr_b16 a[184:185], v115 offset:57344
    buffer_load_dwordx4 v97, s[32:35], s70 offen offset:1024 lds
    v_mfma_f32_32x32x16_bf16 v[208:223], a[164:167], a[24:27], v[208:223]
    ds_read_b64_tr_b16 a[186:187], v115 offset:57856
    ds_read_b64_tr_b16 a[188:189], v116 offset:57344
    ds_read_b64_tr_b16 a[190:191], v116 offset:57856
    v_add_u32 v108, 65536, v108
    v_add_u32 v115, 81920, v115
    v_add_u32 v116, 81920, v116
    s_mul_i32 s100, s101, 7
    s_waitcnt lgkmcnt(9)
    v_mfma_f32_32x32x16_bf16 v[224:239], a[168:171], a[24:27], v[224:239]
    s_waitcnt vmcnt(9)
    buffer_load_dword v10, v104, s[44:47], s100 offen
    v_mfma_f32_32x32x16_bf16 v[240:255], a[172:175], a[24:27], v[240:255]
    s_waitcnt lgkmcnt(0)
    s_barrier
    v_mfma_f32_32x32x16_bf16 v[192:207], a[176:179], a[28:31], v[192:207]
    ds_read_b128 a[32:35], v105 offset:0
    ds_read_b64_tr_b16 a[160:161], v109 offset:0
    ds_read_b64_tr_b16 a[162:163], v109 offset:512
    ds_read_b64_tr_b16 a[164:165], v110 offset:0
    ds_read_b64_tr_b16 a[166:167], v110 offset:512
    ds_read_b64_tr_b16 a[168:169], v109 offset:8192
    s_add_u32 m0, s72, 0
    s_movk_i32 s69, 512
    v_mfma_f32_32x32x16_bf16 v[208:223], a[180:183], a[28:31], v[208:223]
    ds_read_b64_tr_b16 a[170:171], v109 offset:8704
    ds_read_b64_tr_b16 a[172:173], v110 offset:8192
    ds_read_b64_tr_b16 a[174:175], v110 offset:8704
    buffer_load_dwordx4 v90, s[24:27], s69 offen offset:0 lds
    v_and_b32 v2, 1, v13
    v_cmp_eq_u32_e64 vcc, v2, v14
    v_mul_u32_u24 v2, 3840, v14
    v_mfma_f32_32x32x16_bf16 v[224:239], a[184:187], a[28:31], v[224:239]
    buffer_load_dwordx4 v91, s[24:27], s69 offen offset:1024 lds
    v_mul_u32_u24 v3, 96, v12
    v_and_b32 v4, 1, v11
    v_lshlrev_b32 v4, 1, v4
    v_lshrrev_b32 v5, 1, v13
    v_add_u32 v4, v4, v5
    v_mfma_f32_32x32x16_bf16 v[240:255], a[188:191], a[28:31], v[240:255]
    buffer_load_dwordx4 v92, s[24:27], s69 offen offset:2048 lds
    v_lshl_add_u32 v3, v4, 3, v3
    v_add_u32_e64 v2, v2, v3
    v_mov_b32 v3, 7680
    v_cndmask_b32_e64 v2, v3, v2, vcc
    v_add_u32 v98, 147456, v2
    ds_read_b64_tr_b16 a[200:201], v98 offset:0
    s_waitcnt lgkmcnt(5)
    v_mfma_f32_32x32x16_bf16 v[192:207], a[160:163], a[32:35], v[192:207]
    ds_read_b128 a[36:39], v106 offset:0
    ds_read_b64_tr_b16 a[176:177], v111 offset:0
    ds_read_b64_tr_b16 a[178:179], v111 offset:512
    ds_read_b64_tr_b16 a[180:181], v112 offset:0
    ds_read_b64_tr_b16 a[182:183], v112 offset:512
    ds_read_b64_tr_b16 a[184:185], v111 offset:8192
    ds_read_b64_tr_b16 a[202:203], v98 offset:384
    ds_read_b64_tr_b16 a[204:205], v98 offset:768
    v_mfma_f32_32x32x16_bf16 v[208:223], a[164:167], a[32:35], v[208:223]
    ds_read_b64_tr_b16 a[186:187], v111 offset:8704
    ds_read_b64_tr_b16 a[188:189], v112 offset:8192
    ds_read_b64_tr_b16 a[190:191], v112 offset:8704
    buffer_load_dwordx4 v93, s[24:27], s69 offen offset:3072 lds
    ds_read_b64_tr_b16 a[206:207], v98 offset:1152
    ds_read_b64_tr_b16 a[208:209], v98 offset:1536
    ds_read_b64_tr_b16 a[210:211], v98 offset:1920
    s_waitcnt lgkmcnt(15)
    v_mfma_f32_32x32x16_bf16 v[224:239], a[168:171], a[32:35], v[224:239]
    ds_read_b64_tr_b16 a[212:213], v98 offset:32
    ds_read_b64_tr_b16 a[214:215], v98 offset:416
    ds_read_b64_tr_b16 a[216:217], v98 offset:800
    ds_read_b64_tr_b16 a[218:219], v98 offset:1184
    ds_read_b64_tr_b16 a[220:221], v98 offset:1568
    ds_read_b64_tr_b16 a[222:223], v98 offset:1952
    ds_read_b64_tr_b16 a[224:225], v98 offset:2336
    ds_read_b64_tr_b16 a[226:227], v98 offset:2720
    v_mfma_f32_32x32x16_bf16 v[240:255], a[172:175], a[32:35], v[240:255]
    s_mov_b32 s70, 786432
    s_add_u32 m0, s91, 16384
    s_nop 0
    buffer_load_dwordx4 v94, s[32:35], s70 offen offset:0 lds
    ds_read_b64_tr_b16 a[228:229], v98 offset:3104
    ds_read_b64_tr_b16 a[230:231], v98 offset:3488
    ds_read_b64_tr_b16 a[232:233], v98 offset:1600
    ds_read_b64_tr_b16 a[234:235], v98 offset:1984
    ds_read_b64_tr_b16 a[236:237], v98 offset:2368
    v_mfma_f32_16x16x32_bf16 v[176:179], v[20:23], a[160:163], v[176:179]
    ds_read_b64_tr_b16 a[238:239], v98 offset:2752
    ds_read_b64_tr_b16 a[240:241], v98 offset:3136
    v_mfma_f32_16x16x32_bf16 v[180:183], v[20:23], a[164:167], v[180:183]
    buffer_load_dwordx4 v95, s[32:35], s70 offen offset:1024 lds
    ds_read_b64_tr_b16 a[242:243], v98 offset:3520
    v_mfma_f32_16x16x32_bf16 v[184:187], v[20:23], a[168:171], v[184:187]
    v_mov_b32 v4, 0x3f803f80
    v_mov_b32 v2, 0
    v_mov_b32 v3, 0
    v_dot2c_f32_bf16 v2, v4, v128
    v_dot2c_f32_bf16 v3, v128, v128
    v_dot2c_f32_bf16 v2, v4, v129
    v_dot2c_f32_bf16 v3, v129, v129
    v_dot2c_f32_bf16 v2, v4, v130
    v_dot2c_f32_bf16 v3, v130, v130
    v_dot2c_f32_bf16 v2, v4, v131
    v_dot2c_f32_bf16 v3, v131, v131
    v_dot2c_f32_bf16 v2, v4, v132
    v_dot2c_f32_bf16 v3, v132, v132
    v_dot2c_f32_bf16 v2, v4, v133
    v_dot2c_f32_bf16 v3, v133, v133
    v_dot2c_f32_bf16 v2, v4, v134
    v_dot2c_f32_bf16 v3, v134, v134
    v_dot2c_f32_bf16 v2, v4, v135
    v_dot2c_f32_bf16 v3, v135, v135
    v_dot2c_f32_bf16 v2, v4, v136
    v_dot2c_f32_bf16 v3, v136, v136
    v_dot2c_f32_bf16 v2, v4, v137
    v_dot2c_f32_bf16 v3, v137, v137
    v_dot2c_f32_bf16 v2, v4, v138
    v_dot2c_f32_bf16 v3, v138, v138
    v_dot2c_f32_bf16 v2, v4, v139
    v_dot2c_f32_bf16 v3, v139, v139
    v_mfma_f32_16x16x32_bf16 v[188:191], v[20:23], a[172:175], v[188:191]
    s_nop 0
    v_add_f32_dpp v2, v2, v2 row_ror:8 row_mask:0xf bank_mask:0xf
    s_waitcnt lgkmcnt(15)
    v_mfma_f32_32x32x16_bf16 v[192:207], a[176:179], a[36:39], v[192:207]
    ds_read_b128 a[40:43], v107 offset:0
    ds_read_b64_tr_b16 a[160:161], v113 offset:0
    ds_read_b64_tr_b16 a[162:163], v113 offset:512
    ds_read_b64_tr_b16 a[164:165], v114 offset:0
    ds_read_b64_tr_b16 a[166:167], v114 offset:512
    ds_read_b64_tr_b16 a[168:169], v113 offset:8192
    s_add_u32 m0, s91, 24576
    s_nop 0
    buffer_load_dwordx4 v96, s[32:35], s70 offen offset:0 lds
    v_mfma_f32_32x32x16_bf16 v[208:223], a[180:183], a[36:39], v[208:223]
    ds_read_b64_tr_b16 a[170:171], v113 offset:8704
    ds_read_b64_tr_b16 a[172:173], v114 offset:8192
    ds_read_b64_tr_b16 a[174:175], v114 offset:8704
    v_add_f32_dpp v3, v3, v3 row_ror:8 row_mask:0xf bank_mask:0xf
    v_add_f32_dpp v2, v2, v2 row_ror:4 row_mask:0xf bank_mask:0xf
    s_nop 0
    v_add_f32_dpp v3, v3, v3 row_ror:4 row_mask:0xf bank_mask:0xf
    v_add_f32_dpp v2, v2, v2 row_ror:2 row_mask:0xf bank_mask:0xf
    v_mfma_f32_32x32x16_bf16 v[224:239], a[184:187], a[36:39], v[224:239]
    buffer_load_dwordx4 v97, s[32:35], s70 offen offset:1024 lds
    v_add_f32_dpp v3, v3, v3 row_ror:2 row_mask:0xf bank_mask:0xf
    v_add_f32_dpp v2, v2, v2 row_ror:1 row_mask:0xf bank_mask:0xf
    s_nop 0
    v_add_f32_dpp v3, v3, v3 row_ror:1 row_mask:0xf bank_mask:0xf
    v_mov_b32 v4, v2
    v_mov_b32 v5, v3
    v_mfma_f32_32x32x16_bf16 v[240:255], a[188:191], a[36:39], v[240:255]
    v_permlane16_swap_b32 v4, v2
    v_permlane16_swap_b32 v5, v3
    v_add_f32 v2, v4, v2
    v_add_f32 v3, v5, v3
    v_mul_f32 v128, 0xbacccccd, v2
    s_waitcnt lgkmcnt(4)
    v_mfma_f32_32x32x16_bf16 v[192:207], a[160:163], a[40:43], v[192:207]
    ds_read_b128 a[44:47], v108 offset:0
    ds_read_b64_tr_b16 a[176:177], v115 offset:0
    ds_read_b64_tr_b16 a[178:179], v115 offset:512
    ds_read_b64_tr_b16 a[180:181], v116 offset:0
    ds_read_b64_tr_b16 a[182:183], v116 offset:512
    ds_read_b64_tr_b16 a[184:185], v115 offset:8192
    s_mul_i32 s100, s101, 8
    s_waitcnt vmcnt(8)
    buffer_load_dword v10, v104, s[44:47], s100 offen
    v_mfma_f32_32x32x16_bf16 v[208:223], a[164:167], a[40:43], v[208:223]
    ds_read_b64_tr_b16 a[186:187], v115 offset:8704
    ds_read_b64_tr_b16 a[188:189], v116 offset:8192
    ds_read_b64_tr_b16 a[190:191], v116 offset:8704
    v_mul_f32 v3, 0x3acccccd, v3
    v_fma_f32 v3, -v128, v128, v3
    v_max_f32 v3, 0, v3
    v_add_f32 v3, 0x3727c5ac, v3
    s_waitcnt lgkmcnt(9)
    v_mfma_f32_32x32x16_bf16 v[224:239], a[168:171], a[40:43], v[224:239]
    v_rsq_f32 v129, v3
    v_and_b32 v4, 31, v1
    v_cmp_eq_u32 vcc, 0, v4
    v_mul_f32_e64 v130, v3, v129
    v_mfma_f32_32x32x16_bf16 v[240:255], a[172:175], a[40:43], v[240:255]
    v_mul_f32 v131, 0x3fb8aa3b, v129
    v_lshlrev_b32_e64 v125, 4, v125
    v_add_u32 v125, 13549568, v125
    v_mov_b32 v4, 2130706432
    v_cndmask_b32 v125, v4, v125, vcc
    s_mov_b32 s80, 0
    v_cmp_eq_u32 vcc, 0, v16
    s_nop 0
    s_cbranch_vccz L_ok_nonB
L_retry_nonB:
    s_sleep 1
    buffer_load_dword v16, off, s[52:55], 0 sc1
    s_waitcnt vmcnt(0)
    v_cmp_eq_u32 vcc, 0, v16
    s_add_u32 s80, s80, 1
    s_cmp_lt_u32 s80, 100000
    s_cselect_b64 s[82:83], vcc, 0
    s_cmp_lg_u64 s[82:83], 0
    s_cbranch_scc1 L_retry_nonB
    s_nop 4
L_ok_nonB:
    s_waitcnt lgkmcnt(0)
    s_barrier
    v_mfma_f32_32x32x16_bf16 v[192:207], a[176:179], a[44:47], v[192:207]
    ds_read_b128 a[48:51], v105 offset:32768
    ds_read_b64_tr_b16 a[160:161], v109 offset:32768
    ds_read_b64_tr_b16 a[162:163], v109 offset:33280
    ds_read_b64_tr_b16 a[164:165], v110 offset:32768
    ds_read_b64_tr_b16 a[166:167], v110 offset:33280
    ds_read_b64_tr_b16 a[168:169], v109 offset:40960
    s_add_u32 m0, s72, 32768
    s_movk_i32 s69, 640
    v_mfma_f32_32x32x16_bf16 v[208:223], a[180:183], a[44:47], v[208:223]
    ds_read_b64_tr_b16 a[170:171], v109 offset:41472
    ds_read_b64_tr_b16 a[172:173], v110 offset:40960
    ds_read_b64_tr_b16 a[174:175], v110 offset:41472
    v_subrev_u32 v105, 65536, v105
    v_subrev_u32 v109, 65536, v109
    v_subrev_u32 v110, 65536, v110
    buffer_load_dwordx4 v90, s[24:27], s69 offen offset:0 lds
    v_mfma_f32_32x32x16_bf16 v[224:239], a[184:187], a[44:47], v[224:239]
    buffer_load_dwordx4 v91, s[24:27], s69 offen offset:1024 lds
    v_perm_b32 v128, v128, v16, s76
    v_perm_b32 v129, v129, v16, s77
    v_perm_b32 v130, v130, v16, s78
    v_perm_b32 v131, v131, v16, s79
    buffer_store_dwordx4 v[128:131], v125, s[36:39], 0 offen sc1
    s_mov_b32 s28, s6
    s_and_b32 s29, s7, 0xffff
    v_mfma_f32_32x32x16_bf16 v[240:255], a[188:191], a[44:47], v[240:255]
    buffer_load_dwordx4 v92, s[24:27], s69 offen offset:2048 lds
    s_mov_b32 s30, 2457600
    s_mov_b32 s31, 0x20000
    s_mul_i32 s63, s58, 160
    s_mul_i32 s64, s56, 61440
    s_add_u32 s63, s63, s64
    v_add_u32 v2, 0, v1
    s_waitcnt lgkmcnt(4)
    v_mfma_f32_32x32x16_bf16 v[192:207], a[160:163], a[48:51], v[192:207]
    ds_read_b128 a[52:55], v106 offset:32768
    ds_read_b64_tr_b16 a[176:177], v111 offset:32768
    ds_read_b64_tr_b16 a[178:179], v111 offset:33280
    ds_read_b64_tr_b16 a[180:181], v112 offset:32768
    ds_read_b64_tr_b16 a[182:183], v112 offset:33280
    ds_read_b64_tr_b16 a[184:185], v111 offset:40960
    v_mul_u32_u24 v6, 5462, v2
    v_lshrrev_b32_e64 v6, 16, v6
    v_mfma_f32_32x32x16_bf16 v[208:223], a[164:167], a[48:51], v[208:223]
    ds_read_b64_tr_b16 a[186:187], v111 offset:41472
    ds_read_b64_tr_b16 a[188:189], v112 offset:40960
    ds_read_b64_tr_b16 a[190:191], v112 offset:41472
    v_subrev_u32 v106, 65536, v106
    v_subrev_u32 v111, 65536, v111
    v_subrev_u32 v112, 65536, v112
    buffer_load_dwordx4 v93, s[24:27], s69 offen offset:3072 lds
    s_waitcnt lgkmcnt(9)
    v_mfma_f32_32x32x16_bf16 v[224:239], a[168:171], a[48:51], v[224:239]
    v_mul_u32_u24 v7, 12, v6
    v_sub_u32_e64 v7, v2, v7
    v_mul_u32_u24 v8, 10923, v7
    v_lshrrev_b32 v8, 16, v8
    v_mul_u32_u24 v9, 6, v8
    v_mfma_f32_32x32x16_bf16 v[240:255], a[172:175], a[48:51], v[240:255]
    s_mov_b32 s70, 983040
    s_add_u32 m0, s91, 49152
    s_nop 0
    buffer_load_dwordx4 v94, s[32:35], s70 offen offset:0 lds
    v_sub_u32 v9, v7, v9
    v_min_u32_e64 v9, 4, v9
    v_mul_u32_u24 v6, 3840, v6
    v_lshl_add_u32 v6, v9, 4, v6
    v_mul_u32_u24 v8, 80, v8
    v_mfma_f32_16x16x32_bf16 v[176:179], v[20:23], a[160:163], v[176:179]
    s_sub_u32 s64, s63, 0
    v_add3_u32 v17, v6, v8, s64
    v_mfma_f32_16x16x32_bf16 v[180:183], v[20:23], a[164:167], v[180:183]
    buffer_load_dwordx4 v95, s[32:35], s70 offen offset:1024 lds
    v_add_u32 v2, 64, v1
    v_mfma_f32_16x16x32_bf16 v[184:187], v[20:23], a[168:171], v[184:187]
    v_mul_u32_u24 v6, 5462, v2
    v_lshrrev_b32_e64 v6, 16, v6
    v_mfma_f32_16x16x32_bf16 v[188:191], v[20:23], a[172:175], v[188:191]
    v_mul_u32_u24 v7, 12, v6
    s_waitcnt lgkmcnt(4)
    v_mfma_f32_32x32x16_bf16 v[192:207], a[176:179], a[52:55], v[192:207]
    ds_read_b128 a[56:59], v107 offset:32768
    ds_read_b64_tr_b16 a[160:161], v113 offset:32768
    ds_read_b64_tr_b16 a[162:163], v113 offset:33280
    ds_read_b64_tr_b16 a[164:165], v114 offset:32768
    ds_read_b64_tr_b16 a[166:167], v114 offset:33280
    ds_read_b64_tr_b16 a[168:169], v113 offset:40960
    s_add_u32 m0, s91, 57344
    s_nop 0
    buffer_load_dwordx4 v96, s[32:35], s70 offen offset:0 lds
    v_mfma_f32_32x32x16_bf16 v[208:223], a[180:183], a[52:55], v[208:223]
    ds_read_b64_tr_b16 a[170:171], v113 offset:41472
    ds_read_b64_tr_b16 a[172:173], v114 offset:40960
    ds_read_b64_tr_b16 a[174:175], v114 offset:41472
    v_subrev_u32 v107, 65536, v107
    v_subrev_u32 v113, 65536, v113
    v_subrev_u32 v114, 65536, v114
    v_sub_u32 v7, v2, v7
    s_waitcnt lgkmcnt(9)
    v_mfma_f32_32x32x16_bf16 v[224:239], a[184:187], a[52:55], v[224:239]
    buffer_load_dwordx4 v97, s[32:35], s70 offen offset:1024 lds
    v_mul_u32_u24 v8, 10923, v7
    v_lshrrev_b32 v8, 16, v8
    v_mul_u32_u24 v9, 6, v8
    v_sub_u32 v9, v7, v9
    v_min_u32_e64 v9, 4, v9
    v_mfma_f32_32x32x16_bf16 v[240:255], a[188:191], a[52:55], v[240:255]
    v_mul_u32_u24 v6, 3840, v6
    v_lshl_add_u32 v6, v9, 4, v6
    v_mul_u32_u24 v8, 80, v8
    s_sub_u32 s64, s63, 1024
    v_add3_u32 v18, v6, v8, s64
    v_add_u32 v2, 128, v1
    s_waitcnt lgkmcnt(4)
    v_mfma_f32_32x32x16_bf16 v[192:207], a[160:163], a[56:59], v[192:207]
    ds_read_b128 a[60:63], v108 offset:32768
    ds_read_b64_tr_b16 a[176:177], v115 offset:32768
    ds_read_b64_tr_b16 a[178:179], v115 offset:33280
    ds_read_b64_tr_b16 a[180:181], v116 offset:32768
    ds_read_b64_tr_b16 a[182:183], v116 offset:33280
    ds_read_b64_tr_b16 a[184:185], v115 offset:40960
    v_mul_u32_u24 v6, 5462, v2
    v_lshrrev_b32 v6, 16, v6
    v_mfma_f32_32x32x16_bf16 v[208:223], a[164:167], a[56:59], v[208:223]
    ds_read_b64_tr_b16 a[186:187], v115 offset:41472
    ds_read_b64_tr_b16 a[188:189], v116 offset:40960
    ds_read_b64_tr_b16 a[190:191], v116 offset:41472
    v_subrev_u32 v108, 65536, v108
    v_subrev_u32 v115, 65536, v115
    v_subrev_u32 v116, 65536, v116
    v_mul_u32_u24 v7, 12, v6
    s_waitcnt lgkmcnt(9)
    v_mfma_f32_32x32x16_bf16 v[224:239], a[168:171], a[56:59], v[224:239]
    v_sub_u32_e64 v7, v2, v7
    v_mul_u32_u24 v8, 10923, v7
    v_lshrrev_b32 v8, 16, v8
    v_mul_u32_u24 v9, 6, v8
    v_sub_u32_e64 v9, v7, v9
    v_mfma_f32_32x32x16_bf16 v[240:255], a[172:175], a[56:59], v[240:255]
    v_min_u32_e64 v9, 4, v9
    v_mul_u32_u24 v6, 3840, v6
    v_lshl_add_u32 v6, v9, 4, v6
    v_mul_u32_u24 v8, 80, v8
    s_sub_u32 s64, s63, 2048
    v_add3_u32 v19, v6, v8, s64
    s_waitcnt vmcnt(10) lgkmcnt(0)
    s_barrier
    v_mfma_f32_32x32x16_bf16 v[192:207], a[176:179], a[60:63], v[192:207]
    ds_read_b128 a[64:67], v105 offset:0
    ds_read_b64_tr_b16 a[160:161], v109 offset:0
    ds_read_b64_tr_b16 a[162:163], v109 offset:512
    ds_read_b64_tr_b16 a[164:165], v110 offset:0
    ds_read_b64_tr_b16 a[166:167], v110 offset:512
    ds_read_b64_tr_b16 a[168:169], v109 offset:8192
    s_add_u32 m0, s72, 65536
    s_movk_i32 s69, 768
    v_mfma_f32_32x32x16_bf16 v[208:223], a[180:183], a[60:63], v[208:223]
    ds_read_b64_tr_b16 a[170:171], v109 offset:8704
    ds_read_b64_tr_b16 a[172:173], v110 offset:8192
    ds_read_b64_tr_b16 a[174:175], v110 offset:8704
    buffer_load_dwordx4 v90, s[24:27], s69 offen offset:0 lds
    v_mfma_f32_32x32x16_bf16 v[224:239], a[184:187], a[60:63], v[224:239]
    buffer_load_dwordx4 v91, s[24:27], s69 offen offset:1024 lds
    v_mfma_f32_32x32x16_bf16 v[240:255], a[188:191], a[60:63], v[240:255]
    buffer_load_dwordx4 v92, s[24:27], s69 offen offset:2048 lds
    s_waitcnt lgkmcnt(4)
    v_mfma_f32_32x32x16_bf16 v[192:207], a[160:163], a[64:67], v[192:207]
    ds_read_b128 a[68:71], v106 offset:0
    ds_read_b64_tr_b16 a[176:177], v111 offset:0
    ds_read_b64_tr_b16 a[178:179], v111 offset:512
    ds_read_b64_tr_b16 a[180:181], v112 offset:0
    ds_read_b64_tr_b16 a[182:183], v112 offset:512
    ds_read_b64_tr_b16 a[184:185], v111 offset:8192
    v_mfma_f32_32x32x16_bf16 v[208:223], a[164:167], a[64:67], v[208:223]
    ds_read_b64_tr_b16 a[186:187], v111 offset:8704
    ds_read_b64_tr_b16 a[188:189], v112 offset:8192
    ds_read_b64_tr_b16 a[190:191], v112 offset:8704
    buffer_load_dwordx4 v93, s[24:27], s69 offen offset:3072 lds
    s_waitcnt lgkmcnt(9)
    v_mfma_f32_32x32x16_bf16 v[224:239], a[168:171], a[64:67], v[224:239]
    v_mfma_f32_32x32x16_bf16 v[240:255], a[172:175], a[64:67], v[240:255]
    s_mov_b32 s70, 1179648
    s_add_u32 m0, s91, 81920
    s_nop 0
    buffer_load_dwordx4 v94, s[32:35], s70 offen offset:0 lds
    v_mfma_f32_16x16x32_bf16 v[176:179], v[20:23], a[160:163], v[176:179]
    v_mfma_f32_16x16x32_bf16 v[180:183], v[20:23], a[164:167], v[180:183]
    buffer_load_dwordx4 v95, s[32:35], s70 offen offset:1024 lds
    v_mfma_f32_16x16x32_bf16 v[184:187], v[20:23], a[168:171], v[184:187]
    v_mfma_f32_16x16x32_bf16 v[188:191], v[20:23], a[172:175], v[188:191]
    s_waitcnt lgkmcnt(4)
    v_mfma_f32_32x32x16_bf16 v[192:207], a[176:179], a[68:71], v[192:207]
    ds_read_b128 a[72:75], v107 offset:0
    ds_read_b64_tr_b16 a[160:161], v113 offset:0
    ds_read_b64_tr_b16 a[162:163], v113 offset:512
    ds_read_b64_tr_b16 a[164:165], v114 offset:0
    ds_read_b64_tr_b16 a[166:167], v114 offset:512
    ds_read_b64_tr_b16 a[168:169], v113 offset:8192
    s_add_u32 m0, s91, 90112
    s_nop 0
    buffer_load_dwordx4 v96, s[32:35], s70 offen offset:0 lds
    v_mfma_f32_32x32x16_bf16 v[208:223], a[180:183], a[68:71], v[208:223]
    ds_read_b64_tr_b16 a[170:171], v113 offset:8704
    ds_read_b64_tr_b16 a[172:173], v114 offset:8192
    ds_read_b64_tr_b16 a[174:175], v114 offset:8704
    s_waitcnt lgkmcnt(9)
    v_mfma_f32_32x32x16_bf16 v[224:239], a[184:187], a[68:71], v[224:239]
    buffer_load_dwordx4 v97, s[32:35], s70 offen offset:1024 lds
    v_mfma_f32_32x32x16_bf16 v[240:255], a[188:191], a[68:71], v[240:255]
    s_waitcnt lgkmcnt(4)
    v_mfma_f32_32x32x16_bf16 v[192:207], a[160:163], a[72:75], v[192:207]
    ds_read_b128 a[76:79], v108 offset:0
    ds_read_b64_tr_b16 a[176:177], v115 offset:0
    ds_read_b64_tr_b16 a[178:179], v115 offset:512
    ds_read_b64_tr_b16 a[180:181], v116 offset:0
    ds_read_b64_tr_b16 a[182:183], v116 offset:512
    ds_read_b64_tr_b16 a[184:185], v115 offset:8192
    s_add_u32 m0, s72, 147456
    s_movk_i32 s71, 0
    v_mfma_f32_32x32x16_bf16 v[208:223], a[164:167], a[72:75], v[208:223]
    ds_read_b64_tr_b16 a[186:187], v115 offset:8704
    ds_read_b64_tr_b16 a[188:189], v116 offset:8192
    ds_read_b64_tr_b16 a[190:191], v116 offset:8704
    buffer_load_dwordx4 v117, s[40:43], s71 offen offset:0 lds
    s_waitcnt lgkmcnt(9)
    v_mfma_f32_32x32x16_bf16 v[224:239], a[168:171], a[72:75], v[224:239]
    s_movk_i32 s71, 9216
    buffer_load_dwordx4 v117, s[40:43], s71 offen offset:1024 lds
    v_mfma_f32_32x32x16_bf16 v[240:255], a[172:175], a[72:75], v[240:255]
    s_movk_i32 s71, 18432
    buffer_load_dwordx4 v117, s[40:43], s71 offen offset:2048 lds
    s_waitcnt vmcnt(11) lgkmcnt(0)
    s_barrier
    v_mfma_f32_32x32x16_bf16 v[192:207], a[176:179], a[76:79], v[192:207]
    ds_read_b128 a[80:83], v105 offset:32768
    ds_read_b64_tr_b16 a[160:161], v109 offset:32768
    ds_read_b64_tr_b16 a[162:163], v109 offset:33280
    ds_read_b64_tr_b16 a[164:165], v110 offset:32768
    ds_read_b64_tr_b16 a[166:167], v110 offset:33280
    ds_read_b64_tr_b16 a[168:169], v109 offset:40960
    v_mfma_f32_32x32x16_bf16 v[208:223], a[180:183], a[76:79], v[208:223]
    ds_read_b64_tr_b16 a[170:171], v109 offset:41472
    ds_read_b64_tr_b16 a[172:173], v110 offset:40960
    ds_read_b64_tr_b16 a[174:175], v110 offset:41472
    v_add_u32 v105, 65536, v105
    v_add_u32 v109, 65536, v109
    v_add_u32 v110, 65536, v110
    s_movk_i32 s71, 27648
    v_mfma_f32_32x32x16_bf16 v[224:239], a[184:187], a[76:79], v[224:239]
    buffer_load_dwordx4 v117, s[40:43], s71 offen offset:3072 lds
    v_mfma_f32_32x32x16_bf16 v[240:255], a[188:191], a[76:79], v[240:255]
    s_add_u32 m0, s72, 98304
    s_movk_i32 s69, 896
    buffer_load_dwordx4 v90, s[24:27], s69 offen offset:0 lds
    s_waitcnt lgkmcnt(4)
    v_mfma_f32_32x32x16_bf16 v[192:207], a[160:163], a[80:83], v[192:207]
    ds_read_b128 a[84:87], v106 offset:32768
    ds_read_b64_tr_b16 a[176:177], v111 offset:32768
    ds_read_b64_tr_b16 a[178:179], v111 offset:33280
    ds_read_b64_tr_b16 a[180:181], v112 offset:32768
    ds_read_b64_tr_b16 a[182:183], v112 offset:33280
    ds_read_b64_tr_b16 a[184:185], v111 offset:40960
    buffer_load_dwordx4 v91, s[24:27], s69 offen offset:1024 lds
    v_mfma_f32_32x32x16_bf16 v[208:223], a[164:167], a[80:83], v[208:223]
    ds_read_b64_tr_b16 a[186:187], v111 offset:41472
    ds_read_b64_tr_b16 a[188:189], v112 offset:40960
    ds_read_b64_tr_b16 a[190:191], v112 offset:41472
    v_add_u32 v106, 65536, v106
    v_add_u32 v111, 65536, v111
    v_add_u32 v112, 65536, v112
    s_waitcnt lgkmcnt(9)
    v_mfma_f32_32x32x16_bf16 v[224:239], a[168:171], a[80:83], v[224:239]
    buffer_load_dwordx4 v92, s[24:27], s69 offen offset:2048 lds
    v_mfma_f32_32x32x16_bf16 v[240:255], a[172:175], a[80:83], v[240:255]
    v_mfma_f32_16x16x32_bf16 v[176:179], v[20:23], a[160:163], v[176:179]
    buffer_load_dwordx4 v93, s[24:27], s69 offen offset:3072 lds
    v_mfma_f32_16x16x32_bf16 v[180:183], v[20:23], a[164:167], v[180:183]
    v_mfma_f32_16x16x32_bf16 v[184:187], v[20:23], a[168:171], v[184:187]
    v_mfma_f32_16x16x32_bf16 v[188:191], v[20:23], a[172:175], v[188:191]
    s_waitcnt lgkmcnt(4)
    v_mfma_f32_32x32x16_bf16 v[192:207], a[176:179], a[84:87], v[192:207]
    ds_read_b128 a[88:91], v107 offset:32768
    ds_read_b64_tr_b16 a[160:161], v113 offset:32768
    ds_read_b64_tr_b16 a[162:163], v113 offset:33280
    ds_read_b64_tr_b16 a[164:165], v114 offset:32768
    ds_read_b64_tr_b16 a[166:167], v114 offset:33280
    ds_read_b64_tr_b16 a[168:169], v113 offset:40960
    s_mov_b32 s70, 1376256
    s_add_u32 m0, s91, 114688
    v_mfma_f32_32x32x16_bf16 v[208:223], a[180:183], a[84:87], v[208:223]
    ds_read_b64_tr_b16 a[170:171], v113 offset:41472
    ds_read_b64_tr_b16 a[172:173], v114 offset:40960
    ds_read_b64_tr_b16 a[174:175], v114 offset:41472
    v_add_u32 v107, 65536, v107
    v_add_u32 v113, 65536, v113
    v_add_u32 v114, 65536, v114
    buffer_load_dwordx4 v94, s[32:35], s70 offen offset:0 lds
    s_waitcnt lgkmcnt(9)
    v_mfma_f32_32x32x16_bf16 v[224:239], a[184:187], a[84:87], v[224:239]
    buffer_load_dwordx4 v95, s[32:35], s70 offen offset:1024 lds
    v_mfma_f32_32x32x16_bf16 v[240:255], a[188:191], a[84:87], v[240:255]
    s_add_u32 m0, s91, 122880
    s_nop 0
    buffer_load_dwordx4 v96, s[32:35], s70 offen offset:0 lds
    s_waitcnt lgkmcnt(4)
    v_mfma_f32_32x32x16_bf16 v[192:207], a[160:163], a[88:91], v[192:207]
    ds_read_b128 a[92:95], v108 offset:32768
    ds_read_b64_tr_b16 a[176:177], v115 offset:32768
    ds_read_b64_tr_b16 a[178:179], v115 offset:33280
    ds_read_b64_tr_b16 a[180:181], v116 offset:32768
    ds_read_b64_tr_b16 a[182:183], v116 offset:33280
    ds_read_b64_tr_b16 a[184:185], v115 offset:40960
    v_mfma_f32_32x32x16_bf16 v[208:223], a[164:167], a[88:91], v[208:223]
    ds_read_b64_tr_b16 a[186:187], v115 offset:41472
    ds_read_b64_tr_b16 a[188:189], v116 offset:40960
    ds_read_b64_tr_b16 a[190:191], v116 offset:41472
    v_add_u32 v108, 65536, v108
    v_add_u32 v115, 65536, v115
    v_add_u32 v116, 65536, v116
    buffer_load_dwordx4 v97, s[32:35], s70 offen offset:1024 lds
    s_waitcnt lgkmcnt(9)
    v_mfma_f32_32x32x16_bf16 v[224:239], a[168:171], a[88:91], v[224:239]
    v_mfma_f32_32x32x16_bf16 v[240:255], a[172:175], a[88:91], v[240:255]
    s_waitcnt vmcnt(12) lgkmcnt(0)
    s_barrier
    v_mfma_f32_32x32x16_bf16 v[192:207], a[176:179], a[92:95], v[192:207]
    ds_read_b128 a[96:99], v105 offset:0
    ds_read_b64_tr_b16 a[160:161], v109 offset:0
    ds_read_b64_tr_b16 a[162:163], v109 offset:512
    ds_read_b64_tr_b16 a[164:165], v110 offset:0
    ds_read_b64_tr_b16 a[166:167], v110 offset:512
    ds_read_b64_tr_b16 a[168:169], v109 offset:8192
    s_add_u32 m0, s72, 0
    s_movk_i32 s69, 1024
    v_mfma_f32_32x32x16_bf16 v[208:223], a[180:183], a[92:95], v[208:223]
    ds_read_b64_tr_b16 a[170:171], v109 offset:8704
    ds_read_b64_tr_b16 a[172:173], v110 offset:8192
    ds_read_b64_tr_b16 a[174:175], v110 offset:8704
    buffer_load_dwordx4 v90, s[24:27], s69 offen offset:0 lds
    v_mfma_f32_32x32x16_bf16 v[224:239], a[184:187], a[92:95], v[224:239]
    buffer_load_dwordx4 v91, s[24:27], s69 offen offset:1024 lds
    v_mfma_f32_32x32x16_bf16 v[240:255], a[188:191], a[92:95], v[240:255]
    buffer_load_dwordx4 v92, s[24:27], s69 offen offset:2048 lds
    s_waitcnt lgkmcnt(4)
    v_mfma_f32_32x32x16_bf16 v[192:207], a[160:163], a[96:99], v[192:207]
    ds_read_b128 a[100:103], v106 offset:0
    ds_read_b64_tr_b16 a[176:177], v111 offset:0
    ds_read_b64_tr_b16 a[178:179], v111 offset:512
    ds_read_b64_tr_b16 a[180:181], v112 offset:0
    ds_read_b64_tr_b16 a[182:183], v112 offset:512
    ds_read_b64_tr_b16 a[184:185], v111 offset:8192
    s_waitcnt vmcnt(11)
    ds_read_b64_tr_b16 v[140:141], v118 offset:0
    ds_read_b64_tr_b16 v[142:143], v119 offset:0
    v_mfma_f32_32x32x16_bf16 v[208:223], a[164:167], a[96:99], v[208:223]
    ds_read_b64_tr_b16 a[186:187], v111 offset:8704
    ds_read_b64_tr_b16 a[188:189], v112 offset:8192
    ds_read_b64_tr_b16 a[190:191], v112 offset:8704
    buffer_load_dwordx4 v93, s[24:27], s69 offen offset:3072 lds
    ds_read_b64_tr_b16 v[144:145], v118 offset:32
    ds_read_b64_tr_b16 v[146:147], v119 offset:32
    ds_read_b64_tr_b16 v[148:149], v118 offset:64
    s_waitcnt lgkmcnt(14)
    v_mfma_f32_32x32x16_bf16 v[224:239], a[168:171], a[96:99], v[224:239]
    ds_read_b64_tr_b16 v[150:151], v119 offset:64
    ds_read_b64_tr_b16 v[152:153], v118 offset:96
    ds_read_b64_tr_b16 v[154:155], v119 offset:96
    s_waitcnt lgkmcnt(9)
    buffer_store_dwordx4 v[140:143], v120, s[36:39], 0 offen sc1
    s_waitcnt lgkmcnt(4)
    buffer_store_dwordx4 v[144:147], v121, s[36:39], 0 offen sc1
    s_waitcnt lgkmcnt(2)
    buffer_store_dwordx4 v[148:151], v122, s[36:39], 0 offen sc1
    s_waitcnt lgkmcnt(0)
    buffer_store_dwordx4 v[152:155], v123, s[36:39], 0 offen sc1
    v_lshl_add_u32 v6, v14, 3, v12
    v_mfma_f32_32x32x16_bf16 v[240:255], a[172:175], a[96:99], v[240:255]
    s_mov_b32 s70, 1572864
    s_add_u32 m0, s91, 16384
    s_nop 0
    buffer_load_dwordx4 v94, s[32:35], s70 offen offset:0 lds
    v_mul_u32_u24 v6, 192, v6
    v_and_b32 v7, 1, v13
    v_mul_u32_u24 v7, 96, v7
    v_add_u32 v6, v6, v7
    v_and_b32 v7, 1, v11
    v_mfma_f32_16x16x32_bf16 v[176:179], v[20:23], a[160:163], v[176:179]
    v_lshlrev_b32 v7, 1, v7
    v_lshrrev_b32 v8, 1, v13
    v_mfma_f32_16x16x32_bf16 v[180:183], v[20:23], a[164:167], v[180:183]
    buffer_load_dwordx4 v95, s[32:35], s70 offen offset:1024 lds
    v_add_u32_e64 v7, v7, v8
    v_mfma_f32_16x16x32_bf16 v[184:187], v[20:23], a[168:171], v[184:187]
    v_lshl_add_u32 v6, v7, 3, v6
    s_xor_b32 s63, s56, 0
    v_mfma_f32_16x16x32_bf16 v[188:191], v[20:23], a[172:175], v[188:191]
    s_mul_i32 s63, s63, 3072
    v_mfma_f32_32x32x16_bf16 v[192:207], a[176:179], a[100:103], v[192:207]
    ds_read_b128 a[104:107], v107 offset:0
    ds_read_b64_tr_b16 a[160:161], v113 offset:0
    ds_read_b64_tr_b16 a[162:163], v113 offset:512
    ds_read_b64_tr_b16 a[164:165], v114 offset:0
    ds_read_b64_tr_b16 a[166:167], v114 offset:512
    ds_read_b64_tr_b16 a[168:169], v113 offset:8192
    s_add_u32 m0, s91, 24576
    s_nop 0
    buffer_load_dwordx4 v96, s[32:35], s70 offen offset:0 lds
    v_mfma_f32_32x32x16_bf16 v[208:223], a[180:183], a[100:103], v[208:223]
    ds_read_b64_tr_b16 a[170:171], v113 offset:8704
    ds_read_b64_tr_b16 a[172:173], v114 offset:8192
    ds_read_b64_tr_b16 a[174:175], v114 offset:8704
    v_add_u32 v24, s63, v6
    s_xor_b32 s63, s56, 1
    s_mul_i32 s63, s63, 3072
    v_add_u32_e64 v25, s63, v6
    v_mfma_f32_32x32x16_bf16 v[224:239], a[184:187], a[100:103], v[224:239]
    buffer_load_dwordx4 v97, s[32:35], s70 offen offset:1024 lds
    s_xor_b32 s63, s56, 2
    s_mul_i32 s63, s63, 3072
    v_add_u32 v26, s63, v6
    s_xor_b32 s63, s56, 3
    s_mul_i32 s63, s63, 3072
    v_add_u32 v27, s63, v6
    v_add_u32 v24, 131072, v24
    v_mfma_f32_32x32x16_bf16 v[240:255], a[188:191], a[100:103], v[240:255]
    v_add_u32 v25, 131072, v25
    v_add_u32 v26, 131072, v26
    v_add_u32 v27, 131072, v27
    s_lshl_b32 s63, s57, 7
    s_lshl_b32 s64, s56, 5
    s_add_u32 s63, s63, s64
    s_lshl_b32 s63, s63, 4
    s_waitcnt lgkmcnt(4)
    v_mfma_f32_32x32x16_bf16 v[192:207], a[160:163], a[104:107], v[192:207]
    ds_read_b128 a[108:111], v108 offset:0
    ds_read_b64_tr_b16 a[176:177], v115 offset:0
    ds_read_b64_tr_b16 a[178:179], v115 offset:512
    ds_read_b64_tr_b16 a[180:181], v116 offset:0
    ds_read_b64_tr_b16 a[182:183], v116 offset:512
    ds_read_b64_tr_b16 a[184:185], v115 offset:8192
    s_add_u32 s63, s63, 13549568
    v_lshl_add_u32 v136, v15, 4, s63
    v_mfma_f32_32x32x16_bf16 v[208:223], a[164:167], a[104:107], v[208:223]
    ds_read_b64_tr_b16 a[186:187], v115 offset:8704
    ds_read_b64_tr_b16 a[188:189], v116 offset:8192
    ds_read_b64_tr_b16 a[190:191], v116 offset:8704
    v_lshrrev_b32 v44, 0, v16
    v_lshrrev_b32 v45, 8, v16
    v_lshrrev_b32 v46, 16, v16
    v_lshrrev_b32 v47, 24, v16
    s_waitcnt lgkmcnt(9)
    v_mfma_f32_32x32x16_bf16 v[224:239], a[168:171], a[104:107], v[224:239]
    buffer_load_dwordx4 v[132:135], v136, s[36:39], 0 offen sc1
    s_lshl_b32 s63, s57, 3
    s_lshl_b32 s64, s56, 1
    s_add_u32 s63, s63, s64
    s_mul_i32 s63, s63, 49152
    s_lshl_b32 s64, s87, 5
    s_add_u32 s63, s63, s64
    v_lshrrev_b32 v2, 4, v15
    v_mfma_f32_32x32x16_bf16 v[240:255], a[172:175], a[104:107], v[240:255]
    v_mul_u32_u24 v2, 49152, v2
    v_lshl_add_u32 v2, v14, 8, v2
    v_and_b32_e64 v3, 15, v1
    v_lshl_add_u32 v2, v3, 4, v2
    v_add_u32 v28, s63, v2
    s_lshl_b32 s63, s57, 7
    s_lshl_b32 s64, s58, 2
    s_waitcnt vmcnt(13) lgkmcnt(0)
    s_barrier
    v_mfma_f32_32x32x16_bf16 v[192:207], a[176:179], a[108:111], v[192:207]
    ds_read_b128 a[112:115], v105 offset:32768
    ds_read_b64_tr_b16 a[160:161], v109 offset:32768
    ds_read_b64_tr_b16 a[162:163], v109 offset:33280
    ds_read_b64_tr_b16 a[164:165], v110 offset:32768
    ds_read_b64_tr_b16 a[166:167], v110 offset:33280
    ds_read_b64_tr_b16 a[168:169], v109 offset:40960
    s_add_u32 m0, s72, 32768
    s_movk_i32 s69, 1152
    v_mfma_f32_32x32x16_bf16 v[208:223], a[180:183], a[108:111], v[208:223]
    ds_read_b64_tr_b16 a[170:171], v109 offset:41472
    ds_read_b64_tr_b16 a[172:173], v110 offset:40960
    ds_read_b64_tr_b16 a[174:175], v110 offset:41472
    v_subrev_u32 v105, 65536, v105
    v_subrev_u32 v109, 65536, v109
    v_subrev_u32 v110, 65536, v110
    buffer_load_dwordx4 v90, s[24:27], s69 offen offset:0 lds
    v_mfma_f32_32x32x16_bf16 v[224:239], a[184:187], a[108:111], v[224:239]
    buffer_load_dwordx4 v91, s[24:27], s69 offen offset:1024 lds
    s_add_u32 s63, s63, s64
    s_add_u32 s63, s63, 13543424
    v_cmp_eq_u32 vcc, 0, v0
    v_mov_b32_e64 v6, s63
    v_mov_b32 v29, 2130706432
    v_cndmask_b32 v29, v29, v6, vcc
    s_and_b32 s63, s62, 1
    v_mfma_f32_32x32x16_bf16 v[240:255], a[188:191], a[108:111], v[240:255]
    buffer_load_dwordx4 v92, s[24:27], s69 offen offset:2048 lds
    s_lshl_b32 s63, s63, 2
    s_add_u32 s84, s63, s60
    s_lshr_b32 s63, s62, 1
    s_lshl_b32 s63, s63, 3
    s_lshr_b32 s64, s61, 2
    s_add_u32 s63, s63, s64
    s_waitcnt lgkmcnt(4)
    v_mfma_f32_32x32x16_bf16 v[192:207], a[160:163], a[112:115], v[192:207]
    ds_read_b128 a[116:119], v106 offset:32768
    ds_read_b64_tr_b16 a[176:177], v111 offset:32768
    ds_read_b64_tr_b16 a[178:179], v111 offset:33280
    ds_read_b64_tr_b16 a[180:181], v112 offset:32768
    ds_read_b64_tr_b16 a[182:183], v112 offset:33280
    ds_read_b64_tr_b16 a[184:185], v111 offset:40960
    s_lshr_b32 s86, s63, 1
    s_lshl_b32 s85, s63, 2
    v_mfma_f32_32x32x16_bf16 v[208:223], a[164:167], a[112:115], v[208:223]
    ds_read_b64_tr_b16 a[186:187], v111 offset:41472
    ds_read_b64_tr_b16 a[188:189], v112 offset:40960
    ds_read_b64_tr_b16 a[190:191], v112 offset:41472
    v_subrev_u32 v106, 65536, v106
    v_subrev_u32 v111, 65536, v111
    v_subrev_u32 v112, 65536, v112
    buffer_load_dwordx4 v93, s[24:27], s69 offen offset:3072 lds
    s_waitcnt lgkmcnt(9)
    v_mfma_f32_32x32x16_bf16 v[224:239], a[168:171], a[112:115], v[224:239]
    s_add_u32 s85, s85, s56
    s_mul_i32 s74, s56, 5120
    s_mul_i32 s63, s84, 348160
    s_add_u32 s63, s63, s74
    s_add_u32 s63, s63, 8912896
    v_lshlrev_b32 v33, 4, v1
    v_add_u32 v30, s63, v33
    s_mul_i32 s63, s85, 49152
    v_mfma_f32_32x32x16_bf16 v[240:255], a[172:175], a[112:115], v[240:255]
    s_mov_b32 s70, 1769472
    s_add_u32 m0, s91, 49152
    s_nop 0
    buffer_load_dwordx4 v94, s[32:35], s70 offen offset:0 lds
    v_add_u32 v31, s63, v33
    s_mul_i32 s63, s85, 20480
    s_add_u32 s63, s63, 6291456
    v_add_u32_e64 v32, s63, v33
    s_mul_i32 s63, s84, 80
    v_mfma_f32_16x16x32_bf16 v[176:179], v[20:23], a[160:163], v[176:179]
    s_add_u32 s64, s63, 79
    s_lshr_b32 s63, s63, 6
    v_mfma_f32_16x16x32_bf16 v[180:183], v[20:23], a[164:167], v[180:183]
    buffer_load_dwordx4 v95, s[32:35], s70 offen offset:1024 lds
    s_lshr_b32 s64, s64, 6
    v_mfma_f32_16x16x32_bf16 v[184:187], v[20:23], a[168:171], v[184:187]
    s_sub_u32 s64, s64, s63
    s_lshl_b32 s63, s63, 7
    v_mfma_f32_16x16x32_bf16 v[188:191], v[20:23], a[172:175], v[188:191]
    s_lshl_b32 s64, s64, 7
    s_waitcnt lgkmcnt(4)
    v_mfma_f32_32x32x16_bf16 v[192:207], a[176:179], a[116:119], v[192:207]
    ds_read_b128 a[120:123], v107 offset:32768
    ds_read_b64_tr_b16 a[160:161], v113 offset:32768
    ds_read_b64_tr_b16 a[162:163], v113 offset:33280
    ds_read_b64_tr_b16 a[164:165], v114 offset:32768
    ds_read_b64_tr_b16 a[166:167], v114 offset:33280
    ds_read_b64_tr_b16 a[168:169], v113 offset:40960
    s_add_u32 m0, s91, 57344
    s_nop 0
    buffer_load_dwordx4 v96, s[32:35], s70 offen offset:0 lds
    v_mfma_f32_32x32x16_bf16 v[208:223], a[180:183], a[116:119], v[208:223]
    ds_read_b64_tr_b16 a[170:171], v113 offset:41472
    ds_read_b64_tr_b16 a[172:173], v114 offset:40960
    ds_read_b64_tr_b16 a[174:175], v114 offset:41472
    v_subrev_u32 v107, 65536, v107
    v_subrev_u32 v113, 65536, v113
    v_subrev_u32 v114, 65536, v114
    s_add_u32 s63, s63, 13547520
    s_waitcnt lgkmcnt(9)
    v_mfma_f32_32x32x16_bf16 v[224:239], a[184:187], a[116:119], v[224:239]
    buffer_load_dwordx4 v97, s[32:35], s70 offen offset:1024 lds
    v_min_u32 v2, 11, v15
    v_mul_u32_u24 v3, s64, v14
    v_lshl_add_u32 v2, v2, 2, v3
    v_add_u32 v34, s63, v2
    v_min_u32 v2, 4, v15
    v_mfma_f32_32x32x16_bf16 v[240:255], a[188:191], a[116:119], v[240:255]
    v_lshl_add_u32 v2, v2, 2, v3
    v_add_u32 v36, s63, v2
    s_lshl_b32 s63, s86, 7
    v_and_b32_e64 v2, 7, v1
    v_lshl_add_u32 v37, v2, 2, s63
    v_add_u32 v37, 13543424, v37
    s_mov_b32 s80, 0
    s_waitcnt vmcnt(8)
    v_xor_b32_e64 v137, v132, v44
    v_bitop3_b32 v137, v137, v133, v45 bitop3:0xf6
    v_bitop3_b32 v137, v137, v134, v46 bitop3:0xf6
    v_bitop3_b32 v137, v137, v135, v47 bitop3:0xf6
    v_and_b32 v137, 0xff, v137
    v_cmp_ne_u32 vcc, 0, v137
    s_nop 0
    s_cbranch_vccz L_ok_stB
L_retry_stB:
    s_sleep 1
    buffer_load_dwordx4 v[132:135], v136, s[36:39], 0 offen sc1
    s_waitcnt vmcnt(0)
    v_xor_b32 v137, v132, v44
    v_bitop3_b32 v137, v137, v133, v45 bitop3:0xf6
    v_bitop3_b32 v137, v137, v134, v46 bitop3:0xf6
    v_bitop3_b32 v137, v137, v135, v47 bitop3:0xf6
    v_and_b32 v137, 0xff, v137
    v_cmp_ne_u32 vcc, 0, v137
    s_add_u32 s80, s80, 1
    s_cmp_lt_u32 s80, 100000
    s_cselect_b64 s[82:83], vcc, 0
    s_cmp_lg_u64 s[82:83], 0
    s_cbranch_scc1 L_retry_stB
    s_nop 4
L_ok_stB:
    s_waitcnt lgkmcnt(4)
    v_mfma_f32_32x32x16_bf16 v[192:207], a[160:163], a[120:123], v[192:207]
    ds_read_b128 a[124:127], v108 offset:32768
    ds_read_b64_tr_b16 a[176:177], v115 offset:32768
    ds_read_b64_tr_b16 a[178:179], v115 offset:33280
    ds_read_b64_tr_b16 a[180:181], v116 offset:32768
    ds_read_b64_tr_b16 a[182:183], v116 offset:33280
    ds_read_b64_tr_b16 a[184:185], v115 offset:40960
    s_mov_b32 s70, 0
    s_add_u32 m0, s73, 131072
    v_mfma_f32_32x32x16_bf16 v[208:223], a[164:167], a[120:123], v[208:223]
    ds_read_b64_tr_b16 a[186:187], v115 offset:41472
    ds_read_b64_tr_b16 a[188:189], v116 offset:40960
    ds_read_b64_tr_b16 a[190:191], v116 offset:41472
    v_subrev_u32 v108, 65536, v108
    v_subrev_u32 v115, 65536, v115
    v_subrev_u32 v116, 65536, v116
    buffer_load_dwordx4 v17, s[28:31], s70 offen offset:0 lds
    s_waitcnt lgkmcnt(9)
    v_mfma_f32_32x32x16_bf16 v[224:239], a[168:171], a[120:123], v[224:239]
    buffer_load_dwordx4 v18, s[28:31], s70 offen offset:1024 lds
    v_cmp_eq_u32 vcc, 0, v14
    v_and_b32 v132, s88, v132
    v_and_b32 v43, s88, v133
    v_cndmask_b32 v132, 0, v132, vcc
    v_and_b32 v48, s88, v134
    v_mfma_f32_32x32x16_bf16 v[240:255], a[172:175], a[120:123], v[240:255]
    buffer_load_dwordx4 v19, s[28:31], s70 offen offset:2048 lds
    v_cvt_pk_bf16_f32 v52, v132, v132
    v_and_b32_e64 v50, s88, v135
    v_and_b32 v133, 0xffff0000, v52
    v_and_b32 v51, s88, v135
    v_sub_f32 v133, v132, v133
    s_waitcnt lgkmcnt(0)
    s_barrier
    v_mfma_f32_32x32x16_bf16 v[192:207], a[176:179], a[124:127], v[192:207]
    ds_read_b128 a[128:131], v105 offset:0
    ds_read_b64_tr_b16 a[160:161], v109 offset:0
    ds_read_b64_tr_b16 a[162:163], v109 offset:512
    ds_read_b64_tr_b16 a[164:165], v110 offset:0
    ds_read_b64_tr_b16 a[166:167], v110 offset:512
    ds_read_b64_tr_b16 a[168:169], v109 offset:8192
    v_mov_b32_e64 v54, 0
    v_cvt_pk_bf16_f32 v53, v133, 0
    v_mfma_f32_32x32x16_bf16 v[208:223], a[180:183], a[124:127], v[208:223]
    ds_read_b64_tr_b16 a[170:171], v109 offset:8704
    ds_read_b64_tr_b16 a[172:173], v110 offset:8192
    ds_read_b64_tr_b16 a[174:175], v110 offset:8704
    s_mov_b32 s70, 245760
    s_add_u32 m0, s73, 65536
    s_nop 0
    buffer_load_dwordx4 v17, s[28:31], s70 offen offset:0 lds
    v_mov_b32 v55, 0
    v_mfma_f32_32x32x16_bf16 v[224:239], a[184:187], a[124:127], v[224:239]
    v_mfma_f32_32x32x16_bf16 v[240:255], a[188:191], a[124:127], v[240:255]
    buffer_load_dwordx4 v18, s[28:31], s70 offen offset:1024 lds
    s_waitcnt lgkmcnt(4)
    v_mfma_f32_32x32x16_bf16 v[192:207], a[160:163], a[128:131], v[192:207]
    ds_read_b128 a[132:135], v106 offset:0
    ds_read_b64_tr_b16 a[176:177], v111 offset:0
    ds_read_b64_tr_b16 a[178:179], v111 offset:512
    ds_read_b64_tr_b16 a[180:181], v112 offset:0
    ds_read_b64_tr_b16 a[182:183], v112 offset:512
    ds_read_b64_tr_b16 a[184:185], v111 offset:8192
    buffer_load_dwordx4 v19, s[28:31], s70 offen offset:2048 lds
    v_mfma_f32_32x32x16_bf16 v[208:223], a[164:167], a[128:131], v[208:223]
    ds_read_b64_tr_b16 a[186:187], v111 offset:8704
    ds_read_b64_tr_b16 a[188:189], v112 offset:8192
    ds_read_b64_tr_b16 a[190:191], v112 offset:8704
    s_waitcnt lgkmcnt(9)
    v_mfma_f32_32x32x16_bf16 v[224:239], a[168:171], a[128:131], v[224:239]
    s_mov_b32 s70, 491520
    s_add_u32 m0, s73, 77824
    s_nop 0
    buffer_load_dwordx4 v17, s[28:31], s70 offen offset:0 lds
    v_mfma_f32_32x32x16_bf16 v[240:255], a[172:175], a[128:131], v[240:255]
    v_mfma_f32_16x16x32_bf16 v[176:179], v[20:23], a[160:163], v[176:179]
    buffer_load_dwordx4 v18, s[28:31], s70 offen offset:1024 lds
    v_mfma_f32_16x16x32_bf16 v[180:183], v[20:23], a[164:167], v[180:183]
    v_mfma_f32_16x16x32_bf16 v[184:187], v[20:23], a[168:171], v[184:187]
    v_mfma_f32_16x16x32_bf16 v[188:191], v[20:23], a[172:175], v[188:191]
    s_waitcnt lgkmcnt(4)
    v_mfma_f32_32x32x16_bf16 v[192:207], a[176:179], a[132:135], v[192:207]
    ds_read_b128 a[136:139], v107 offset:0
    ds_read_b64_tr_b16 a[160:161], v113 offset:0
    ds_read_b64_tr_b16 a[162:163], v113 offset:512
    ds_read_b64_tr_b16 a[164:165], v114 offset:0
    ds_read_b64_tr_b16 a[166:167], v114 offset:512
    ds_read_b64_tr_b16 a[168:169], v113 offset:8192
    buffer_load_dwordx4 v19, s[28:31], s70 offen offset:2048 lds
    v_mfma_f32_32x32x16_bf16 v[208:223], a[180:183], a[132:135], v[208:223]
    ds_read_b64_tr_b16 a[170:171], v113 offset:8704
    ds_read_b64_tr_b16 a[172:173], v114 offset:8192
    ds_read_b64_tr_b16 a[174:175], v114 offset:8704
    s_mov_b32 s70, 737280
    s_add_u32 m0, s73, 98304
    s_nop 0
    buffer_load_dwordx4 v17, s[28:31], s70 offen offset:0 lds
    s_waitcnt lgkmcnt(9)
    v_mfma_f32_32x32x16_bf16 v[224:239], a[184:187], a[132:135], v[224:239]
    v_mfma_f32_32x32x16_bf16 v[240:255], a[188:191], a[132:135], v[240:255]
    buffer_load_dwordx4 v18, s[28:31], s70 offen offset:1024 lds
    s_waitcnt lgkmcnt(4)
    v_mfma_f32_32x32x16_bf16 v[192:207], a[160:163], a[136:139], v[192:207]
    ds_read_b128 a[140:143], v108 offset:0
    ds_read_b64_tr_b16 a[176:177], v115 offset:0
    ds_read_b64_tr_b16 a[178:179], v115 offset:512
    ds_read_b64_tr_b16 a[180:181], v116 offset:0
    ds_read_b64_tr_b16 a[182:183], v116 offset:512
    ds_read_b64_tr_b16 a[184:185], v115 offset:8192
    v_mfma_f32_32x32x16_bf16 v[208:223], a[164:167], a[136:139], v[208:223]
    ds_read_b64_tr_b16 a[186:187], v115 offset:8704
    ds_read_b64_tr_b16 a[188:189], v116 offset:8192
    ds_read_b64_tr_b16 a[190:191], v116 offset:8704
    buffer_load_dwordx4 v19, s[28:31], s70 offen offset:2048 lds
    s_waitcnt lgkmcnt(9)
    v_mfma_f32_32x32x16_bf16 v[224:239], a[168:171], a[136:139], v[224:239]
    v_mfma_f32_32x32x16_bf16 v[240:255], a[172:175], a[136:139], v[240:255]
    s_mov_b32 s70, 983040
    s_add_u32 m0, s73, 110592
    s_nop 0
    buffer_load_dwordx4 v17, s[28:31], s70 offen offset:0 lds
    s_waitcnt vmcnt(13) lgkmcnt(0)
    s_barrier
    v_mfma_f32_32x32x16_bf16 v[192:207], a[176:179], a[140:143], v[192:207]
    ds_read_b128 a[144:147], v105 offset:32768
    ds_read_b64_tr_b16 a[160:161], v109 offset:32768
    ds_read_b64_tr_b16 a[162:163], v109 offset:33280
    ds_read_b64_tr_b16 a[164:165], v110 offset:32768
    ds_read_b64_tr_b16 a[166:167], v110 offset:33280
    ds_read_b64_tr_b16 a[168:169], v109 offset:40960
    buffer_load_dwordx4 v18, s[28:31], s70 offen offset:1024 lds
    buffer_store_dword v16, v124, s[36:39], 0 offen sc1
    v_mfma_f32_32x32x16_bf16 v[208:223], a[180:183], a[140:143], v[208:223]
    ds_read_b64_tr_b16 a[170:171], v109 offset:41472
    ds_read_b64_tr_b16 a[172:173], v110 offset:40960
    ds_read_b64_tr_b16 a[174:175], v110 offset:41472
    v_lshlrev_b32 v56, 2, v15
    v_add_u32 v56, 159744, v56
    s_mul_i32 s63, s56, 512
    v_add_u32_e64 v57, s63, v56
    v_mfma_f32_32x32x16_bf16 v[224:239], a[184:187], a[140:143], v[224:239]
    buffer_load_dwordx4 v19, s[28:31], s70 offen offset:2048 lds
    v_mfma_f32_32x32x16_bf16 v[240:255], a[188:191], a[140:143], v[240:255]
    s_waitcnt lgkmcnt(4)
    v_mfma_f32_16x16x32_bf16 v[176:179], v[20:23], a[160:163], v[176:179]
    ds_read_b128 a[148:151], v106 offset:32768
    ds_read_b64_tr_b16 a[176:177], v111 offset:32768
    v_mfma_f32_16x16x32_bf16 v[180:183], v[20:23], a[164:167], v[180:183]
    ds_read_b64_tr_b16 a[178:179], v111 offset:33280
    s_waitcnt lgkmcnt(3)
    v_mfma_f32_16x16x32_bf16 v[184:187], v[20:23], a[168:171], v[184:187]
    ds_read_b64_tr_b16 a[180:181], v112 offset:32768
    ds_read_b64_tr_b16 a[182:183], v112 offset:33280
    v_mfma_f32_16x16x32_bf16 v[188:191], v[20:23], a[172:175], v[188:191]
    ds_read_b64_tr_b16 a[184:185], v111 offset:40960
    ds_read_b64_tr_b16 a[186:187], v111 offset:41472
    v_mfma_f32_32x32x16_bf16 v[192:207], a[160:163], a[144:147], v[192:207]
    ds_read_b64_tr_b16 a[188:189], v112 offset:40960
    ds_read_b64_tr_b16 a[190:191], v112 offset:41472
    s_mov_b32 s70, 1228800
    s_add_u32 m0, s73, 0
    s_nop 0
    buffer_load_dwordx4 v17, s[28:31], s70 offen offset:0 lds
    v_mfma_f32_32x32x16_bf16 v[208:223], a[164:167], a[144:147], v[208:223]
    buffer_load_dwordx4 v18, s[28:31], s70 offen offset:1024 lds
    v_mfma_f32_32x32x16_bf16 v[224:239], a[168:171], a[144:147], v[224:239]
    buffer_load_dwordx4 v19, s[28:31], s70 offen offset:2048 lds
    v_mfma_f32_32x32x16_bf16 v[240:255], a[172:175], a[144:147], v[240:255]
    s_waitcnt lgkmcnt(4)
    v_mfma_f32_32x32x16_bf16 v[192:207], a[176:179], a[148:151], v[192:207]
    ds_read_b128 a[152:155], v107 offset:32768
    ds_read_b64_tr_b16 a[160:161], v113 offset:32768
    ds_read_b64_tr_b16 a[162:163], v113 offset:33280
    ds_read_b64_tr_b16 a[164:165], v114 offset:32768
    ds_read_b64_tr_b16 a[166:167], v114 offset:33280
    ds_read_b64_tr_b16 a[168:169], v113 offset:40960
    s_mov_b32 s70, 1474560
    s_add_u32 m0, s73, 12288
    v_mfma_f32_32x32x16_bf16 v[208:223], a[180:183], a[148:151], v[208:223]
    ds_read_b64_tr_b16 a[170:171], v113 offset:41472
    ds_read_b64_tr_b16 a[172:173], v114 offset:40960
    ds_read_b64_tr_b16 a[174:175], v114 offset:41472
    ds_write_b32 v57, v176 offset:0
    ds_write_b32 v57, v180 offset:128
    ds_write_b32 v57, v184 offset:256
    buffer_load_dwordx4 v17, s[28:31], s70 offen offset:0 lds
    s_waitcnt lgkmcnt(12)
    v_mfma_f32_32x32x16_bf16 v[224:239], a[184:187], a[148:151], v[224:239]
    ds_write_b32 v57, v188 offset:384
    buffer_load_dwordx4 v18, s[28:31], s70 offen offset:1024 lds
    v_mfma_f32_32x32x16_bf16 v[240:255], a[188:191], a[148:151], v[240:255]
    buffer_load_dwordx4 v19, s[28:31], s70 offen offset:2048 lds
    s_waitcnt lgkmcnt(0)
    s_barrier
    v_mfma_f32_32x32x16_bf16 v[192:207], a[160:163], a[152:155], v[192:207]
    ds_read_b128 a[156:159], v108 offset:32768
    ds_read_b64_tr_b16 a[176:177], v115 offset:32768
    ds_read_b64_tr_b16 a[178:179], v115 offset:33280
    ds_read_b64_tr_b16 a[180:181], v116 offset:32768
    ds_read_b64_tr_b16 a[182:183], v116 offset:33280
    ds_read_b64_tr_b16 a[184:185], v115 offset:40960
    ds_read_b64_tr_b16 a[186:187], v115 offset:41472
    v_mfma_f32_32x32x16_bf16 v[208:223], a[164:167], a[152:155], v[208:223]
    ds_read_b64_tr_b16 a[188:189], v116 offset:40960
    ds_read_b64_tr_b16 a[190:191], v116 offset:41472
    ds_read_b32 v176, v56 offset:0
    ds_read_b32 v177, v56 offset:512
    ds_read_b32 v178, v56 offset:1024
    ds_read_b32 v179, v56 offset:1536
    v_mfma_f32_32x32x16_bf16 v[224:239], a[168:171], a[152:155], v[224:239]
    ds_read_b32 v180, v56 offset:128
    ds_read_b32 v181, v56 offset:640
    ds_read_b32 v182, v56 offset:1152
    ds_read_b32 v183, v56 offset:1664
    ds_read_b32 v184, v56 offset:256
    ds_read_b32 v185, v56 offset:768
    v_mfma_f32_32x32x16_bf16 v[240:255], a[172:175], a[152:155], v[240:255]
    ds_read_b32 v186, v56 offset:1280
    ds_read_b32 v187, v56 offset:1792
    ds_read_b32 v188, v56 offset:384
    ds_read_b32 v189, v56 offset:896
    ds_read_b32 v190, v56 offset:1408
    ds_read_b32 v191, v56 offset:1920
    s_waitcnt lgkmcnt(15)
    v_mfma_f32_32x32x16_bf16 v[192:207], a[176:179], a[156:159], v[192:207]
    s_waitcnt lgkmcnt(14)
    v_add_f32 v176, v176, v177
    s_waitcnt lgkmcnt(10)
    v_add_f32 v180, v180, v181
    s_waitcnt lgkmcnt(6)
    v_add_f32 v184, v184, v185
    s_waitcnt lgkmcnt(2)
    v_add_f32 v188, v188, v189
    v_add_f32 v178, v178, v179
    v_add_f32 v182, v182, v183
    v_add_f32 v186, v186, v187
    s_waitcnt lgkmcnt(0)
    v_add_f32 v190, v190, v191
    v_add_f32_e64 v178, v176, v178
    v_mfma_f32_32x32x16_bf16 v[208:223], a[180:183], a[156:159], v[208:223]
    v_add_f32 v182, v180, v182
    v_add_f32 v186, v184, v186
    v_add_f32_e64 v190, v188, v190
    v_cvt_pk_bf16_f32 v177, v178, 0
    v_cvt_pk_bf16_f32 v181, v182, 0
    v_cvt_pk_bf16_f32 v185, v186, 0
    v_cvt_pk_bf16_f32 v189, v190, 0
    v_lshlrev_b32 v179, 16, v177
    v_lshlrev_b32 v183, 16, v181
    v_mfma_f32_32x32x16_bf16 v[224:239], a[184:187], a[156:159], v[224:239]
    v_lshlrev_b32 v187, 16, v185
    v_lshlrev_b32 v191, 16, v189
    v_sub_f32 v179, v178, v179
    v_sub_f32 v183, v182, v183
    v_sub_f32 v187, v186, v187
    v_sub_f32 v191, v190, v191
    v_cvt_pk_bf16_f32 v176, v178, v179
    v_cvt_pk_bf16_f32 v180, v182, v183
    v_cvt_pk_bf16_f32 v184, v186, v187
    v_mfma_f32_32x32x16_bf16 v[240:255], a[188:191], a[156:159], v[240:255]
    v_cvt_pk_bf16_f32 v188, v190, v191
    v_mov_b32 v178, 0
    v_mov_b32 v182, 0
    v_mov_b32 v186, 0
    v_mov_b32 v190, 0
    v_mov_b32 v179, 0
    v_mov_b32 v183, 0
    v_mov_b32 v187, 0
    v_mov_b32 v191, 0
    v_mfma_f32_32x32x16_bf16 v[192:207], v[176:179], v[52:55], v[192:207]
    v_mfma_f32_32x32x16_bf16 v[208:223], v[180:183], v[52:55], v[208:223]
    v_mfma_f32_32x32x16_bf16 v[224:239], v[184:187], v[52:55], v[224:239]
    v_mfma_f32_32x32x16_bf16 v[240:255], v[188:191], v[52:55], v[240:255]
    s_waitcnt vmcnt(19)
    s_barrier
    ds_read_b64_tr_b16 a[160:161], v24 offset:0
    ds_read_b64_tr_b16 a[162:163], v24 offset:768
    ds_read_b64_tr_b16 a[164:165], v24 offset:32
    ds_read_b64_tr_b16 a[166:167], v24 offset:800
    ds_read_b64_tr_b16 a[168:169], v24 offset:64
    ds_read_b64_tr_b16 a[170:171], v24 offset:832
    v_subrev_u32 v24, 65536, v24
    ds_read_b64_tr_b16 a[172:173], v25 offset:0
    ds_read_b64_tr_b16 a[174:175], v25 offset:768
    ds_read_b64_tr_b16 a[176:177], v25 offset:32
    ds_read_b64_tr_b16 a[178:179], v25 offset:800
    ds_read_b64_tr_b16 a[180:181], v25 offset:64
    ds_read_b64_tr_b16 a[182:183], v25 offset:832
    v_subrev_u32 v25, 65536, v25
    s_waitcnt lgkmcnt(6)
    v_mfma_f32_32x32x16_bf16 v[144:159], a[160:163], a[0:3], 0
    ds_read_b64_tr_b16 a[184:185], v26 offset:0
    ds_read_b64_tr_b16 a[186:187], v26 offset:768
    s_mov_b32 s70, 1720320
    s_add_u32 m0, s73, 32768
    s_nop 0
    buffer_load_dwordx4 v17, s[28:31], s70 offen offset:0 lds
    buffer_load_dword v35, v34, s[36:39], 0 offen offset:0 sc1
    v_mov_b32_e64 v56, v48
    v_pk_mul_f32 v[124:125], v[192:193], v[50:51] neg_lo:[0,1] neg_hi:[0,1]
    v_mfma_f32_32x32x16_bf16 v[160:175], a[164:167], a[0:3], 0
    ds_read_b64_tr_b16 a[188:189], v26 offset:32
    ds_read_b64_tr_b16 a[190:191], v26 offset:800
    buffer_load_dwordx4 v18, s[28:31], s70 offen offset:1024 lds
    v_pk_mul_f32 v[126:127], v[194:195], v[50:51] neg_lo:[0,1] neg_hi:[0,1]
    v_pk_mul_f32 v[128:129], v[196:197], v[50:51] neg_lo:[0,1] neg_hi:[0,1]
    v_pk_mul_f32 v[130:131], v[198:199], v[50:51] neg_lo:[0,1] neg_hi:[0,1]
    v_exp_f32_e64 v124, v124
    v_mfma_f32_32x32x16_bf16 v[176:191], a[168:171], a[0:3], 0
    ds_read_b64_tr_b16 a[192:193], v26 offset:64
    ds_read_b64_tr_b16 a[194:195], v26 offset:832
    v_exp_f32 v125, v125
    v_exp_f32 v126, v126
    v_exp_f32_e64 v127, v127
    v_mfma_f32_16x16x32_bf16 v[132:135], v[20:23], a[160:163], 0
    v_subrev_u32 v26, 65536, v26
    v_mfma_f32_16x16x32_bf16 v[136:139], v[20:23], a[164:167], 0
    buffer_load_dwordx4 v19, s[28:31], s70 offen offset:2048 lds
    v_mfma_f32_16x16x32_bf16 v[140:143], v[20:23], a[168:171], 0
    s_waitcnt lgkmcnt(6)
    v_mfma_f32_32x32x16_bf16 v[144:159], a[172:175], a[4:7], v[144:159]
    ds_read_b64_tr_b16 a[160:161], v27 offset:0
    ds_read_b64_tr_b16 a[162:163], v27 offset:768
    ds_read_b64_tr_b16 a[164:165], v27 offset:32
    v_exp_f32 v128, v128
    v_exp_f32_e64 v129, v129
    v_mfma_f32_32x32x16_bf16 v[160:175], a[176:179], a[4:7], v[160:175]
    ds_read_b64_tr_b16 a[166:167], v27 offset:800
    ds_read_b64_tr_b16 a[168:169], v27 offset:64
    v_exp_f32 v130, v130
    v_exp_f32 v131, v131
    v_pk_fma_f32 v[124:125], v[124:125], v[56:57], v[56:57] op_sel_hi:[1,0,0]
    v_pk_fma_f32 v[126:127], v[126:127], v[56:57], v[56:57] op_sel_hi:[1,0,0]
    v_mfma_f32_32x32x16_bf16 v[176:191], a[180:183], a[4:7], v[176:191]
    ds_read_b64_tr_b16 a[170:171], v27 offset:832
    v_subrev_u32 v27, 65536, v27
    s_mov_b32 s70, 1966080
    s_add_u32 m0, s73, 45056
    s_nop 0
    buffer_load_dwordx4 v17, s[28:31], s70 offen offset:0 lds
    v_pk_fma_f32 v[128:129], v[128:129], v[56:57], v[56:57] op_sel_hi:[1,0,0]
    v_pk_fma_f32 v[130:131], v[130:131], v[56:57], v[56:57] op_sel_hi:[1,0,0]
    s_waitcnt vmcnt(21)
    s_barrier
    s_waitcnt lgkmcnt(6)
    v_mfma_f32_32x32x16_bf16 v[144:159], a[184:187], a[8:11], v[144:159]
    ds_read_b64_tr_b16 a[172:173], v24 offset:0
    ds_read_b64_tr_b16 a[174:175], v24 offset:768
    v_rcp_f32 v124, v124
    v_rcp_f32 v125, v125
    v_rcp_f32_e64 v126, v126
    v_mfma_f32_32x32x16_bf16 v[160:175], a[188:191], a[8:11], v[160:175]
    ds_read_b64_tr_b16 a[176:177], v24 offset:32
    ds_read_b64_tr_b16 a[178:179], v24 offset:800
    v_rcp_f32 v127, v127
    v_rcp_f32 v128, v128
    v_rcp_f32_e64 v129, v129
    v_mfma_f32_32x32x16_bf16 v[176:191], a[192:195], a[8:11], v[176:191]
    ds_read_b64_tr_b16 a[180:181], v24 offset:64
    ds_read_b64_tr_b16 a[182:183], v24 offset:832
    buffer_load_dwordx4 v18, s[28:31], s70 offen offset:1024 lds
    v_rcp_f32 v130, v130
    v_rcp_f32 v131, v131
    s_waitcnt lgkmcnt(6)
    v_mfma_f32_32x32x16_bf16 v[144:159], a[160:163], a[12:15], v[144:159]
    ds_read_b64_tr_b16 a[184:185], v25 offset:0
    ds_read_b64_tr_b16 a[186:187], v25 offset:768
    v_pk_mul_f32 v[192:193], v[192:193], v[124:125]
    v_pk_mul_f32 v[194:195], v[194:195], v[126:127]
    v_pk_mul_f32 v[196:197], v[196:197], v[128:129]
    v_pk_mul_f32 v[198:199], v[198:199], v[130:131]
    v_cvt_pk_bf16_f32 v192, v192, v193
    v_mfma_f32_32x32x16_bf16 v[160:175], a[164:167], a[12:15], v[160:175]
    ds_read_b64_tr_b16 a[188:189], v25 offset:32
    ds_read_b64_tr_b16 a[190:191], v25 offset:800
    v_cvt_pk_bf16_f32 v193, v194, v195
    v_cvt_pk_bf16_f32 v194, v196, v197
    v_cvt_pk_bf16_f32 v195, v198, v199
    buffer_store_dwordx4 v[192:195], v28, s[36:39], 0 offen offset:0 sc1
    v_pk_mul_f32 v[124:125], v[200:201], v[50:51] neg_lo:[0,1] neg_hi:[0,1]
    v_pk_mul_f32 v[126:127], v[202:203], v[50:51] neg_lo:[0,1] neg_hi:[0,1]
    v_mfma_f32_32x32x16_bf16 v[176:191], a[168:171], a[12:15], v[176:191]
    ds_read_b64_tr_b16 a[192:193], v25 offset:64
    ds_read_b64_tr_b16 a[194:195], v25 offset:832
    buffer_load_dwordx4 v19, s[28:31], s70 offen offset:2048 lds
    v_pk_mul_f32 v[128:129], v[204:205], v[50:51] neg_lo:[0,1] neg_hi:[0,1]
    v_pk_mul_f32 v[130:131], v[206:207], v[50:51] neg_lo:[0,1] neg_hi:[0,1]
    v_exp_f32 v124, v124
    s_waitcnt lgkmcnt(6)
    v_mfma_f32_32x32x16_bf16 v[144:159], a[172:175], a[16:19], v[144:159]
    ds_read_b64_tr_b16 a[160:161], v26 offset:0
    ds_read_b64_tr_b16 a[162:163], v26 offset:768
    v_exp_f32 v125, v125
    v_exp_f32 v126, v126
    v_exp_f32 v127, v127
    v_mfma_f32_32x32x16_bf16 v[160:175], a[176:179], a[16:19], v[160:175]
    ds_read_b64_tr_b16 a[164:165], v26 offset:32
    ds_read_b64_tr_b16 a[166:167], v26 offset:800
    v_exp_f32 v128, v128
    v_exp_f32 v129, v129
    v_exp_f32_e64 v130, v130
    v_mfma_f32_32x32x16_bf16 v[176:191], a[180:183], a[16:19], v[176:191]
    ds_read_b64_tr_b16 a[168:169], v26 offset:64
    ds_read_b64_tr_b16 a[170:171], v26 offset:832
    v_exp_f32_e64 v131, v131
    v_pk_fma_f32 v[124:125], v[124:125], v[56:57], v[56:57] op_sel_hi:[1,0,0]
    v_pk_fma_f32 v[126:127], v[126:127], v[56:57], v[56:57] op_sel_hi:[1,0,0]
    v_pk_fma_f32 v[128:129], v[128:129], v[56:57], v[56:57] op_sel_hi:[1,0,0]
    v_mfma_f32_16x16x32_bf16 v[132:135], v[20:23], a[172:175], v[132:135]
    v_pk_fma_f32 v[130:131], v[130:131], v[56:57], v[56:57] op_sel_hi:[1,0,0]
    v_mfma_f32_16x16x32_bf16 v[136:139], v[20:23], a[176:179], v[136:139]
    v_rcp_f32_e64 v124, v124
    v_mfma_f32_16x16x32_bf16 v[140:143], v[20:23], a[180:183], v[140:143]
    s_waitcnt lgkmcnt(6)
    v_mfma_f32_32x32x16_bf16 v[144:159], a[184:187], a[20:23], v[144:159]
    ds_read_b64_tr_b16 a[172:173], v27 offset:0
    ds_read_b64_tr_b16 a[174:175], v27 offset:768
    v_rcp_f32 v125, v125
    v_rcp_f32 v126, v126
    v_rcp_f32 v127, v127
    v_mfma_f32_32x32x16_bf16 v[160:175], a[188:191], a[20:23], v[160:175]
    ds_read_b64_tr_b16 a[176:177], v27 offset:32
    ds_read_b64_tr_b16 a[178:179], v27 offset:800
    v_rcp_f32 v128, v128
    v_rcp_f32 v129, v129
    v_rcp_f32_e64 v130, v130
    v_mfma_f32_32x32x16_bf16 v[176:191], a[192:195], a[20:23], v[176:191]
    ds_read_b64_tr_b16 a[180:181], v27 offset:64
    ds_read_b64_tr_b16 a[182:183], v27 offset:832
    v_rcp_f32_e64 v131, v131
    v_pk_mul_f32 v[200:201], v[200:201], v[124:125]
    v_pk_mul_f32 v[202:203], v[202:203], v[126:127]
    v_pk_mul_f32 v[204:205], v[204:205], v[128:129]
    s_waitcnt vmcnt(21)
    s_barrier
    s_waitcnt lgkmcnt(6)
    v_mfma_f32_32x32x16_bf16 v[144:159], a[160:163], a[24:27], v[144:159]
    ds_read_b64_tr_b16 a[184:185], v24 offset:12288
    ds_read_b64_tr_b16 a[186:187], v24 offset:13056
    s_mov_b32 s70, 2211840
    s_add_u32 m0, s73, 131072
    s_nop 0
    buffer_load_dwordx4 v17, s[28:31], s70 offen offset:0 lds
    v_pk_mul_f32 v[206:207], v[206:207], v[130:131]
    v_cvt_pk_bf16_f32 v200, v200, v201
    v_cvt_pk_bf16_f32 v201, v202, v203
    v_mfma_f32_32x32x16_bf16 v[160:175], a[164:167], a[24:27], v[160:175]
    ds_read_b64_tr_b16 a[188:189], v24 offset:12320
    ds_read_b64_tr_b16 a[190:191], v24 offset:13088
    buffer_load_dwordx4 v18, s[28:31], s70 offen offset:1024 lds
    v_cvt_pk_bf16_f32 v202, v204, v205
    v_cvt_pk_bf16_f32 v203, v206, v207
    buffer_store_dwordx4 v[200:203], v28, s[36:39], 0 offen offset:512 sc1
    v_pk_mul_f32 v[124:125], v[208:209], v[50:51] neg_lo:[0,1] neg_hi:[0,1]
    v_pk_mul_f32 v[126:127], v[210:211], v[50:51] neg_lo:[0,1] neg_hi:[0,1]
    v_mfma_f32_32x32x16_bf16 v[176:191], a[168:171], a[24:27], v[176:191]
    ds_read_b64_tr_b16 a[192:193], v24 offset:12352
    ds_read_b64_tr_b16 a[194:195], v24 offset:13120
    v_pk_mul_f32 v[128:129], v[212:213], v[50:51] neg_lo:[0,1] neg_hi:[0,1]
    v_pk_mul_f32 v[130:131], v[214:215], v[50:51] neg_lo:[0,1] neg_hi:[0,1]
    v_exp_f32 v124, v124
    s_waitcnt lgkmcnt(6)
    v_mfma_f32_32x32x16_bf16 v[144:159], a[172:175], a[28:31], v[144:159]
    ds_read_b64_tr_b16 a[160:161], v25 offset:12288
    ds_read_b64_tr_b16 a[162:163], v25 offset:13056
    buffer_load_dwordx4 v19, s[28:31], s70 offen offset:2048 lds
    v_exp_f32 v125, v125
    v_exp_f32 v126, v126
    v_mfma_f32_32x32x16_bf16 v[160:175], a[176:179], a[28:31], v[160:175]
    ds_read_b64_tr_b16 a[164:165], v25 offset:12320
    ds_read_b64_tr_b16 a[166:167], v25 offset:13088
    v_exp_f32 v127, v127
    v_exp_f32 v128, v128
    v_exp_f32_e64 v129, v129
    v_mfma_f32_32x32x16_bf16 v[176:191], a[180:183], a[28:31], v[176:191]
    ds_read_b64_tr_b16 a[168:169], v25 offset:12352
    ds_read_b64_tr_b16 a[170:171], v25 offset:13120
    v_exp_f32 v130, v130
    v_exp_f32 v131, v131
    v_pk_fma_f32 v[124:125], v[124:125], v[56:57], v[56:57] op_sel_hi:[1,0,0]
    s_waitcnt lgkmcnt(6)
    v_mfma_f32_32x32x16_bf16 v[144:159], a[184:187], a[32:35], v[144:159]
    ds_read_b64_tr_b16 a[172:173], v26 offset:12288
    ds_read_b64_tr_b16 a[174:175], v26 offset:13056
    v_pk_fma_f32 v[126:127], v[126:127], v[56:57], v[56:57] op_sel_hi:[1,0,0]
    v_pk_fma_f32 v[128:129], v[128:129], v[56:57], v[56:57] op_sel_hi:[1,0,0]
    v_pk_fma_f32 v[130:131], v[130:131], v[56:57], v[56:57] op_sel_hi:[1,0,0]
    v_rcp_f32 v124, v124
    v_mfma_f32_32x32x16_bf16 v[160:175], a[188:191], a[32:35], v[160:175]
    ds_read_b64_tr_b16 a[176:177], v26 offset:12320
    ds_read_b64_tr_b16 a[178:179], v26 offset:13088
    v_rcp_f32 v125, v125
    v_rcp_f32 v126, v126
    v_rcp_f32_e64 v127, v127
    v_mfma_f32_32x32x16_bf16 v[176:191], a[192:195], a[32:35], v[176:191]
    ds_read_b64_tr_b16 a[180:181], v26 offset:12352
    ds_read_b64_tr_b16 a[182:183], v26 offset:13120
    v_rcp_f32 v128, v128
    v_rcp_f32 v129, v129
    v_rcp_f32_e64 v130, v130
    v_mfma_f32_16x16x32_bf16 v[132:135], v[20:23], a[184:187], v[132:135]
    s_mov_b32 s80, 0
    s_waitcnt vmcnt(10)
    v_cmp_ne_u32 vcc, v35, v16
    s_nop 0
    s_cbranch_vccz L_ok_fwB
L_retry_fwB:
    s_sleep 1
    buffer_load_dword v35, v34, s[36:39], 0 offen offset:0 sc1
    s_waitcnt vmcnt(0)
    v_cmp_ne_u32 vcc, v35, v16
    s_add_u32 s80, s80, 1
    s_cmp_lt_u32 s80, 100000
    s_cselect_b64 s[82:83], vcc, 0
    s_cmp_lg_u64 s[82:83], 0
    s_cbranch_scc1 L_retry_fwB
    s_nop 4
L_ok_fwB:
    v_mfma_f32_16x16x32_bf16 v[136:139], v[20:23], a[188:191], v[136:139]
    v_rcp_f32 v131, v131
    v_mfma_f32_16x16x32_bf16 v[140:143], v[20:23], a[192:195], v[140:143]
    v_pk_mul_f32 v[208:209], v[208:209], v[124:125]
    s_waitcnt lgkmcnt(6)
    v_mfma_f32_32x32x16_bf16 v[144:159], a[160:163], a[36:39], v[144:159]
    ds_read_b64_tr_b16 a[184:185], v27 offset:12288
    ds_read_b64_tr_b16 a[186:187], v27 offset:13056
    v_pk_mul_f32 v[210:211], v[210:211], v[126:127]
    v_pk_mul_f32 v[212:213], v[212:213], v[128:129]
    v_pk_mul_f32 v[214:215], v[214:215], v[130:131]
    v_cvt_pk_bf16_f32 v208, v208, v209
    v_cvt_pk_bf16_f32 v209, v210, v211
    v_mfma_f32_32x32x16_bf16 v[160:175], a[164:167], a[36:39], v[160:175]
    ds_read_b64_tr_b16 a[188:189], v27 offset:12320
    ds_read_b64_tr_b16 a[190:191], v27 offset:13088
    v_cvt_pk_bf16_f32 v210, v212, v213
    v_cvt_pk_bf16_f32 v211, v214, v215
    buffer_store_dwordx4 v[208:211], v28, s[36:39], 0 offen offset:1024 sc1
    v_pk_mul_f32 v[124:125], v[216:217], v[50:51] neg_lo:[0,1] neg_hi:[0,1]
    v_pk_mul_f32 v[126:127], v[218:219], v[50:51] neg_lo:[0,1] neg_hi:[0,1]
    v_pk_mul_f32 v[128:129], v[220:221], v[50:51] neg_lo:[0,1] neg_hi:[0,1]
    v_mfma_f32_32x32x16_bf16 v[176:191], a[168:171], a[36:39], v[176:191]
    ds_read_b64_tr_b16 a[192:193], v27 offset:12352
    ds_read_b64_tr_b16 a[194:195], v27 offset:13120
    v_pk_mul_f32 v[130:131], v[222:223], v[50:51] neg_lo:[0,1] neg_hi:[0,1]
    v_exp_f32 v124, v124
    v_exp_f32 v125, v125
    s_barrier
    s_waitcnt lgkmcnt(6)
    v_mfma_f32_32x32x16_bf16 v[144:159], a[172:175], a[40:43], v[144:159]
    ds_read_b64_tr_b16 a[160:161], v24 offset:32768
    ds_read_b64_tr_b16 a[162:163], v24 offset:33536
    v_exp_f32 v126, v126
    v_exp_f32 v127, v127
    v_exp_f32 v128, v128
    v_mfma_f32_32x32x16_bf16 v[160:175], a[176:179], a[40:43], v[160:175]
    ds_read_b64_tr_b16 a[164:165], v24 offset:32800
    ds_read_b64_tr_b16 a[166:167], v24 offset:33568
    v_exp_f32 v129, v129
    v_exp_f32 v130, v130
    v_exp_f32_e64 v131, v131
    v_mfma_f32_32x32x16_bf16 v[176:191], a[180:183], a[40:43], v[176:191]
    ds_read_b64_tr_b16 a[168:169], v24 offset:32832
    ds_read_b64_tr_b16 a[170:171], v24 offset:33600
    v_pk_fma_f32 v[124:125], v[124:125], v[56:57], v[56:57] op_sel_hi:[1,0,0]
    v_pk_fma_f32 v[126:127], v[126:127], v[56:57], v[56:57] op_sel_hi:[1,0,0]
    v_pk_fma_f32 v[128:129], v[128:129], v[56:57], v[56:57] op_sel_hi:[1,0,0]
    v_pk_fma_f32 v[130:131], v[130:131], v[56:57], v[56:57] op_sel_hi:[1,0,0]
    s_waitcnt lgkmcnt(6)
    v_mfma_f32_32x32x16_bf16 v[144:159], a[184:187], a[44:47], v[144:159]
    ds_read_b64_tr_b16 a[172:173], v25 offset:32768
    ds_read_b64_tr_b16 a[174:175], v25 offset:33536
    v_rcp_f32 v124, v124
    v_rcp_f32 v125, v125
    v_rcp_f32 v126, v126
    v_mfma_f32_32x32x16_bf16 v[160:175], a[188:191], a[44:47], v[160:175]
    ds_read_b64_tr_b16 a[176:177], v25 offset:32800
    ds_read_b64_tr_b16 a[178:179], v25 offset:33568
    v_rcp_f32 v127, v127
    v_rcp_f32 v128, v128
    v_rcp_f32_e64 v129, v129
    v_mfma_f32_32x32x16_bf16 v[176:191], a[192:195], a[44:47], v[176:191]
    ds_read_b64_tr_b16 a[180:181], v25 offset:32832
    ds_read_b64_tr_b16 a[182:183], v25 offset:33600
    v_rcp_f32 v130, v130
    v_rcp_f32 v131, v131
    v_pk_mul_f32 v[216:217], v[216:217], v[124:125]
    s_waitcnt lgkmcnt(6)
    v_mfma_f32_32x32x16_bf16 v[144:159], a[160:163], a[48:51], v[144:159]
    ds_read_b64_tr_b16 a[184:185], v26 offset:32768
    ds_read_b64_tr_b16 a[186:187], v26 offset:33536
    v_pk_mul_f32 v[218:219], v[218:219], v[126:127]
    v_pk_mul_f32 v[220:221], v[220:221], v[128:129]
    v_pk_mul_f32 v[222:223], v[222:223], v[130:131]
    v_cvt_pk_bf16_f32 v216, v216, v217
    v_cvt_pk_bf16_f32 v217, v218, v219
    v_mfma_f32_32x32x16_bf16 v[160:175], a[164:167], a[48:51], v[160:175]
    ds_read_b64_tr_b16 a[188:189], v26 offset:32800
    ds_read_b64_tr_b16 a[190:191], v26 offset:33568
    v_cvt_pk_bf16_f32 v218, v220, v221
    v_cvt_pk_bf16_f32 v219, v222, v223
    buffer_store_dwordx4 v[216:219], v28, s[36:39], 0 offen offset:1536 sc1
    v_pk_mul_f32 v[124:125], v[224:225], v[50:51] neg_lo:[0,1] neg_hi:[0,1]
    v_pk_mul_f32 v[126:127], v[226:227], v[50:51] neg_lo:[0,1] neg_hi:[0,1]
    v_pk_mul_f32 v[128:129], v[228:229], v[50:51] neg_lo:[0,1] neg_hi:[0,1]
    v_mfma_f32_32x32x16_bf16 v[176:191], a[168:171], a[48:51], v[176:191]
    ds_read_b64_tr_b16 a[192:193], v26 offset:32832
    ds_read_b64_tr_b16 a[194:195], v26 offset:33600
    v_pk_mul_f32 v[130:131], v[230:231], v[50:51] neg_lo:[0,1] neg_hi:[0,1]
    v_exp_f32 v124, v124
    v_exp_f32_e64 v125, v125
    v_mfma_f32_16x16x32_bf16 v[132:135], v[20:23], a[160:163], v[132:135]
    v_exp_f32_e64 v126, v126
    v_mfma_f32_16x16x32_bf16 v[136:139], v[20:23], a[164:167], v[136:139]
    v_exp_f32_e64 v127, v127
    v_mfma_f32_16x16x32_bf16 v[140:143], v[20:23], a[168:171], v[140:143]
    s_waitcnt lgkmcnt(6)
    v_mfma_f32_32x32x16_bf16 v[144:159], a[172:175], a[52:55], v[144:159]
    ds_read_b64_tr_b16 a[160:161], v27 offset:32768
    ds_read_b64_tr_b16 a[162:163], v27 offset:33536
    v_exp_f32 v128, v128
    v_exp_f32 v129, v129
    v_exp_f32 v130, v130
    v_mfma_f32_32x32x16_bf16 v[160:175], a[176:179], a[52:55], v[160:175]
    ds_read_b64_tr_b16 a[164:165], v27 offset:32800
    ds_read_b64_tr_b16 a[166:167], v27 offset:33568
    v_exp_f32_e64 v131, v131
    v_pk_fma_f32 v[124:125], v[124:125], v[56:57], v[56:57] op_sel_hi:[1,0,0]
    v_pk_fma_f32 v[126:127], v[126:127], v[56:57], v[56:57] op_sel_hi:[1,0,0]
    v_pk_fma_f32 v[128:129], v[128:129], v[56:57], v[56:57] op_sel_hi:[1,0,0]
    v_mfma_f32_32x32x16_bf16 v[176:191], a[180:183], a[52:55], v[176:191]
    ds_read_b64_tr_b16 a[168:169], v27 offset:32832
    ds_read_b64_tr_b16 a[170:171], v27 offset:33600
    v_pk_fma_f32 v[130:131], v[130:131], v[56:57], v[56:57] op_sel_hi:[1,0,0]
    v_rcp_f32 v124, v124
    v_rcp_f32 v125, v125
    s_barrier
    s_waitcnt lgkmcnt(6)
    v_mfma_f32_32x32x16_bf16 v[144:159], a[184:187], a[56:59], v[144:159]
    ds_read_b64_tr_b16 a[172:173], v24 offset:45056
    ds_read_b64_tr_b16 a[174:175], v24 offset:45824
    ds_read_b64_tr_b16 a[176:177], v24 offset:45088
    s_mov_b32 s70, 0
    s_add_u32 m0, s74, 61440
    s_nop 0
    buffer_load_dwordx4 v30, s[36:39], s70 offen offset:0 sc1 lds
    v_rcp_f32_e64 v126, v126
    v_mfma_f32_32x32x16_bf16 v[160:175], a[188:191], a[56:59], v[160:175]
    ds_read_b64_tr_b16 a[178:179], v24 offset:45856
    ds_read_b64_tr_b16 a[180:181], v24 offset:45120
    buffer_load_dwordx4 v30, s[36:39], s70 offen offset:1024 sc1 lds
    v_rcp_f32 v127, v127
    v_rcp_f32 v128, v128
    v_mfma_f32_32x32x16_bf16 v[176:191], a[192:195], a[56:59], v[176:191]
    ds_read_b64_tr_b16 a[182:183], v24 offset:45888
    v_subrev_u32 v24, 65536, v24
    v_rcp_f32 v129, v129
    v_rcp_f32 v130, v130
    s_waitcnt lgkmcnt(6)
    v_mfma_f32_32x32x16_bf16 v[144:159], a[160:163], a[60:63], v[144:159]
    ds_read_b64_tr_b16 a[184:185], v25 offset:45056
    ds_read_b64_tr_b16 a[186:187], v25 offset:45824
    ds_read_b64_tr_b16 a[188:189], v25 offset:45088
    buffer_load_dwordx4 v30, s[36:39], s70 offen offset:2048 sc1 lds
    v_rcp_f32 v131, v131
    v_pk_mul_f32 v[224:225], v[224:225], v[124:125]
    v_pk_mul_f32 v[226:227], v[226:227], v[126:127]
    v_mfma_f32_32x32x16_bf16 v[160:175], a[164:167], a[60:63], v[160:175]
    ds_read_b64_tr_b16 a[190:191], v25 offset:45856
    ds_read_b64_tr_b16 a[192:193], v25 offset:45120
    v_pk_mul_f32 v[228:229], v[228:229], v[128:129]
    buffer_load_dword v35, v36, s[36:39], 0 offen offset:48 sc1
    v_pk_mul_f32 v[230:231], v[230:231], v[130:131]
    v_cvt_pk_bf16_f32 v224, v224, v225
    v_cvt_pk_bf16_f32 v225, v226, v227
    v_cvt_pk_bf16_f32 v226, v228, v229
    v_mfma_f32_32x32x16_bf16 v[176:191], a[168:171], a[60:63], v[176:191]
    ds_read_b64_tr_b16 a[194:195], v25 offset:45888
    v_subrev_u32 v25, 65536, v25
    v_cvt_pk_bf16_f32 v227, v230, v231
    buffer_store_dwordx4 v[224:227], v28, s[36:39], 0 offen offset:2048 sc1
    v_pk_mul_f32 v[124:125], v[232:233], v[50:51] neg_lo:[0,1] neg_hi:[0,1]
    v_pk_mul_f32 v[126:127], v[234:235], v[50:51] neg_lo:[0,1] neg_hi:[0,1]
    v_pk_mul_f32 v[128:129], v[236:237], v[50:51] neg_lo:[0,1] neg_hi:[0,1]
    s_waitcnt lgkmcnt(6)
    v_mfma_f32_32x32x16_bf16 v[144:159], a[172:175], a[64:67], v[144:159]
    ds_read_b64_tr_b16 a[160:161], v26 offset:45056
    ds_read_b64_tr_b16 a[162:163], v26 offset:45824
    buffer_load_dwordx4 v30, s[36:39], s70 offen offset:3072 sc1 lds
    v_pk_mul_f32 v[130:131], v[238:239], v[50:51] neg_lo:[0,1] neg_hi:[0,1]
    v_exp_f32 v124, v124
    v_exp_f32_e64 v125, v125
    v_mfma_f32_32x32x16_bf16 v[160:175], a[176:179], a[64:67], v[160:175]
    ds_read_b64_tr_b16 a[164:165], v26 offset:45088
    ds_read_b64_tr_b16 a[166:167], v26 offset:45856
    v_exp_f32 v126, v126
    v_exp_f32 v127, v127
    v_exp_f32_e64 v128, v128
    v_mfma_f32_32x32x16_bf16 v[176:191], a[180:183], a[64:67], v[176:191]
    ds_read_b64_tr_b16 a[168:169], v26 offset:45120
    ds_read_b64_tr_b16 a[170:171], v26 offset:45888
    v_exp_f32 v129, v129
    v_exp_f32 v130, v130
    v_exp_f32_e64 v131, v131
    v_mfma_f32_16x16x32_bf16 v[132:135], v[20:23], a[172:175], v[132:135]
    v_subrev_u32 v26, 65536, v26
    v_pk_fma_f32 v[124:125], v[124:125], v[56:57], v[56:57] op_sel_hi:[1,0,0]
    v_mfma_f32_16x16x32_bf16 v[136:139], v[20:23], a[176:179], v[136:139]
    s_mov_b32 s70, 4096
    s_add_u32 m0, s74, 65536
    v_mfma_f32_16x16x32_bf16 v[140:143], v[20:23], a[180:183], v[140:143]
    buffer_load_dwordx4 v30, s[36:39], s70 offen sc1 lds
    v_pk_fma_f32 v[126:127], v[126:127], v[56:57], v[56:57] op_sel_hi:[1,0,0]
    s_waitcnt lgkmcnt(6)
    v_mfma_f32_32x32x16_bf16 v[144:159], a[184:187], a[68:71], v[144:159]
    ds_read_b64_tr_b16 a[172:173], v27 offset:45056
    ds_read_b64_tr_b16 a[174:175], v27 offset:45824
    ds_read_b64_tr_b16 a[176:177], v27 offset:45088
    v_pk_fma_f32 v[128:129], v[128:129], v[56:57], v[56:57] op_sel_hi:[1,0,0]
    v_pk_fma_f32 v[130:131], v[130:131], v[56:57], v[56:57] op_sel_hi:[1,0,0]
    v_rcp_f32 v124, v124
    v_mfma_f32_32x32x16_bf16 v[160:175], a[188:191], a[68:71], v[160:175]
    ds_read_b64_tr_b16 a[178:179], v27 offset:45856
    ds_read_b64_tr_b16 a[180:181], v27 offset:45120
    v_rcp_f32 v125, v125
    v_rcp_f32 v126, v126
    v_rcp_f32_e64 v127, v127
    v_mfma_f32_32x32x16_bf16 v[176:191], a[192:195], a[68:71], v[176:191]
    ds_read_b64_tr_b16 a[182:183], v27 offset:45888
    v_subrev_u32 v27, 65536, v27
    v_rcp_f32 v128, v128
    v_rcp_f32 v129, v129
    s_barrier
    s_waitcnt lgkmcnt(6)
    v_mfma_f32_32x32x16_bf16 v[144:159], a[160:163], a[72:75], v[144:159]
    ds_read_b64_tr_b16 a[184:185], v24 offset:0
    ds_read_b64_tr_b16 a[186:187], v24 offset:768
    s_mov_b32 s70, 20480
    s_add_u32 m0, s74, 81920
    s_nop 0
    buffer_load_dwordx4 v30, s[36:39], s70 offen offset:0 sc1 lds
    v_rcp_f32 v130, v130
    v_mfma_f32_32x32x16_bf16 v[160:175], a[164:167], a[72:75], v[160:175]
    ds_read_b64_tr_b16 a[188:189], v24 offset:32
    ds_read_b64_tr_b16 a[190:191], v24 offset:800
    v_rcp_f32_e64 v131, v131
    v_pk_mul_f32 v[232:233], v[232:233], v[124:125]
    v_pk_mul_f32 v[234:235], v[234:235], v[126:127]
    v_pk_mul_f32 v[236:237], v[236:237], v[128:129]
    v_mfma_f32_32x32x16_bf16 v[176:191], a[168:171], a[72:75], v[176:191]
    ds_read_b64_tr_b16 a[192:193], v24 offset:64
    ds_read_b64_tr_b16 a[194:195], v24 offset:832
    buffer_load_dwordx4 v30, s[36:39], s70 offen offset:1024 sc1 lds
    v_pk_mul_f32 v[238:239], v[238:239], v[130:131]
    v_cvt_pk_bf16_f32 v232, v232, v233
    v_cvt_pk_bf16_f32 v233, v234, v235
    v_cvt_pk_bf16_f32 v234, v236, v237
    s_waitcnt lgkmcnt(6)
    v_mfma_f32_32x32x16_bf16 v[144:159], a[172:175], a[76:79], v[144:159]
    ds_read_b64_tr_b16 a[160:161], v25 offset:0
    ds_read_b64_tr_b16 a[162:163], v25 offset:768
    v_cvt_pk_bf16_f32 v235, v238, v239
    buffer_store_dwordx4 v[232:235], v28, s[36:39], 0 offen offset:2560 sc1
    v_pk_mul_f32 v[124:125], v[240:241], v[50:51] neg_lo:[0,1] neg_hi:[0,1]
    v_pk_mul_f32 v[126:127], v[242:243], v[50:51] neg_lo:[0,1] neg_hi:[0,1]
    v_pk_mul_f32 v[128:129], v[244:245], v[50:51] neg_lo:[0,1] neg_hi:[0,1]
    v_pk_mul_f32 v[130:131], v[246:247], v[50:51] neg_lo:[0,1] neg_hi:[0,1]
    v_mfma_f32_32x32x16_bf16 v[160:175], a[176:179], a[76:79], v[160:175]
    ds_read_b64_tr_b16 a[164:165], v25 offset:32
    ds_read_b64_tr_b16 a[166:167], v25 offset:800
    v_exp_f32 v124, v124
    v_exp_f32 v125, v125
    v_exp_f32 v126, v126
    v_mfma_f32_32x32x16_bf16 v[176:191], a[180:183], a[76:79], v[176:191]
    ds_read_b64_tr_b16 a[168:169], v25 offset:64
    ds_read_b64_tr_b16 a[170:171], v25 offset:832
    buffer_load_dwordx4 v30, s[36:39], s70 offen offset:2048 sc1 lds
    v_exp_f32 v127, v127
    v_exp_f32 v128, v128
    s_waitcnt lgkmcnt(6)
    v_mfma_f32_32x32x16_bf16 v[144:159], a[184:187], a[80:83], v[144:159]
    ds_read_b64_tr_b16 a[172:173], v26 offset:0
    ds_read_b64_tr_b16 a[174:175], v26 offset:768
    v_exp_f32 v129, v129
    v_exp_f32 v130, v130
    v_exp_f32 v131, v131
    v_mfma_f32_32x32x16_bf16 v[160:175], a[188:191], a[80:83], v[160:175]
    ds_read_b64_tr_b16 a[176:177], v26 offset:32
    ds_read_b64_tr_b16 a[178:179], v26 offset:800
    v_pk_fma_f32 v[124:125], v[124:125], v[56:57], v[56:57] op_sel_hi:[1,0,0]
    v_pk_fma_f32 v[126:127], v[126:127], v[56:57], v[56:57] op_sel_hi:[1,0,0]
    v_pk_fma_f32 v[128:129], v[128:129], v[56:57], v[56:57] op_sel_hi:[1,0,0]
    v_pk_fma_f32 v[130:131], v[130:131], v[56:57], v[56:57] op_sel_hi:[1,0,0]
    v_mfma_f32_32x32x16_bf16 v[176:191], a[192:195], a[80:83], v[176:191]
    ds_read_b64_tr_b16 a[180:181], v26 offset:64
    ds_read_b64_tr_b16 a[182:183], v26 offset:832
    buffer_load_dwordx4 v30, s[36:39], s70 offen offset:3072 sc1 lds
    v_rcp_f32 v124, v124
    v_rcp_f32 v125, v125
    v_mfma_f32_16x16x32_bf16 v[132:135], v[20:23], a[184:187], v[132:135]
    v_rcp_f32_e64 v126, v126
    v_mfma_f32_16x16x32_bf16 v[136:139], v[20:23], a[188:191], v[136:139]
    v_rcp_f32_e64 v127, v127
    v_mfma_f32_16x16x32_bf16 v[140:143], v[20:23], a[192:195], v[140:143]
    s_waitcnt lgkmcnt(6)
    v_mfma_f32_32x32x16_bf16 v[144:159], a[160:163], a[84:87], v[144:159]
    ds_read_b64_tr_b16 a[184:185], v27 offset:0
    ds_read_b64_tr_b16 a[186:187], v27 offset:768
    s_mov_b32 s70, 24576
    s_add_u32 m0, s74, 86016
    s_nop 0
    buffer_load_dwordx4 v30, s[36:39], s70 offen sc1 lds
    v_rcp_f32_e64 v128, v128
    v_mfma_f32_32x32x16_bf16 v[160:175], a[164:167], a[84:87], v[160:175]
    ds_read_b64_tr_b16 a[188:189], v27 offset:32
    ds_read_b64_tr_b16 a[190:191], v27 offset:800
    v_rcp_f32 v129, v129
    v_rcp_f32 v130, v130
    v_rcp_f32_e64 v131, v131
    v_mfma_f32_32x32x16_bf16 v[176:191], a[168:171], a[84:87], v[176:191]
    ds_read_b64_tr_b16 a[192:193], v27 offset:64
    ds_read_b64_tr_b16 a[194:195], v27 offset:832
    v_pk_mul_f32 v[240:241], v[240:241], v[124:125]
    v_pk_mul_f32 v[242:243], v[242:243], v[126:127]
    v_pk_mul_f32 v[244:245], v[244:245], v[128:129]
    v_pk_mul_f32 v[246:247], v[246:247], v[130:131]
    v_cvt_pk_bf16_f32 v240, v240, v241
    s_barrier
    s_waitcnt lgkmcnt(6)
    v_mfma_f32_32x32x16_bf16 v[144:159], a[172:175], a[88:91], v[144:159]
    ds_read_b64_tr_b16 a[160:161], v24 offset:12288
    ds_read_b64_tr_b16 a[162:163], v24 offset:13056
    s_mov_b32 s70, 40960
    s_add_u32 m0, s74, 102400
    s_nop 0
    buffer_load_dwordx4 v30, s[36:39], s70 offen offset:0 sc1 lds
    v_cvt_pk_bf16_f32 v241, v242, v243
    v_cvt_pk_bf16_f32 v242, v244, v245
    v_cvt_pk_bf16_f32 v243, v246, v247
    v_mfma_f32_32x32x16_bf16 v[160:175], a[176:179], a[88:91], v[160:175]
    ds_read_b64_tr_b16 a[164:165], v24 offset:12320
    ds_read_b64_tr_b16 a[166:167], v24 offset:13088
    buffer_store_dwordx4 v[240:243], v28, s[36:39], 0 offen offset:3072 sc1
    v_pk_mul_f32 v[124:125], v[248:249], v[50:51] neg_lo:[0,1] neg_hi:[0,1]
    v_pk_mul_f32 v[126:127], v[250:251], v[50:51] neg_lo:[0,1] neg_hi:[0,1]
    v_pk_mul_f32 v[128:129], v[252:253], v[50:51] neg_lo:[0,1] neg_hi:[0,1]
    v_pk_mul_f32 v[130:131], v[254:255], v[50:51] neg_lo:[0,1] neg_hi:[0,1]
    v_mfma_f32_32x32x16_bf16 v[176:191], a[180:183], a[88:91], v[176:191]
    ds_read_b64_tr_b16 a[168:169], v24 offset:12352
    ds_read_b64_tr_b16 a[170:171], v24 offset:13120
    v_exp_f32 v124, v124
    v_exp_f32 v125, v125
    s_waitcnt lgkmcnt(6)
    v_mfma_f32_32x32x16_bf16 v[144:159], a[184:187], a[92:95], v[144:159]
    ds_read_b64_tr_b16 a[172:173], v25 offset:12288
    ds_read_b64_tr_b16 a[174:175], v25 offset:13056
    buffer_load_dwordx4 v30, s[36:39], s70 offen offset:1024 sc1 lds
    v_exp_f32 v126, v126
    v_exp_f32 v127, v127
    v_mfma_f32_32x32x16_bf16 v[160:175], a[188:191], a[92:95], v[160:175]
    ds_read_b64_tr_b16 a[176:177], v25 offset:12320
    ds_read_b64_tr_b16 a[178:179], v25 offset:13088
    v_exp_f32 v128, v128
    v_exp_f32 v129, v129
    v_exp_f32_e64 v130, v130
    v_mfma_f32_32x32x16_bf16 v[176:191], a[192:195], a[92:95], v[176:191]
    ds_read_b64_tr_b16 a[180:181], v25 offset:12352
    ds_read_b64_tr_b16 a[182:183], v25 offset:13120
    v_exp_f32_e64 v131, v131
    v_pk_fma_f32 v[124:125], v[124:125], v[56:57], v[56:57] op_sel_hi:[1,0,0]
    v_pk_fma_f32 v[126:127], v[126:127], v[56:57], v[56:57] op_sel_hi:[1,0,0]
    v_pk_fma_f32 v[128:129], v[128:129], v[56:57], v[56:57] op_sel_hi:[1,0,0]
    s_waitcnt lgkmcnt(6)
    v_mfma_f32_32x32x16_bf16 v[144:159], a[160:163], a[96:99], v[144:159]
    ds_read_b64_tr_b16 a[184:185], v26 offset:12288
    ds_read_b64_tr_b16 a[186:187], v26 offset:13056
    buffer_load_dwordx4 v30, s[36:39], s70 offen offset:2048 sc1 lds
    v_pk_fma_f32 v[130:131], v[130:131], v[56:57], v[56:57] op_sel_hi:[1,0,0]
    v_rcp_f32 v124, v124
    v_rcp_f32_e64 v125, v125
    v_mfma_f32_32x32x16_bf16 v[160:175], a[164:167], a[96:99], v[160:175]
    ds_read_b64_tr_b16 a[188:189], v26 offset:12320
    ds_read_b64_tr_b16 a[190:191], v26 offset:13088
    v_rcp_f32 v126, v126
    v_rcp_f32 v127, v127
    v_rcp_f32_e64 v128, v128
    v_mfma_f32_32x32x16_bf16 v[176:191], a[168:171], a[96:99], v[176:191]
    ds_read_b64_tr_b16 a[192:193], v26 offset:12352
    ds_read_b64_tr_b16 a[194:195], v26 offset:13120
    v_rcp_f32 v129, v129
    v_rcp_f32 v130, v130
    v_rcp_f32_e64 v131, v131
    v_mfma_f32_16x16x32_bf16 v[132:135], v[20:23], a[160:163], v[132:135]
    v_pk_mul_f32 v[248:249], v[248:249], v[124:125]
    v_pk_mul_f32 v[250:251], v[250:251], v[126:127]
    v_mfma_f32_16x16x32_bf16 v[136:139], v[20:23], a[164:167], v[136:139]
    buffer_load_dwordx4 v30, s[36:39], s70 offen offset:3072 sc1 lds
    v_pk_mul_f32 v[252:253], v[252:253], v[128:129]
    v_mfma_f32_16x16x32_bf16 v[140:143], v[20:23], a[168:171], v[140:143]
    v_pk_mul_f32 v[254:255], v[254:255], v[130:131]
    s_waitcnt lgkmcnt(6)
    v_mfma_f32_32x32x16_bf16 v[144:159], a[172:175], a[100:103], v[144:159]
    ds_read_b64_tr_b16 a[160:161], v27 offset:12288
    ds_read_b64_tr_b16 a[162:163], v27 offset:13056
    v_cvt_pk_bf16_f32 v248, v248, v249
    v_cvt_pk_bf16_f32 v249, v250, v251
    v_cvt_pk_bf16_f32 v250, v252, v253
    v_cvt_pk_bf16_f32 v251, v254, v255
    buffer_store_dwordx4 v[248:251], v28, s[36:39], 0 offen offset:3584 sc1
    s_mul_i32 s63, s58, 13568
    v_mfma_f32_32x32x16_bf16 v[160:175], a[176:179], a[100:103], v[160:175]
    ds_read_b64_tr_b16 a[164:165], v27 offset:12320
    ds_read_b64_tr_b16 a[166:167], v27 offset:13088
    s_add_u32 s63, s63, 13434880
    v_lshl_add_u32 v58, v0, 4, s63
    s_movk_i32 s66, 72
    v_cmp_gt_u32 s[96:97], s66, v0
    v_mov_b32 v2, 2130706432
    s_nop 0
    v_cndmask_b32 v59, v2, v58, s[96:97]
    v_mfma_f32_32x32x16_bf16 v[176:191], a[180:183], a[100:103], v[176:191]
    ds_read_b64_tr_b16 a[168:169], v27 offset:12352
    ds_read_b64_tr_b16 a[170:171], v27 offset:13120
    s_mov_b32 s70, 45056
    s_add_u32 m0, s74, 106496
    s_nop 0
    buffer_load_dwordx4 v30, s[36:39], s70 offen sc1 lds
    v_add_u32_e64 v3, 0, v0
    v_mul_u32_u24 v4, 3121, v3
    s_waitcnt vmcnt(30)
    s_barrier
    s_waitcnt lgkmcnt(6)
    v_mfma_f32_32x32x16_bf16 v[144:159], a[184:187], a[104:107], v[144:159]
    ds_read_b64_tr_b16 a[172:173], v24 offset:32768
    ds_read_b64_tr_b16 a[174:175], v24 offset:33536
    v_lshrrev_b32 v4, 16, v4
    v_mul_u32_u24 v5, 21, v4
    v_sub_u32 v5, v3, v5
    v_mul_u32_u24 v6, 6554, v4
    v_lshrrev_b32_e64 v6, 16, v6
    v_mfma_f32_32x32x16_bf16 v[160:175], a[188:191], a[104:107], v[160:175]
    ds_read_b64_tr_b16 a[176:177], v24 offset:32800
    ds_read_b64_tr_b16 a[178:179], v24 offset:33568
    v_mul_u32_u24 v7, 10, v6
    v_sub_u32 v7, v4, v7
    v_mul_u32_u24 v6, 1920, v6
    v_mul_u32_u24 v5, 80, v5
    v_lshl_add_u32 v5, v7, 3, v5
    v_mfma_f32_32x32x16_bf16 v[176:191], a[192:195], a[104:107], v[176:191]
    ds_read_b64_tr_b16 a[180:181], v24 offset:32832
    ds_read_b64_tr_b16 a[182:183], v24 offset:33600
    v_add_u32_e64 v5, v5, v6
    v_add_u32 v60, 147456, v5
    v_add_u32 v3, 256, v0
    v_mul_u32_u24 v4, 3121, v3
    v_lshrrev_b32 v4, 16, v4
    s_waitcnt lgkmcnt(6)
    v_mfma_f32_32x32x16_bf16 v[144:159], a[160:163], a[108:111], v[144:159]
    ds_read_b64_tr_b16 a[184:185], v25 offset:32768
    ds_read_b64_tr_b16 a[186:187], v25 offset:33536
    v_mul_u32_u24 v5, 21, v4
    v_sub_u32 v5, v3, v5
    v_mul_u32_u24 v6, 6554, v4
    v_lshrrev_b32 v6, 16, v6
    v_mul_u32_u24 v7, 10, v6
    v_mfma_f32_32x32x16_bf16 v[160:175], a[164:167], a[108:111], v[160:175]
    ds_read_b64_tr_b16 a[188:189], v25 offset:32800
    ds_read_b64_tr_b16 a[190:191], v25 offset:33568
    v_sub_u32_e64 v7, v4, v7
    v_mul_u32_u24 v6, 1920, v6
    v_mul_u32_u24 v5, 80, v5
    v_lshl_add_u32 v5, v7, 3, v5
    v_add_u32_e64 v5, v5, v6
    v_mfma_f32_32x32x16_bf16 v[176:191], a[168:171], a[108:111], v[176:191]
    ds_read_b64_tr_b16 a[192:193], v25 offset:32832
    ds_read_b64_tr_b16 a[194:195], v25 offset:33600
    v_add_u32 v61, 147456, v5
    v_add_u32 v3, 512, v0
    v_mul_u32_u24 v4, 3121, v3
    v_lshrrev_b32 v4, 16, v4
    v_mul_u32_u24 v5, 21, v4
    s_waitcnt lgkmcnt(6)
    v_mfma_f32_32x32x16_bf16 v[144:159], a[172:175], a[112:115], v[144:159]
    ds_read_b64_tr_b16 a[160:161], v26 offset:32768
    ds_read_b64_tr_b16 a[162:163], v26 offset:33536
    v_sub_u32 v5, v3, v5
    v_mul_u32_u24 v6, 6554, v4
    v_lshrrev_b32 v6, 16, v6
    v_mul_u32_u24 v7, 10, v6
    v_sub_u32_e64 v7, v4, v7
    v_mfma_f32_32x32x16_bf16 v[160:175], a[176:179], a[112:115], v[160:175]
    ds_read_b64_tr_b16 a[164:165], v26 offset:32800
    ds_read_b64_tr_b16 a[166:167], v26 offset:33568
    v_mul_u32_u24 v6, 1920, v6
    v_mul_u32_u24 v5, 80, v5
    v_lshl_add_u32 v5, v7, 3, v5
    v_add_u32_e64 v5, v5, v6
    v_add_u32 v62, 147456, v5
    v_mfma_f32_32x32x16_bf16 v[176:191], a[180:183], a[112:115], v[176:191]
    ds_read_b64_tr_b16 a[168:169], v26 offset:32832
    ds_read_b64_tr_b16 a[170:171], v26 offset:33600
    v_add_u32 v3, 768, v0
    v_mul_u32_u24 v4, 3121, v3
    v_lshrrev_b32 v4, 16, v4
    v_mul_u32_u24 v5, 21, v4
    v_sub_u32_e64 v5, v3, v5
    v_mfma_f32_16x16x32_bf16 v[132:135], v[20:23], a[172:175], v[132:135]
    v_mul_u32_u24 v6, 6554, v4
    v_lshrrev_b32_e64 v6, 16, v6
    v_mfma_f32_16x16x32_bf16 v[136:139], v[20:23], a[176:179], v[136:139]
    v_mul_u32_u24 v7, 10, v6
    v_sub_u32 v7, v4, v7
    v_mfma_f32_16x16x32_bf16 v[140:143], v[20:23], a[180:183], v[140:143]
    v_mul_u32_u24 v6, 1920, v6
    s_waitcnt lgkmcnt(6)
    v_mfma_f32_32x32x16_bf16 v[144:159], a[184:187], a[116:119], v[144:159]
    ds_read_b64_tr_b16 a[172:173], v27 offset:32768
    ds_read_b64_tr_b16 a[174:175], v27 offset:33536
    v_mul_u32_u24 v5, 80, v5
    v_lshl_add_u32 v5, v7, 3, v5
    v_add_u32 v5, v5, v6
    v_add_u32 v63, 147456, v5
    v_mov_b32 v3, 155264
    v_mfma_f32_32x32x16_bf16 v[160:175], a[188:191], a[116:119], v[160:175]
    ds_read_b64_tr_b16 a[176:177], v27 offset:32800
    ds_read_b64_tr_b16 a[178:179], v27 offset:33568
    v_cndmask_b32 v63, v3, v63, s[96:97]
    v_mov_b32 v4, 0
    v_lshlrev_b32 v3, 2, v15
    v_add_u32 v3, 155136, v3
    ds_write_b32 v3, v4
    v_bfe_u32 v3, v1, 2, 1
    v_mfma_f32_32x32x16_bf16 v[176:191], a[192:195], a[116:119], v[176:191]
    ds_read_b64_tr_b16 a[180:181], v27 offset:32832
    ds_read_b64_tr_b16 a[182:183], v27 offset:33600
    v_cmp_eq_u32 s[98:99], v3, v14
    v_bfe_u32 v4, v1, 3, 2
    v_lshl_add_u32 v4, v4, 2, v13
    v_mul_u32_u24 v5, 80, v4
    v_mul_u32_u24 v6, 3840, v14
    s_waitcnt vmcnt(26)
    s_barrier
    s_waitcnt lgkmcnt(7)
    v_mfma_f32_32x32x16_bf16 v[144:159], a[160:163], a[120:123], v[144:159]
    ds_read_b64_tr_b16 a[184:185], v24 offset:45056
    ds_read_b64_tr_b16 a[186:187], v24 offset:45824
    ds_read_b64_tr_b16 a[188:189], v24 offset:45088
    s_mov_b32 s70, 61440
    s_add_u32 m0, s74, 0
    s_nop 0
    buffer_load_dwordx4 v30, s[36:39], s70 offen offset:0 sc1 lds
    v_add_u32 v5, v5, v6
    v_mov_b32 v7, 155136
    v_mfma_f32_32x32x16_bf16 v[160:175], a[164:167], a[120:123], v[160:175]
    ds_read_b64_tr_b16 a[190:191], v24 offset:45856
    ds_read_b64_tr_b16 a[192:193], v24 offset:45120
    buffer_load_dwordx4 v30, s[36:39], s70 offen offset:1024 sc1 lds
    v_cmp_gt_u32_e64 vcc, 8, v4
    v_add_u32 v6, 147456, v5
    v_cndmask_b32 v64, v7, v6, s[98:99]
    v_add_u32 v6, 150016, v5
    v_cndmask_b32 v67, v7, v6, s[98:99]
    v_mfma_f32_32x32x16_bf16 v[176:191], a[168:171], a[120:123], v[176:191]
    ds_read_b64_tr_b16 a[194:195], v24 offset:45888
    v_add_u32 v24, 131072, v24
    v_add_u32 v6, 148736, v5
    v_cndmask_b32_e64 v6, v7, v6, vcc
    v_cndmask_b32 v65, v7, v6, s[98:99]
    v_add_u32 v6, 148736, v5
    v_cndmask_b32 v6, v6, v7, vcc
    s_waitcnt lgkmcnt(6)
    v_mfma_f32_32x32x16_bf16 v[144:159], a[172:175], a[124:127], v[144:159]
    ds_read_b64_tr_b16 a[160:161], v25 offset:45056
    ds_read_b64_tr_b16 a[162:163], v25 offset:45824
    ds_read_b64_tr_b16 a[164:165], v25 offset:45088
    buffer_load_dwordx4 v30, s[36:39], s70 offen offset:2048 sc1 lds
    v_cndmask_b32 v66, v7, v6, s[98:99]
    s_lshl_b32 s63, s57, 3
    s_lshl_b32 s64, s56, 1
    s_add_u32 s63, s63, s64
    v_mfma_f32_32x32x16_bf16 v[160:175], a[176:179], a[124:127], v[160:175]
    ds_read_b64_tr_b16 a[166:167], v25 offset:45856
    ds_read_b64_tr_b16 a[168:169], v25 offset:45120
    s_mul_i32 s63, s63, 20480
    s_mul_i32 s64, s58, 2560
    s_add_u32 s63, s63, s64
    s_add_u32 s63, s63, 6291456
    v_lshrrev_b32_e64 v3, 4, v15
    v_mul_u32_u24 v3, 20480, v3
    v_mfma_f32_32x32x16_bf16 v[176:191], a[180:183], a[124:127], v[176:191]
    ds_read_b64_tr_b16 a[170:171], v25 offset:45888
    v_add_u32 v25, 131072, v25
    v_mul_u32_u24 v4, 1280, v14
    v_and_b32_e64 v5, 15, v1
    v_lshl_add_u32 v4, v5, 4, v4
    v_add3_u32 v49, v3, v4, s63
    s_lshl_b32 s63, s57, 7
    s_waitcnt lgkmcnt(6)
    v_mfma_f32_32x32x16_bf16 v[144:159], a[184:187], a[128:131], v[144:159]
    ds_read_b64_tr_b16 a[172:173], v26 offset:45056
    ds_read_b64_tr_b16 a[174:175], v26 offset:45824
    buffer_load_dwordx4 v30, s[36:39], s70 offen offset:3072 sc1 lds
    s_lshl_b32 s64, s58, 2
    s_add_u32 s63, s63, s64
    s_add_u32 s63, s63, 13545472
    v_cmp_eq_u32 vcc, 0, v0
    v_mov_b32 v6, s63
    v_mfma_f32_32x32x16_bf16 v[160:175], a[188:191], a[128:131], v[160:175]
    ds_read_b64_tr_b16 a[176:177], v26 offset:45088
    ds_read_b64_tr_b16 a[178:179], v26 offset:45856
    v_mov_b32 v57, 2130706432
    v_cndmask_b32 v57, v57, v6, vcc
    v_lshlrev_b32 v68, 2, v15
    v_add_u32 v68, 159744, v68
    s_mul_i32 s63, s56, 384
    v_add_u32_e64 v69, s63, v68
    v_mfma_f32_32x32x16_bf16 v[176:191], a[192:195], a[128:131], v[176:191]
    ds_read_b64_tr_b16 a[180:181], v26 offset:45120
    ds_read_b64_tr_b16 a[182:183], v26 offset:45888
    v_mfma_f32_16x16x32_bf16 v[132:135], v[20:23], a[184:187], v[132:135]
    v_add_u32 v26, 131072, v26
    v_mfma_f32_16x16x32_bf16 v[136:139], v[20:23], a[188:191], v[136:139]
    s_mov_b32 s70, 65536
    s_add_u32 m0, s74, 4096
    v_mfma_f32_16x16x32_bf16 v[140:143], v[20:23], a[192:195], v[140:143]
    buffer_load_dwordx4 v30, s[36:39], s70 offen sc1 lds
    s_waitcnt lgkmcnt(6)
    v_mfma_f32_32x32x16_bf16 v[144:159], a[160:163], a[132:135], v[144:159]
    ds_read_b64_tr_b16 a[184:185], v27 offset:45056
    ds_read_b64_tr_b16 a[186:187], v27 offset:45824
    ds_read_b64_tr_b16 a[188:189], v27 offset:45088
    v_mfma_f32_32x32x16_bf16 v[160:175], a[164:167], a[132:135], v[160:175]
    ds_read_b64_tr_b16 a[190:191], v27 offset:45856
    ds_read_b64_tr_b16 a[192:193], v27 offset:45120
    v_mfma_f32_32x32x16_bf16 v[176:191], a[168:171], a[132:135], v[176:191]
    ds_read_b64_tr_b16 a[194:195], v27 offset:45888
    v_add_u32 v27, 131072, v27
    s_waitcnt vmcnt(27)
    s_barrier
    s_waitcnt lgkmcnt(6)
    v_mfma_f32_32x32x16_bf16 v[144:159], a[172:175], a[136:139], v[144:159]
    ds_read_b64_tr_b16 a[160:161], v24 offset:0
    ds_read_b64_tr_b16 a[162:163], v24 offset:768
    s_mov_b32 s70, 81920
    s_add_u32 m0, s74, 20480
    s_nop 0
    buffer_load_dwordx4 v30, s[36:39], s70 offen offset:0 sc1 lds
    v_mfma_f32_32x32x16_bf16 v[160:175], a[176:179], a[136:139], v[160:175]
    ds_read_b64_tr_b16 a[164:165], v24 offset:32
    ds_read_b64_tr_b16 a[166:167], v24 offset:800
    v_mfma_f32_32x32x16_bf16 v[176:191], a[180:183], a[136:139], v[176:191]
    ds_read_b64_tr_b16 a[168:169], v24 offset:64
    ds_read_b64_tr_b16 a[170:171], v24 offset:832
    buffer_load_dwordx4 v30, s[36:39], s70 offen offset:1024 sc1 lds
    s_waitcnt lgkmcnt(6)
    v_mfma_f32_32x32x16_bf16 v[144:159], a[184:187], a[140:143], v[144:159]
    ds_read_b64_tr_b16 a[172:173], v25 offset:0
    ds_read_b64_tr_b16 a[174:175], v25 offset:768
    v_mfma_f32_32x32x16_bf16 v[160:175], a[188:191], a[140:143], v[160:175]
    ds_read_b64_tr_b16 a[176:177], v25 offset:32
    ds_read_b64_tr_b16 a[178:179], v25 offset:800
    v_mfma_f32_32x32x16_bf16 v[176:191], a[192:195], a[140:143], v[176:191]
    ds_read_b64_tr_b16 a[180:181], v25 offset:64
    ds_read_b64_tr_b16 a[182:183], v25 offset:832
    buffer_load_dwordx4 v30, s[36:39], s70 offen offset:2048 sc1 lds
    s_waitcnt lgkmcnt(6)
    v_mfma_f32_16x16x32_bf16 v[132:135], v[20:23], a[160:163], v[132:135]
    ds_read_b64_tr_b16 a[184:185], v26 offset:0
    ds_read_b64_tr_b16 a[186:187], v26 offset:768
    v_mfma_f32_16x16x32_bf16 v[136:139], v[20:23], a[164:167], v[136:139]
    ds_read_b64_tr_b16 a[188:189], v26 offset:32
    ds_read_b64_tr_b16 a[190:191], v26 offset:800
    v_mfma_f32_16x16x32_bf16 v[140:143], v[20:23], a[168:171], v[140:143]
    ds_read_b64_tr_b16 a[192:193], v26 offset:64
    ds_read_b64_tr_b16 a[194:195], v26 offset:832
    v_mfma_f32_32x32x16_bf16 v[144:159], a[160:163], a[144:147], v[144:159]
    buffer_load_dwordx4 v30, s[36:39], s70 offen offset:3072 sc1 lds
    v_mfma_f32_32x32x16_bf16 v[160:175], a[164:167], a[144:147], v[160:175]
    v_mfma_f32_32x32x16_bf16 v[176:191], a[168:171], a[144:147], v[176:191]
    s_waitcnt lgkmcnt(6)
    v_mfma_f32_32x32x16_bf16 v[144:159], a[172:175], a[148:151], v[144:159]
    ds_read_b64_tr_b16 a[160:161], v27 offset:0
    ds_read_b64_tr_b16 a[162:163], v27 offset:768
    ds_read_b64_tr_b16 a[164:165], v27 offset:32
    s_mov_b32 s70, 86016
    s_add_u32 m0, s74, 24576
    s_nop 0
    buffer_load_dwordx4 v30, s[36:39], s70 offen sc1 lds
    v_mfma_f32_32x32x16_bf16 v[160:175], a[176:179], a[148:151], v[160:175]
    ds_read_b64_tr_b16 a[166:167], v27 offset:800
    ds_read_b64_tr_b16 a[168:169], v27 offset:64
    ds_read_b64_tr_b16 a[170:171], v27 offset:832
    v_mfma_f32_32x32x16_bf16 v[176:191], a[180:183], a[148:151], v[176:191]
    ds_write_b32 v69, v132 offset:0
    ds_write_b32 v69, v136 offset:128
    ds_write_b32 v69, v140 offset:256
    s_waitcnt vmcnt(11)
    s_waitcnt lgkmcnt(0)
    s_barrier
    v_mfma_f32_32x32x16_bf16 v[144:159], a[184:187], a[152:155], v[144:159]
    buffer_store_dword v16, v29, s[36:39], 0 offen sc1
    ds_read_b32 v132, v68 offset:0
    ds_read_b32 v133, v68 offset:384
    ds_read_b32 v134, v68 offset:768
    ds_read_b32 v135, v68 offset:1152
    s_mov_b32 s70, 102400
    s_add_u32 m0, s74, 40960
    s_nop 0
    buffer_load_dwordx4 v30, s[36:39], s70 offen offset:0 sc1 lds
    v_mfma_f32_32x32x16_bf16 v[160:175], a[188:191], a[152:155], v[160:175]
    ds_read_b32 v136, v68 offset:128
    ds_read_b32 v137, v68 offset:512
    ds_read_b32 v138, v68 offset:896
    ds_read_b32 v139, v68 offset:1280
    v_mfma_f32_32x32x16_bf16 v[176:191], a[192:195], a[152:155], v[176:191]
    ds_read_b32 v140, v68 offset:256
    ds_read_b32 v141, v68 offset:640
    ds_read_b32 v142, v68 offset:1024
    ds_read_b32 v143, v68 offset:1408
    v_mfma_f32_32x32x16_bf16 v[144:159], a[160:163], a[156:159], v[144:159]
    s_waitcnt lgkmcnt(10)
    v_add_f32 v132, v132, v133
    s_waitcnt lgkmcnt(6)
    v_add_f32 v136, v136, v137
    s_waitcnt lgkmcnt(2)
    v_add_f32 v140, v140, v141
    v_add_f32 v134, v134, v135
    v_add_f32 v138, v138, v139
    s_waitcnt lgkmcnt(0)
    v_add_f32 v142, v142, v143
    v_add_f32 v134, v132, v134
    v_add_f32 v138, v136, v138
    v_add_f32 v142, v140, v142
    v_mfma_f32_32x32x16_bf16 v[160:175], a[164:167], a[156:159], v[160:175]
    v_cvt_pk_bf16_f32 v133, v134, 0
    v_cvt_pk_bf16_f32 v137, v138, 0
    v_cvt_pk_bf16_f32 v141, v142, 0
    v_lshlrev_b32 v135, 16, v133
    v_lshlrev_b32 v139, 16, v137
    v_lshlrev_b32 v143, 16, v141
    v_sub_f32 v135, v134, v135
    v_sub_f32 v139, v138, v139
    v_sub_f32 v143, v142, v143
    v_mfma_f32_32x32x16_bf16 v[176:191], a[168:171], a[156:159], v[176:191]
    v_cvt_pk_bf16_f32 v132, v134, v135
    v_cvt_pk_bf16_f32 v136, v138, v139
    v_cvt_pk_bf16_f32 v140, v142, v143
    v_mov_b32 v134, 0
    v_mov_b32 v138, 0
    v_mov_b32 v142, 0
    v_mov_b32 v135, 0
    v_mov_b32 v139, 0
    v_mov_b32 v143, 0
    v_mfma_f32_32x32x16_bf16 v[144:159], v[132:135], v[52:55], v[144:159]
    v_mfma_f32_32x32x16_bf16 v[160:175], v[136:139], v[52:55], v[160:175]
    v_mfma_f32_32x32x16_bf16 v[176:191], v[140:143], v[52:55], v[176:191]
    s_nop 9
    v_cvt_pk_bf16_f32 v144, v144, v145
    buffer_load_dwordx4 v30, s[36:39], s70 offen offset:1024 sc1 lds
    v_cvt_pk_bf16_f32 v145, v146, v147
    v_cvt_pk_bf16_f32 v146, v148, v149
    v_cvt_pk_bf16_f32 v147, v150, v151
    v_cvt_pk_bf16_f32 v148, v152, v153
    v_cvt_pk_bf16_f32 v149, v154, v155
    v_cvt_pk_bf16_f32 v150, v156, v157
    v_cvt_pk_bf16_f32 v151, v158, v159
    v_cvt_pk_bf16_f32 v152, v160, v161
    v_cvt_pk_bf16_f32 v153, v162, v163
    v_cvt_pk_bf16_f32 v154, v164, v165
    v_cvt_pk_bf16_f32 v155, v166, v167
    v_cvt_pk_bf16_f32 v156, v168, v169
    v_cvt_pk_bf16_f32 v157, v170, v171
    v_cvt_pk_bf16_f32 v158, v172, v173
    v_cvt_pk_bf16_f32 v159, v174, v175
    v_cvt_pk_bf16_f32 v160, v176, v177
    buffer_load_dwordx4 v30, s[36:39], s70 offen offset:2048 sc1 lds
    v_cvt_pk_bf16_f32 v161, v178, v179
    v_cvt_pk_bf16_f32 v162, v180, v181
    v_cvt_pk_bf16_f32 v163, v182, v183
    v_mfma_f32_32x32x16_bf16 v[208:223], a[200:203], v[144:147], 0
    v_mfma_f32_32x32x16_bf16 v[224:239], a[212:215], v[144:147], 0
    v_mfma_f32_32x32x16_bf16 v[208:223], a[204:207], v[148:151], v[208:223]
    buffer_load_dwordx4 v30, s[36:39], s70 offen offset:3072 sc1 lds
    v_mfma_f32_32x32x16_bf16 v[224:239], a[216:219], v[148:151], v[224:239]
    v_mfma_f32_32x32x16_bf16 v[208:223], a[208:211], v[152:155], v[208:223]
    v_mfma_f32_32x32x16_bf16 v[224:239], a[220:223], v[152:155], v[224:239]
    s_mov_b32 s70, 106496
    s_add_u32 m0, s74, 45056
    s_nop 0
    buffer_load_dwordx4 v30, s[36:39], s70 offen sc1 lds
    v_mfma_f32_32x32x16_bf16 v[240:255], a[232:235], v[152:155], 0
    v_mfma_f32_32x32x16_bf16 v[224:239], a[224:227], v[156:159], v[224:239]
    v_mfma_f32_32x32x16_bf16 v[240:255], a[236:239], v[156:159], v[240:255]
    s_mov_b32 s70, 122880
    s_add_u32 m0, s74, 122880
    s_nop 0
    buffer_load_dwordx4 v30, s[36:39], s70 offen offset:0 sc1 lds
    v_mfma_f32_32x32x16_bf16 v[224:239], a[228:231], v[160:163], v[224:239]
    v_mfma_f32_32x32x16_bf16 v[240:255], a[240:243], v[160:163], v[240:255]
    s_mov_b32 s80, 0
    v_cmp_ne_u32 vcc, v35, v16
    s_nop 0
    s_cbranch_vccz L_ok_fw2B
L_retry_fw2B:
    s_sleep 1
    buffer_load_dword v35, v36, s[36:39], 0 offen offset:48 sc1
    s_waitcnt vmcnt(0)
    v_cmp_ne_u32 vcc, v35, v16
    s_add_u32 s80, s80, 1
    s_cmp_lt_u32 s80, 100000
    s_cselect_b64 s[82:83], vcc, 0
    s_cmp_lg_u64 s[82:83], 0
    s_cbranch_scc1 L_retry_fw2B
    s_nop 4
L_ok_fw2B:
    buffer_load_dword v35, v37, s[36:39], 0 offen offset:0 sc1
    s_mul_i32 s63, s58, 217088
    s_mul_i32 s64, s57, 848
    s_add_u32 s63, s63, s64
    s_add_u32 s63, s63, 11698176
    s_lshl_b32 s65, s56, 4
    v_and_b32 v2, 15, v1
    v_add_u32 v2, s65, v2
    s_mul_i32 s65, s57, 53
    s_sub_u32 s65, 840, s65
    s_min_u32 s65, s65, 53
    v_cmp_gt_u32 s[96:97], s65, v2
    v_mul_u32_u24 v3, 54272, v11
    v_lshl_add_u32 v3, v2, 4, v3
    v_add_u32 v18, s63, v3
    v_mov_b32 v4, 2130706432
    v_cndmask_b32 v18, v4, v18, s[96:97]
    s_mul_i32 s63, s58, 13568
    s_add_u32 s63, s63, s64
    s_add_u32 s63, s63, 13434880
    v_lshl_add_u32 v19, v2, 4, s63
    buffer_load_dwordx4 v30, s[36:39], s70 offen offset:1024 sc1 lds
    v_cmp_gt_u32 vcc, 16, v1
    v_cndmask_b32 v19, v4, v19, s[96:97]
    s_nop 0
    v_cndmask_b32 v19, v4, v19, vcc
    s_mov_b32 s66, 13568
    s_mov_b32 s67, 27136
    s_mov_b32 s68, 40704
    v_max3_f32 v24, v208, v209, v210
    v_min3_f32 v25, v208, v209, v210
    v_max3_f32 v24, v24, v211, v212
    v_min3_f32 v25, v25, v211, v212
    v_max3_f32 v24, v24, v213, v214
    v_min3_f32 v25, v25, v213, v214
    v_max3_f32 v24, v24, v215, v216
    v_min3_f32 v25, v25, v215, v216
    v_max3_f32 v24, v24, v217, v218
    v_min3_f32 v25, v25, v217, v218
    v_max3_f32 v24, v24, v219, v220
    buffer_load_dwordx4 v30, s[36:39], s70 offen offset:2048 sc1 lds
    v_min3_f32 v25, v25, v219, v220
    v_max3_f32 v24, v24, v221, v222
    v_min3_f32 v25, v25, v221, v222
    v_max3_f32 v24, v24, v223, v224
    v_min3_f32 v25, v25, v223, v224
    v_max3_f32 v24, v24, v225, v226
    v_min3_f32 v25, v25, v225, v226
    v_max_f32 v24, v24, v227
    v_min_f32 v25, v25, v227
    v_mul_f32_e64 v24, -v50, v24
    v_mul_f32_e64 v25, v50, v25
    v_pk_fma_f32 v[112:113], v[208:209], v[50:51], v[24:25] op_sel_hi:[1,1,0]
    v_pk_fma_f32 v[132:133], v[208:209], v[50:51], v[24:25] op_sel:[0,0,1] op_sel_hi:[1,1,1] neg_lo:[0,1,0] neg_hi:[0,1,0]
    v_pk_fma_f32 v[114:115], v[210:211], v[50:51], v[24:25] op_sel_hi:[1,1,0]
    v_pk_fma_f32 v[134:135], v[210:211], v[50:51], v[24:25] op_sel:[0,0,1] op_sel_hi:[1,1,1] neg_lo:[0,1,0] neg_hi:[0,1,0]
    v_pk_fma_f32 v[116:117], v[212:213], v[50:51], v[24:25] op_sel_hi:[1,1,0]
    buffer_load_dwordx4 v30, s[36:39], s70 offen offset:3072 sc1 lds
    v_pk_fma_f32 v[136:137], v[212:213], v[50:51], v[24:25] op_sel:[0,0,1] op_sel_hi:[1,1,1] neg_lo:[0,1,0] neg_hi:[0,1,0]
    v_pk_fma_f32 v[118:119], v[214:215], v[50:51], v[24:25] op_sel_hi:[1,1,0]
    v_pk_fma_f32 v[138:139], v[214:215], v[50:51], v[24:25] op_sel:[0,0,1] op_sel_hi:[1,1,1] neg_lo:[0,1,0] neg_hi:[0,1,0]
    v_pk_fma_f32 v[120:121], v[216:217], v[50:51], v[24:25] op_sel_hi:[1,1,0]
    v_pk_fma_f32 v[140:141], v[216:217], v[50:51], v[24:25] op_sel:[0,0,1] op_sel_hi:[1,1,1] neg_lo:[0,1,0] neg_hi:[0,1,0]
    v_pk_fma_f32 v[122:123], v[218:219], v[50:51], v[24:25] op_sel_hi:[1,1,0]
    v_pk_fma_f32 v[142:143], v[218:219], v[50:51], v[24:25] op_sel:[0,0,1] op_sel_hi:[1,1,1] neg_lo:[0,1,0] neg_hi:[0,1,0]
    v_pk_fma_f32 v[124:125], v[220:221], v[50:51], v[24:25] op_sel_hi:[1,1,0]
    v_pk_fma_f32 v[144:145], v[220:221], v[50:51], v[24:25] op_sel:[0,0,1] op_sel_hi:[1,1,1] neg_lo:[0,1,0] neg_hi:[0,1,0]
    v_pk_fma_f32 v[126:127], v[222:223], v[50:51], v[24:25] op_sel_hi:[1,1,0]
    v_pk_fma_f32 v[146:147], v[222:223], v[50:51], v[24:25] op_sel:[0,0,1] op_sel_hi:[1,1,1] neg_lo:[0,1,0] neg_hi:[0,1,0]
    v_pk_fma_f32 v[128:129], v[224:225], v[50:51], v[24:25] op_sel_hi:[1,1,0]
    v_pk_fma_f32 v[148:149], v[224:225], v[50:51], v[24:25] op_sel:[0,0,1] op_sel_hi:[1,1,1] neg_lo:[0,1,0] neg_hi:[0,1,0]
    v_pk_fma_f32 v[130:131], v[226:227], v[50:51], v[24:25] op_sel_hi:[1,1,0]
    v_pk_fma_f32 v[150:151], v[226:227], v[50:51], v[24:25] op_sel:[0,0,1] op_sel_hi:[1,1,1] neg_lo:[0,1,0] neg_hi:[0,1,0]
    v_exp_f32_e64 v112, v112
    s_mov_b32 s70, 126976
    s_add_u32 m0, s74, 126976
    s_nop 0
    buffer_load_dwordx4 v30, s[36:39], s70 offen sc1 lds
    v_exp_f32 v113, v113
    v_exp_f32 v114, v114
    v_exp_f32 v115, v115
    v_exp_f32 v116, v116
    v_exp_f32 v117, v117
    v_exp_f32 v118, v118
    v_exp_f32 v119, v119
    v_exp_f32 v120, v120
    v_exp_f32 v121, v121
    v_exp_f32 v122, v122
    v_exp_f32 v123, v123
    v_exp_f32 v124, v124
    v_exp_f32 v125, v125
    v_exp_f32 v126, v126
    v_exp_f32 v127, v127
    v_exp_f32 v128, v128
    v_exp_f32 v129, v129
    v_exp_f32 v130, v130
    v_exp_f32 v131, v131
    v_exp_f32 v132, v132
    v_exp_f32 v133, v133
    v_exp_f32 v134, v134
    v_exp_f32 v135, v135
    v_exp_f32 v136, v136
    v_exp_f32 v137, v137
    v_exp_f32 v138, v138
    v_exp_f32 v139, v139
    v_exp_f32 v140, v140
    v_exp_f32 v141, v141
    v_exp_f32 v142, v142
    v_exp_f32 v143, v143
    v_exp_f32 v144, v144
    v_exp_f32 v145, v145
    v_exp_f32 v146, v146
    v_exp_f32 v147, v147
    v_exp_f32 v148, v148
    v_exp_f32 v149, v149
    v_exp_f32 v150, v150
    v_exp_f32 v151, v151
    v_pk_add_f32 v[68:69], v[112:113], v[114:115]
    v_pk_add_f32 v[70:71], v[132:133], v[134:135]
    v_pk_add_f32 v[68:69], v[68:69], v[116:117]
    v_pk_add_f32 v[70:71], v[70:71], v[136:137]
    v_pk_add_f32 v[68:69], v[68:69], v[118:119]
    v_pk_add_f32 v[70:71], v[70:71], v[138:139]
    v_pk_add_f32 v[68:69], v[68:69], v[120:121]
    v_pk_add_f32 v[70:71], v[70:71], v[140:141]
    v_pk_add_f32 v[68:69], v[68:69], v[122:123]
    v_pk_add_f32 v[70:71], v[70:71], v[142:143]
    v_pk_add_f32 v[68:69], v[68:69], v[124:125]
    v_pk_add_f32 v[70:71], v[70:71], v[144:145]
    v_pk_add_f32 v[68:69], v[68:69], v[126:127]
    v_pk_add_f32 v[70:71], v[70:71], v[146:147]
    v_pk_add_f32 v[68:69], v[68:69], v[128:129]
    v_pk_add_f32 v[70:71], v[70:71], v[148:149]
    v_pk_add_f32 v[68:69], v[68:69], v[130:131]
    v_pk_add_f32 v[70:71], v[70:71], v[150:151]
    v_add_f32 v68, v68, v69
    v_add_f32 v70, v70, v71
    v_rcp_f32 v68, v68
    v_rcp_f32 v70, v70
    v_pk_mul_f32 v[112:113], v[112:113], v[68:69] op_sel_hi:[1,0]
    v_pk_mul_f32 v[132:133], v[132:133], v[70:71] op_sel_hi:[1,0]
    v_pk_mul_f32 v[114:115], v[114:115], v[68:69] op_sel_hi:[1,0]
    v_pk_mul_f32 v[134:135], v[134:135], v[70:71] op_sel_hi:[1,0]
    v_pk_mul_f32 v[116:117], v[116:117], v[68:69] op_sel_hi:[1,0]
    v_pk_mul_f32 v[136:137], v[136:137], v[70:71] op_sel_hi:[1,0]
    v_pk_mul_f32 v[118:119], v[118:119], v[68:69] op_sel_hi:[1,0]
    v_pk_mul_f32 v[138:139], v[138:139], v[70:71] op_sel_hi:[1,0]
    v_pk_mul_f32 v[120:121], v[120:121], v[68:69] op_sel_hi:[1,0]
    v_pk_mul_f32 v[140:141], v[140:141], v[70:71] op_sel_hi:[1,0]
    v_pk_mul_f32 v[122:123], v[122:123], v[68:69] op_sel_hi:[1,0]
    v_pk_mul_f32 v[142:143], v[142:143], v[70:71] op_sel_hi:[1,0]
    v_pk_mul_f32 v[124:125], v[124:125], v[68:69] op_sel_hi:[1,0]
    v_pk_mul_f32 v[144:145], v[144:145], v[70:71] op_sel_hi:[1,0]
    v_pk_mul_f32 v[126:127], v[126:127], v[68:69] op_sel_hi:[1,0]
    v_pk_mul_f32 v[146:147], v[146:147], v[70:71] op_sel_hi:[1,0]
    v_pk_mul_f32 v[128:129], v[128:129], v[68:69] op_sel_hi:[1,0]
    v_pk_mul_f32 v[148:149], v[148:149], v[70:71] op_sel_hi:[1,0]
    v_pk_mul_f32 v[130:131], v[130:131], v[68:69] op_sel_hi:[1,0]
    v_pk_mul_f32 v[150:151], v[150:151], v[70:71] op_sel_hi:[1,0]
    v_cvt_pk_bf16_f32 v168, v112, v113
    v_cvt_pk_bf16_f32 v169, v114, v115
    v_cvt_pk_bf16_f32 v170, v116, v117
    v_cvt_pk_bf16_f32 v171, v118, v119
    v_cvt_pk_bf16_f32 v172, v120, v121
    v_cvt_pk_bf16_f32 v173, v122, v123
    v_cvt_pk_bf16_f32 v174, v124, v125
    v_cvt_pk_bf16_f32 v175, v126, v127
    v_cvt_pk_bf16_f32 v176, v128, v129
    v_cvt_pk_bf16_f32 v177, v130, v131
    v_cvt_pk_bf16_f32 v178, v132, v133
    v_cvt_pk_bf16_f32 v179, v134, v135
    v_cvt_pk_bf16_f32 v180, v136, v137
    v_cvt_pk_bf16_f32 v181, v138, v139
    v_cvt_pk_bf16_f32 v182, v140, v141
    v_cvt_pk_bf16_f32 v183, v142, v143
    v_cvt_pk_bf16_f32 v184, v144, v145
    v_cvt_pk_bf16_f32 v185, v146, v147
    v_cvt_pk_bf16_f32 v186, v148, v149
    v_cvt_pk_bf16_f32 v187, v150, v151
    s_mov_b32 s80, 0
    s_waitcnt vmcnt(4)
    v_cmp_ne_u32 vcc, v35, v16
    s_nop 0
    s_cbranch_vccz L_ok_fbB
L_retry_fbB:
    s_sleep 1
    buffer_load_dword v35, v37, s[36:39], 0 offen offset:0 sc1
    s_waitcnt vmcnt(0)
    v_cmp_ne_u32 vcc, v35, v16
    s_add_u32 s80, s80, 1
    s_cmp_lt_u32 s80, 100000
    s_cselect_b64 s[82:83], vcc, 0
    s_cmp_lg_u64 s[82:83], 0
    s_cbranch_scc1 L_retry_fbB
    s_nop 4
L_ok_fbB:
    buffer_load_dwordx4 v[152:155], v18, s[36:39], 0 offen sc1
    buffer_load_dwordx4 v[156:159], v18, s[36:39], s66 offen sc1
    buffer_load_dwordx4 v[160:163], v18, s[36:39], s67 offen sc1
    buffer_load_dwordx4 v[164:167], v18, s[36:39], s68 offen sc1
    v_max3_f32 v24, v228, v229, v230
    v_min3_f32 v25, v228, v229, v230
    v_max3_f32 v24, v24, v231, v232
    v_min3_f32 v25, v25, v231, v232
    v_max3_f32 v24, v24, v233, v234
    v_min3_f32 v25, v25, v233, v234
    v_max3_f32 v24, v24, v235, v236
    v_min3_f32 v25, v25, v235, v236
    v_max3_f32 v24, v24, v237, v238
    v_min3_f32 v25, v25, v237, v238
    v_max3_f32 v24, v24, v239, v240
    v_min3_f32 v25, v25, v239, v240
    v_max3_f32 v24, v24, v241, v242
    v_min3_f32 v25, v25, v241, v242
    v_max3_f32 v24, v24, v243, v244
    v_min3_f32 v25, v25, v243, v244
    s_mov_b32 s69, 4096
    buffer_load_dwordx4 a[0:3], v31, s[36:39], s69 offen offset:0 sc1
    v_max3_f32 v24, v24, v245, v246
    v_min3_f32 v25, v25, v245, v246
    v_max_f32 v24, v24, v247
    v_min_f32_e64 v25, v25, v247
    v_mul_f32_e64 v24, -v50, v24
    v_mul_f32_e64 v25, v50, v25
    v_pk_fma_f32 v[112:113], v[228:229], v[50:51], v[24:25] op_sel_hi:[1,1,0]
    v_pk_fma_f32 v[132:133], v[228:229], v[50:51], v[24:25] op_sel:[0,0,1] op_sel_hi:[1,1,1] neg_lo:[0,1,0] neg_hi:[0,1,0]
    v_pk_fma_f32 v[114:115], v[230:231], v[50:51], v[24:25] op_sel_hi:[1,1,0]
    v_pk_fma_f32 v[134:135], v[230:231], v[50:51], v[24:25] op_sel:[0,0,1] op_sel_hi:[1,1,1] neg_lo:[0,1,0] neg_hi:[0,1,0]
    v_pk_fma_f32 v[116:117], v[232:233], v[50:51], v[24:25] op_sel_hi:[1,1,0]
    v_pk_fma_f32 v[136:137], v[232:233], v[50:51], v[24:25] op_sel:[0,0,1] op_sel_hi:[1,1,1] neg_lo:[0,1,0] neg_hi:[0,1,0]
    v_pk_fma_f32 v[118:119], v[234:235], v[50:51], v[24:25] op_sel_hi:[1,1,0]
    v_pk_fma_f32 v[138:139], v[234:235], v[50:51], v[24:25] op_sel:[0,0,1] op_sel_hi:[1,1,1] neg_lo:[0,1,0] neg_hi:[0,1,0]
    v_pk_fma_f32 v[120:121], v[236:237], v[50:51], v[24:25] op_sel_hi:[1,1,0]
    v_pk_fma_f32 v[140:141], v[236:237], v[50:51], v[24:25] op_sel:[0,0,1] op_sel_hi:[1,1,1] neg_lo:[0,1,0] neg_hi:[0,1,0]
    buffer_load_dwordx4 a[4:7], v31, s[36:39], s69 offen offset:1024 sc1
    v_pk_fma_f32 v[122:123], v[238:239], v[50:51], v[24:25] op_sel_hi:[1,1,0]
    v_pk_fma_f32 v[142:143], v[238:239], v[50:51], v[24:25] op_sel:[0,0,1] op_sel_hi:[1,1,1] neg_lo:[0,1,0] neg_hi:[0,1,0]
    v_pk_fma_f32 v[124:125], v[240:241], v[50:51], v[24:25] op_sel_hi:[1,1,0]
    v_pk_fma_f32 v[144:145], v[240:241], v[50:51], v[24:25] op_sel:[0,0,1] op_sel_hi:[1,1,1] neg_lo:[0,1,0] neg_hi:[0,1,0]
    v_pk_fma_f32 v[126:127], v[242:243], v[50:51], v[24:25] op_sel_hi:[1,1,0]
    v_pk_fma_f32 v[146:147], v[242:243], v[50:51], v[24:25] op_sel:[0,0,1] op_sel_hi:[1,1,1] neg_lo:[0,1,0] neg_hi:[0,1,0]
    v_pk_fma_f32 v[128:129], v[244:245], v[50:51], v[24:25] op_sel_hi:[1,1,0]
    v_pk_fma_f32 v[148:149], v[244:245], v[50:51], v[24:25] op_sel:[0,0,1] op_sel_hi:[1,1,1] neg_lo:[0,1,0] neg_hi:[0,1,0]
    v_pk_fma_f32 v[130:131], v[246:247], v[50:51], v[24:25] op_sel_hi:[1,1,0]
    v_pk_fma_f32 v[150:151], v[246:247], v[50:51], v[24:25] op_sel:[0,0,1] op_sel_hi:[1,1,1] neg_lo:[0,1,0] neg_hi:[0,1,0]
    v_exp_f32 v112, v112
    v_exp_f32 v113, v113
    v_exp_f32 v114, v114
    v_exp_f32 v115, v115
    buffer_load_dwordx4 a[8:11], v31, s[36:39], s69 offen offset:2048 sc1
    v_exp_f32 v116, v116
    v_exp_f32 v117, v117
    v_exp_f32 v118, v118
    v_exp_f32 v119, v119
    v_exp_f32 v120, v120
    v_exp_f32 v121, v121
    v_exp_f32 v122, v122
    v_exp_f32 v123, v123
    v_exp_f32 v124, v124
    v_exp_f32 v125, v125
    buffer_load_dwordx4 a[12:15], v31, s[36:39], s69 offen offset:3072 sc1
    v_exp_f32 v126, v126
    v_exp_f32 v127, v127
    v_exp_f32 v128, v128
    v_exp_f32 v129, v129
    v_exp_f32 v130, v130
    v_exp_f32 v131, v131
    v_exp_f32 v132, v132
    v_exp_f32 v133, v133
    v_exp_f32 v134, v134
    v_exp_f32 v135, v135
    s_mov_b32 s69, 8192
    buffer_load_dwordx4 a[16:19], v31, s[36:39], s69 offen offset:0 sc1
    v_exp_f32 v136, v136
    v_exp_f32 v137, v137
    v_exp_f32 v138, v138
    v_exp_f32 v139, v139
    v_exp_f32 v140, v140
    v_exp_f32 v141, v141
    v_exp_f32 v142, v142
    v_exp_f32 v143, v143
    v_exp_f32 v144, v144
    v_exp_f32 v145, v145
    buffer_load_dwordx4 a[20:23], v31, s[36:39], s69 offen offset:1024 sc1
    v_exp_f32 v146, v146
    v_exp_f32 v147, v147
    v_exp_f32 v148, v148
    v_exp_f32 v149, v149
    v_exp_f32 v150, v150
    v_exp_f32 v151, v151
    v_pk_add_f32 v[68:69], v[112:113], v[114:115]
    v_pk_add_f32 v[70:71], v[132:133], v[134:135]
    v_pk_add_f32 v[68:69], v[68:69], v[116:117]
    v_pk_add_f32 v[70:71], v[70:71], v[136:137]
    v_pk_add_f32 v[68:69], v[68:69], v[118:119]
    v_pk_add_f32 v[70:71], v[70:71], v[138:139]
    buffer_load_dwordx4 a[24:27], v31, s[36:39], s69 offen offset:2048 sc1
    v_pk_add_f32 v[68:69], v[68:69], v[120:121]
    v_pk_add_f32 v[70:71], v[70:71], v[140:141]
    v_pk_add_f32 v[68:69], v[68:69], v[122:123]
    v_pk_add_f32 v[70:71], v[70:71], v[142:143]
    v_pk_add_f32 v[68:69], v[68:69], v[124:125]
    v_pk_add_f32 v[70:71], v[70:71], v[144:145]
    v_pk_add_f32 v[68:69], v[68:69], v[126:127]
    v_pk_add_f32 v[70:71], v[70:71], v[146:147]
    v_pk_add_f32 v[68:69], v[68:69], v[128:129]
    v_pk_add_f32 v[70:71], v[70:71], v[148:149]
    v_pk_add_f32 v[68:69], v[68:69], v[130:131]
    v_pk_add_f32 v[70:71], v[70:71], v[150:151]
    v_add_f32 v68, v68, v69
    v_add_f32 v70, v70, v71
    v_rcp_f32 v68, v68
    v_rcp_f32 v70, v70
    buffer_load_dwordx4 a[28:31], v31, s[36:39], s69 offen offset:3072 sc1
    v_pk_mul_f32 v[112:113], v[112:113], v[68:69] op_sel_hi:[1,0]
    v_pk_mul_f32 v[132:133], v[132:133], v[70:71] op_sel_hi:[1,0]
    v_pk_mul_f32 v[114:115], v[114:115], v[68:69] op_sel_hi:[1,0]
    v_pk_mul_f32 v[134:135], v[134:135], v[70:71] op_sel_hi:[1,0]
    v_pk_mul_f32 v[116:117], v[116:117], v[68:69] op_sel_hi:[1,0]
    v_pk_mul_f32 v[136:137], v[136:137], v[70:71] op_sel_hi:[1,0]
    v_pk_mul_f32 v[118:119], v[118:119], v[68:69] op_sel_hi:[1,0]
    v_pk_mul_f32 v[138:139], v[138:139], v[70:71] op_sel_hi:[1,0]
    v_pk_mul_f32 v[120:121], v[120:121], v[68:69] op_sel_hi:[1,0]
    v_pk_mul_f32 v[140:141], v[140:141], v[70:71] op_sel_hi:[1,0]
    v_pk_mul_f32 v[122:123], v[122:123], v[68:69] op_sel_hi:[1,0]
    v_pk_mul_f32 v[142:143], v[142:143], v[70:71] op_sel_hi:[1,0]
    v_pk_mul_f32 v[124:125], v[124:125], v[68:69] op_sel_hi:[1,0]
    v_pk_mul_f32 v[144:145], v[144:145], v[70:71] op_sel_hi:[1,0]
    v_pk_mul_f32 v[126:127], v[126:127], v[68:69] op_sel_hi:[1,0]
    v_pk_mul_f32 v[146:147], v[146:147], v[70:71] op_sel_hi:[1,0]
    s_mov_b32 s69, 16384
    buffer_load_dwordx4 a[32:35], v31, s[36:39], s69 offen offset:0 sc1
    v_pk_mul_f32 v[128:129], v[128:129], v[68:69] op_sel_hi:[1,0]
    v_pk_mul_f32 v[148:149], v[148:149], v[70:71] op_sel_hi:[1,0]
    v_pk_mul_f32 v[130:131], v[130:131], v[68:69] op_sel_hi:[1,0]
    v_pk_mul_f32 v[150:151], v[150:151], v[70:71] op_sel_hi:[1,0]
    v_cvt_pk_bf16_f32 v188, v112, v113
    v_cvt_pk_bf16_f32 v189, v114, v115
    v_cvt_pk_bf16_f32 v190, v116, v117
    v_cvt_pk_bf16_f32 v191, v118, v119
    v_cvt_pk_bf16_f32 v192, v120, v121
    v_cvt_pk_bf16_f32 v193, v122, v123
    v_cvt_pk_bf16_f32 v194, v124, v125
    v_cvt_pk_bf16_f32 v195, v126, v127
    v_cvt_pk_bf16_f32 v196, v128, v129
    v_cvt_pk_bf16_f32 v197, v130, v131
    v_cvt_pk_bf16_f32 v198, v132, v133
    v_cvt_pk_bf16_f32 v199, v134, v135
    buffer_load_dwordx4 a[36:39], v31, s[36:39], s69 offen offset:1024 sc1
    v_cvt_pk_bf16_f32 v200, v136, v137
    v_cvt_pk_bf16_f32 v201, v138, v139
    v_cvt_pk_bf16_f32 v202, v140, v141
    v_cvt_pk_bf16_f32 v203, v142, v143
    v_cvt_pk_bf16_f32 v204, v144, v145
    v_cvt_pk_bf16_f32 v205, v146, v147
    v_cvt_pk_bf16_f32 v206, v148, v149
    v_cvt_pk_bf16_f32 v207, v150, v151
    s_mov_b32 s80, 0
    s_waitcnt vmcnt(13)
    v_xor_b32_e64 v17, v152, v44
    v_bitop3_b32 v17, v17, v153, v45 bitop3:0xf6
    v_bitop3_b32 v17, v17, v154, v46 bitop3:0xf6
    v_bitop3_b32 v17, v17, v155, v47 bitop3:0xf6
    s_waitcnt vmcnt(12)
    v_bitop3_b32 v17, v17, v156, v44 bitop3:0xf6
    v_bitop3_b32 v17, v17, v157, v45 bitop3:0xf6
    v_bitop3_b32 v17, v17, v158, v46 bitop3:0xf6
    v_bitop3_b32 v17, v17, v159, v47 bitop3:0xf6
    s_waitcnt vmcnt(11)
    v_bitop3_b32 v17, v17, v160, v44 bitop3:0xf6
    v_bitop3_b32 v17, v17, v161, v45 bitop3:0xf6
    v_bitop3_b32 v17, v17, v162, v46 bitop3:0xf6
    v_bitop3_b32 v17, v17, v163, v47 bitop3:0xf6
    s_waitcnt vmcnt(10)
    v_bitop3_b32 v17, v17, v164, v44 bitop3:0xf6
    v_bitop3_b32 v17, v17, v165, v45 bitop3:0xf6
    v_bitop3_b32 v17, v17, v166, v46 bitop3:0xf6
    v_bitop3_b32 v17, v17, v167, v47 bitop3:0xf6
    v_and_b32 v17, 0xff, v17
    v_cndmask_b32 v17, 0, v17, s[96:97]
    v_cmp_ne_u32 vcc, 0, v17
    s_nop 0
    s_cbranch_vccz L_ok_h1
L_retry_h1:
    s_sleep 1
    buffer_load_dwordx4 v[152:155], v18, s[36:39], 0 offen sc1
    buffer_load_dwordx4 v[156:159], v18, s[36:39], s66 offen sc1
    buffer_load_dwordx4 v[160:163], v18, s[36:39], s67 offen sc1
    buffer_load_dwordx4 v[164:167], v18, s[36:39], s68 offen sc1
    s_waitcnt vmcnt(0)
    v_xor_b32_e64 v17, v152, v44
    v_bitop3_b32 v17, v17, v153, v45 bitop3:0xf6
    v_bitop3_b32 v17, v17, v154, v46 bitop3:0xf6
    v_bitop3_b32 v17, v17, v155, v47 bitop3:0xf6
    v_bitop3_b32 v17, v17, v156, v44 bitop3:0xf6
    v_bitop3_b32 v17, v17, v157, v45 bitop3:0xf6
    v_bitop3_b32 v17, v17, v158, v46 bitop3:0xf6
    v_bitop3_b32 v17, v17, v159, v47 bitop3:0xf6
    v_bitop3_b32 v17, v17, v160, v44 bitop3:0xf6
    v_bitop3_b32 v17, v17, v161, v45 bitop3:0xf6
    v_bitop3_b32 v17, v17, v162, v46 bitop3:0xf6
    v_bitop3_b32 v17, v17, v163, v47 bitop3:0xf6
    v_bitop3_b32 v17, v17, v164, v44 bitop3:0xf6
    v_bitop3_b32 v17, v17, v165, v45 bitop3:0xf6
    v_bitop3_b32 v17, v17, v166, v46 bitop3:0xf6
    v_bitop3_b32 v17, v17, v167, v47 bitop3:0xf6
    v_and_b32 v17, 0xff, v17
    v_cndmask_b32 v17, 0, v17, s[96:97]
    v_cmp_ne_u32 vcc, 0, v17
    s_add_u32 s80, s80, 1
    s_cmp_lt_u32 s80, 100000
    s_cselect_b64 s[82:83], vcc, 0
    s_cmp_lg_u64 s[82:83], 0
    s_cbranch_scc1 L_retry_h1
    s_nop 4
L_ok_h1:
    v_and_b32 v152, s88, v152
    v_and_b32 v153, s88, v153
    v_and_b32 v154, s88, v154
    v_and_b32 v155, s88, v155
    v_and_b32 v156, s88, v156
    v_and_b32 v157, s88, v157
    v_and_b32 v158, s88, v158
    v_and_b32 v159, s88, v159
    v_and_b32 v160, s88, v160
    v_and_b32 v161, s88, v161
    v_and_b32 v162, s88, v162
    v_and_b32 v163, s88, v163
    v_and_b32 v164, s88, v164
    v_and_b32 v165, s88, v165
    v_and_b32 v166, s88, v166
    v_and_b32 v167, s88, v167
    v_pk_add_f32 v[152:153], v[152:153], v[156:157]
    v_pk_add_f32 v[154:155], v[154:155], v[158:159]
    v_pk_add_f32 v[160:161], v[160:161], v[164:165]
    v_pk_add_f32 v[162:163], v[162:163], v[166:167]
    v_pk_add_f32 v[152:153], v[152:153], v[160:161]
    v_pk_add_f32 v[154:155], v[154:155], v[162:163]
    v_mov_b32 v156, v152
    v_mov_b32 v157, v153
    v_mov_b32 v158, v154
    v_mov_b32 v159, v155
    v_permlane16_swap_b32 v156, v152
    v_permlane16_swap_b32 v157, v153
    v_permlane16_swap_b32 v158, v154
    v_permlane16_swap_b32 v159, v155
    v_add_f32 v152, v156, v152
    v_add_f32 v153, v157, v153
    v_add_f32 v154, v158, v154
    v_add_f32 v155, v159, v155
    v_mov_b32 v156, v152
    v_mov_b32 v157, v153
    v_mov_b32 v158, v154
    v_mov_b32 v159, v155
    v_permlane32_swap_b32 v156, v152
    v_permlane32_swap_b32 v157, v153
    v_permlane32_swap_b32 v158, v154
    v_permlane32_swap_b32 v159, v155
    v_add_f32 v152, v156, v152
    v_add_f32 v153, v157, v153
    v_add_f32 v154, v158, v154
    v_add_f32 v155, v159, v155
    v_perm_b32 v152, v152, v16, s76
    v_perm_b32 v153, v153, v16, s77
    v_perm_b32 v154, v154, v16, s78
    v_perm_b32 v155, v155, v16, s79
    buffer_store_dwordx4 v[152:155], v19, s[36:39], 0 offen sc1
    s_barrier
    v_add_u32 v33, 61440, v33
    ds_read_b128 v[108:111], v33 offset:0
    ds_read_b128 v[112:115], v33 offset:1024
    ds_read_b128 v[116:119], v33 offset:2048
    ds_read_b128 v[120:123], v33 offset:3072
    ds_read_b128 v[124:127], v33 offset:4096
    ds_read_b128 v[128:131], v33 offset:5120
    ds_read_b128 v[132:135], v33 offset:6144
    ds_read_b128 v[136:139], v33 offset:7168
    ds_read_b128 v[140:143], v33 offset:8192
    ds_read_b128 v[144:147], v33 offset:9216
    s_waitcnt lgkmcnt(5)
    s_waitcnt vmcnt(10)
    v_mfma_f32_16x16x32_bf16 v[88:91], v[108:111], a[0:3], 0
    ds_read_b128 v[148:151], v33 offset:10240
    buffer_load_dwordx4 a[40:43], v31, s[36:39], s69 offen offset:2048 sc1
    s_movk_i32 s66, 72
    v_cmp_gt_u32 s[96:97], s66, v0
    s_movk_i32 s66, 4096
    v_mfma_f32_16x16x32_bf16 v[92:95], v[112:115], a[0:3], 0
    ds_read_b128 v[152:155], v33 offset:11264
    s_movk_i32 s67, 8192
    s_movk_i32 s68, 12288
    v_mfma_f32_16x16x32_bf16 v[96:99], v[116:119], a[0:3], 0
    ds_read_b128 v[156:159], v33 offset:12288
    buffer_load_dwordx4 a[44:47], v31, s[36:39], s69 offen offset:3072 sc1
    v_mfma_f32_16x16x32_bf16 v[100:103], v[120:123], a[0:3], 0
    ds_read_b128 v[160:163], v33 offset:13312
    v_mfma_f32_16x16x32_bf16 v[104:107], v[124:127], a[0:3], 0
    ds_read_b128 v[164:167], v33 offset:14336
    s_waitcnt lgkmcnt(5)
    s_waitcnt vmcnt(11)
    v_mfma_f32_16x16x32_bf16 v[88:91], v[128:131], a[4:7], v[88:91]
    ds_read_b128 v[108:111], v33 offset:15360
    s_mov_b32 s69, 20480
    buffer_load_dwordx4 a[48:51], v31, s[36:39], s69 offen offset:0 sc1
    v_mfma_f32_16x16x32_bf16 v[92:95], v[132:135], a[4:7], v[92:95]
    ds_read_b128 v[112:115], v33 offset:16384
    v_mfma_f32_16x16x32_bf16 v[96:99], v[136:139], a[4:7], v[96:99]
    ds_read_b128 v[116:119], v33 offset:17408
    v_mfma_f32_16x16x32_bf16 v[100:103], v[140:143], a[4:7], v[100:103]
    ds_read_b128 v[120:123], v33 offset:18432
    buffer_load_dwordx4 a[52:55], v31, s[36:39], s69 offen offset:1024 sc1
    v_mfma_f32_16x16x32_bf16 v[104:107], v[144:147], a[4:7], v[104:107]
    ds_read_b128 v[124:127], v33 offset:19456
    s_barrier
    s_waitcnt lgkmcnt(5)
    s_waitcnt vmcnt(12)
    v_mfma_f32_16x16x32_bf16 v[88:91], v[148:151], a[8:11], v[88:91]
    ds_read_b128 v[128:131], v33 offset:20480
    v_mfma_f32_16x16x32_bf16 v[92:95], v[152:155], a[8:11], v[92:95]
    ds_read_b128 v[132:135], v33 offset:21504
    buffer_load_dwordx4 a[56:59], v31, s[36:39], s69 offen offset:2048 sc1
    v_mfma_f32_16x16x32_bf16 v[96:99], v[156:159], a[8:11], v[96:99]
    ds_read_b128 v[136:139], v33 offset:22528
    v_mfma_f32_16x16x32_bf16 v[100:103], v[160:163], a[8:11], v[100:103]
    ds_read_b128 v[140:143], v33 offset:23552
    v_mfma_f32_16x16x32_bf16 v[104:107], v[164:167], a[8:11], v[104:107]
    ds_read_b128 v[144:147], v33 offset:24576
    buffer_load_dwordx4 a[60:63], v31, s[36:39], s69 offen offset:3072 sc1
    s_waitcnt lgkmcnt(5)
    s_waitcnt vmcnt(13)
    v_mfma_f32_16x16x32_bf16 v[88:91], v[108:111], a[12:15], v[88:91]
    ds_read_b128 v[148:151], v33 offset:25600
    v_mfma_f32_16x16x32_bf16 v[92:95], v[112:115], a[12:15], v[92:95]
    ds_read_b128 v[152:155], v33 offset:26624
    v_mfma_f32_16x16x32_bf16 v[96:99], v[116:119], a[12:15], v[96:99]
    ds_read_b128 v[156:159], v33 offset:27648
    s_mov_b32 s69, 28672
    buffer_load_dwordx4 a[64:67], v31, s[36:39], s69 offen offset:0 sc1
    v_mfma_f32_16x16x32_bf16 v[100:103], v[120:123], a[12:15], v[100:103]
    ds_read_b128 v[160:163], v33 offset:28672
    v_mfma_f32_16x16x32_bf16 v[104:107], v[124:127], a[12:15], v[104:107]
    ds_read_b128 v[164:167], v33 offset:29696
    s_waitcnt lgkmcnt(5)
    s_waitcnt vmcnt(13)
    v_mfma_f32_16x16x32_bf16 v[88:91], v[128:131], a[16:19], v[88:91]
    ds_read_b128 v[108:111], v33 offset:30720
    buffer_load_dwordx4 a[68:71], v31, s[36:39], s69 offen offset:1024 sc1
    v_mfma_f32_16x16x32_bf16 v[92:95], v[132:135], a[16:19], v[92:95]
    ds_read_b128 v[112:115], v33 offset:31744
    v_mfma_f32_16x16x32_bf16 v[96:99], v[136:139], a[16:19], v[96:99]
    ds_read_b128 v[116:119], v33 offset:32768
    v_mfma_f32_16x16x32_bf16 v[100:103], v[140:143], a[16:19], v[100:103]
    ds_read_b128 v[120:123], v33 offset:33792
    buffer_load_dwordx4 a[72:75], v31, s[36:39], s69 offen offset:2048 sc1
    v_mfma_f32_16x16x32_bf16 v[104:107], v[144:147], a[16:19], v[104:107]
    ds_read_b128 v[124:127], v33 offset:34816
    s_waitcnt lgkmcnt(5)
    s_waitcnt vmcnt(14)
    v_mfma_f32_16x16x32_bf16 v[88:91], v[148:151], a[20:23], v[88:91]
    ds_read_b128 v[128:131], v33 offset:35840
    v_mfma_f32_16x16x32_bf16 v[92:95], v[152:155], a[20:23], v[92:95]
    ds_read_b128 v[132:135], v33 offset:36864
    buffer_load_dwordx4 a[76:79], v31, s[36:39], s69 offen offset:3072 sc1
    v_mfma_f32_16x16x32_bf16 v[96:99], v[156:159], a[20:23], v[96:99]
    ds_read_b128 v[136:139], v33 offset:37888
    v_mfma_f32_16x16x32_bf16 v[100:103], v[160:163], a[20:23], v[100:103]
    ds_read_b128 v[140:143], v33 offset:38912
    v_mfma_f32_16x16x32_bf16 v[104:107], v[164:167], a[20:23], v[104:107]
    ds_read_b128 v[144:147], v33 offset:39936
    s_mov_b32 s69, 32768
    buffer_load_dwordx4 a[80:83], v31, s[36:39], s69 offen offset:0 sc1
    s_barrier
    s_waitcnt lgkmcnt(5)
    s_waitcnt vmcnt(15)
    v_mfma_f32_16x16x32_bf16 v[88:91], v[108:111], a[24:27], v[88:91]
    ds_read_b128 v[148:151], v33 offset:40960
    buffer_load_dwordx4 v[72:75], v58, s[36:39], 0 offen sc1
    buffer_load_dwordx4 v[76:79], v58, s[36:39], s66 offen sc1
    buffer_load_dwordx4 v[80:83], v58, s[36:39], s67 offen sc1
    buffer_load_dwordx4 v[84:87], v59, s[36:39], s68 offen sc1
    v_mfma_f32_16x16x32_bf16 v[92:95], v[112:115], a[24:27], v[92:95]
    ds_read_b128 v[152:155], v33 offset:41984
    v_mfma_f32_16x16x32_bf16 v[96:99], v[116:119], a[24:27], v[96:99]
    ds_read_b128 v[156:159], v33 offset:43008
    buffer_load_dwordx4 a[84:87], v31, s[36:39], s69 offen offset:1024 sc1
    v_mfma_f32_16x16x32_bf16 v[100:103], v[120:123], a[24:27], v[100:103]
    ds_read_b128 v[160:163], v33 offset:44032
    v_mfma_f32_16x16x32_bf16 v[104:107], v[124:127], a[24:27], v[104:107]
    ds_read_b128 v[164:167], v33 offset:45056
    s_waitcnt lgkmcnt(5)
    s_waitcnt vmcnt(19)
    v_mfma_f32_16x16x32_bf16 v[88:91], v[128:131], a[28:31], v[88:91]
    ds_read_b128 v[108:111], v33 offset:46080
    buffer_load_dwordx4 a[88:91], v31, s[36:39], s69 offen offset:2048 sc1
    v_mfma_f32_16x16x32_bf16 v[92:95], v[132:135], a[28:31], v[92:95]
    ds_read_b128 v[112:115], v33 offset:47104
    v_mfma_f32_16x16x32_bf16 v[96:99], v[136:139], a[28:31], v[96:99]
    ds_read_b128 v[116:119], v33 offset:48128
    v_mfma_f32_16x16x32_bf16 v[100:103], v[140:143], a[28:31], v[100:103]
    ds_read_b128 v[120:123], v33 offset:49152
    buffer_load_dwordx4 a[92:95], v31, s[36:39], s69 offen offset:3072 sc1
    v_mfma_f32_16x16x32_bf16 v[104:107], v[144:147], a[28:31], v[104:107]
    ds_read_b128 v[124:127], v33 offset:50176
    s_waitcnt lgkmcnt(5)
    s_waitcnt vmcnt(20)
    v_mfma_f32_16x16x32_bf16 v[88:91], v[148:151], a[32:35], v[88:91]
    ds_read_b128 v[128:131], v33 offset:51200
    v_mfma_f32_16x16x32_bf16 v[92:95], v[152:155], a[32:35], v[92:95]
    ds_read_b128 v[132:135], v33 offset:52224
    s_mov_b32 s69, 40960
    buffer_load_dwordx4 a[96:99], v31, s[36:39], s69 offen offset:0 sc1
    v_mfma_f32_16x16x32_bf16 v[96:99], v[156:159], a[32:35], v[96:99]
    ds_read_b128 v[136:139], v33 offset:53248
    v_mfma_f32_16x16x32_bf16 v[100:103], v[160:163], a[32:35], v[100:103]
    ds_read_b128 v[140:143], v33 offset:54272
    v_mfma_f32_16x16x32_bf16 v[104:107], v[164:167], a[32:35], v[104:107]
    ds_read_b128 v[144:147], v33 offset:55296
    buffer_load_dwordx4 a[100:103], v31, s[36:39], s69 offen offset:1024 sc1
    s_waitcnt lgkmcnt(5)
    s_waitcnt vmcnt(21)
    v_mfma_f32_16x16x32_bf16 v[88:91], v[108:111], a[36:39], v[88:91]
    ds_read_b128 v[148:151], v33 offset:56320
    v_mfma_f32_16x16x32_bf16 v[92:95], v[112:115], a[36:39], v[92:95]
    ds_read_b128 v[152:155], v33 offset:57344
    v_mfma_f32_16x16x32_bf16 v[96:99], v[116:119], a[36:39], v[96:99]
    ds_read_b128 v[156:159], v33 offset:58368
    buffer_load_dwordx4 a[104:107], v31, s[36:39], s69 offen offset:2048 sc1
    v_mfma_f32_16x16x32_bf16 v[100:103], v[120:123], a[36:39], v[100:103]
    ds_read_b128 v[160:163], v33 offset:59392
    v_mfma_f32_16x16x32_bf16 v[104:107], v[124:127], a[36:39], v[104:107]
    ds_read_b128 v[164:167], v33 offset:60416
    s_barrier
    s_waitcnt lgkmcnt(5)
    s_waitcnt vmcnt(20)
    v_mfma_f32_16x16x32_bf16 v[88:91], v[128:131], a[40:43], v[88:91]
    v_subrev_u32 v33, 61440, v33
    ds_read_b128 v[108:111], v33 offset:0
    buffer_load_dwordx4 a[108:111], v31, s[36:39], s69 offen offset:3072 sc1
    v_mfma_f32_16x16x32_bf16 v[92:95], v[132:135], a[40:43], v[92:95]
    ds_read_b128 v[112:115], v33 offset:1024
    v_mfma_f32_16x16x32_bf16 v[96:99], v[136:139], a[40:43], v[96:99]
    ds_read_b128 v[116:119], v33 offset:2048
    v_mfma_f32_16x16x32_bf16 v[100:103], v[140:143], a[40:43], v[100:103]
    ds_read_b128 v[120:123], v33 offset:3072
    s_mov_b32 s70, 143360
    s_add_u32 m0, s74, 61440
    s_nop 0
    buffer_load_dwordx4 v30, s[36:39], s70 offen offset:0 sc1 lds
    v_mfma_f32_16x16x32_bf16 v[104:107], v[144:147], a[40:43], v[104:107]
    ds_read_b128 v[124:127], v33 offset:4096
    s_waitcnt lgkmcnt(5)
    s_waitcnt vmcnt(21)
    v_mfma_f32_16x16x32_bf16 v[88:91], v[148:151], a[44:47], v[88:91]
    ds_read_b128 v[128:131], v33 offset:5120
    v_mfma_f32_16x16x32_bf16 v[92:95], v[152:155], a[44:47], v[92:95]
    ds_read_b128 v[132:135], v33 offset:6144
    buffer_load_dwordx4 v30, s[36:39], s70 offen offset:1024 sc1 lds
    v_mfma_f32_16x16x32_bf16 v[96:99], v[156:159], a[44:47], v[96:99]
    ds_read_b128 v[136:139], v33 offset:7168
    v_mfma_f32_16x16x32_bf16 v[100:103], v[160:163], a[44:47], v[100:103]
    ds_read_b128 v[140:143], v33 offset:8192
    v_mfma_f32_16x16x32_bf16 v[104:107], v[164:167], a[44:47], v[104:107]
    ds_read_b128 v[144:147], v33 offset:9216
    buffer_load_dwordx4 v30, s[36:39], s70 offen offset:2048 sc1 lds
    s_waitcnt lgkmcnt(5)
    s_waitcnt vmcnt(22)
    v_mfma_f32_16x16x32_bf16 v[88:91], v[108:111], a[48:51], v[88:91]
    ds_read_b128 v[148:151], v33 offset:10240
    v_mfma_f32_16x16x32_bf16 v[92:95], v[112:115], a[48:51], v[92:95]
    ds_read_b128 v[152:155], v33 offset:11264
    v_mfma_f32_16x16x32_bf16 v[96:99], v[116:119], a[48:51], v[96:99]
    ds_read_b128 v[156:159], v33 offset:12288
    buffer_load_dwordx4 v30, s[36:39], s70 offen offset:3072 sc1 lds
    v_mfma_f32_16x16x32_bf16 v[100:103], v[120:123], a[48:51], v[100:103]
    ds_read_b128 v[160:163], v33 offset:13312
    v_mfma_f32_16x16x32_bf16 v[104:107], v[124:127], a[48:51], v[104:107]
    ds_read_b128 v[164:167], v33 offset:14336
    s_waitcnt lgkmcnt(5)
    s_waitcnt vmcnt(22)
    v_mfma_f32_16x16x32_bf16 v[88:91], v[128:131], a[52:55], v[88:91]
    ds_read_b128 v[108:111], v33 offset:15360
    s_mov_b32 s70, 147456
    s_add_u32 m0, s74, 65536
    s_nop 0
    buffer_load_dwordx4 v30, s[36:39], s70 offen sc1 lds
    v_mfma_f32_16x16x32_bf16 v[92:95], v[132:135], a[52:55], v[92:95]
    ds_read_b128 v[112:115], v33 offset:16384
    v_mfma_f32_16x16x32_bf16 v[96:99], v[136:139], a[52:55], v[96:99]
    ds_read_b128 v[116:119], v33 offset:17408
    v_mfma_f32_16x16x32_bf16 v[100:103], v[140:143], a[52:55], v[100:103]
    ds_read_b128 v[120:123], v33 offset:18432
    s_mov_b32 s69, 45056
    buffer_load_dwordx4 a[112:115], v31, s[36:39], s69 offen offset:0 sc1
    v_mfma_f32_16x16x32_bf16 v[104:107], v[144:147], a[52:55], v[104:107]
    ds_read_b128 v[124:127], v33 offset:19456
    s_barrier
    s_waitcnt lgkmcnt(5)
    s_waitcnt vmcnt(23)
    v_mfma_f32_16x16x32_bf16 v[88:91], v[148:151], a[56:59], v[88:91]
    ds_read_b128 v[128:131], v33 offset:20480
    v_mfma_f32_16x16x32_bf16 v[92:95], v[152:155], a[56:59], v[92:95]
    ds_read_b128 v[132:135], v33 offset:21504
    buffer_load_dwordx4 a[116:119], v31, s[36:39], s69 offen offset:1024 sc1
    v_mfma_f32_16x16x32_bf16 v[96:99], v[156:159], a[56:59], v[96:99]
    ds_read_b128 v[136:139], v33 offset:22528
    v_mfma_f32_16x16x32_bf16 v[100:103], v[160:163], a[56:59], v[100:103]
    ds_read_b128 v[140:143], v33 offset:23552
    v_mfma_f32_16x16x32_bf16 v[104:107], v[164:167], a[56:59], v[104:107]
    ds_read_b128 v[144:147], v33 offset:24576
    buffer_load_dwordx4 a[120:123], v31, s[36:39], s69 offen offset:2048 sc1
    s_waitcnt lgkmcnt(5)
    s_waitcnt vmcnt(24)
    v_mfma_f32_16x16x32_bf16 v[88:91], v[108:111], a[60:63], v[88:91]
    ds_read_b128 v[148:151], v33 offset:25600
    v_mfma_f32_16x16x32_bf16 v[92:95], v[112:115], a[60:63], v[92:95]
    ds_read_b128 v[152:155], v33 offset:26624
    v_mfma_f32_16x16x32_bf16 v[96:99], v[116:119], a[60:63], v[96:99]
    ds_read_b128 v[156:159], v33 offset:27648
    buffer_load_dwordx4 a[124:127], v31, s[36:39], s69 offen offset:3072 sc1
    v_mfma_f32_16x16x32_bf16 v[100:103], v[120:123], a[60:63], v[100:103]
    ds_read_b128 v[160:163], v33 offset:28672
    v_mfma_f32_16x16x32_bf16 v[104:107], v[124:127], a[60:63], v[104:107]
    ds_read_b128 v[164:167], v33 offset:29696
    s_mov_b32 s80, 0
    s_waitcnt vmcnt(16)
    v_xor_b32 v12, v84, v44
    v_bitop3_b32 v12, v12, v85, v45 bitop3:0xf6
    v_bitop3_b32 v12, v12, v86, v46 bitop3:0xf6
    v_bitop3_b32 v12, v12, v87, v47 bitop3:0xf6
    v_cndmask_b32 v12, 0, v12, s[96:97]
    v_bitop3_b32 v12, v12, v72, v44 bitop3:0xf6
    v_bitop3_b32 v12, v12, v73, v45 bitop3:0xf6
    v_bitop3_b32 v12, v12, v74, v46 bitop3:0xf6
    v_bitop3_b32 v12, v12, v75, v47 bitop3:0xf6
    v_bitop3_b32 v12, v12, v76, v44 bitop3:0xf6
    v_bitop3_b32 v12, v12, v77, v45 bitop3:0xf6
    v_bitop3_b32 v12, v12, v78, v46 bitop3:0xf6
    v_bitop3_b32 v12, v12, v79, v47 bitop3:0xf6
    v_bitop3_b32 v12, v12, v80, v44 bitop3:0xf6
    v_bitop3_b32 v12, v12, v81, v45 bitop3:0xf6
    v_bitop3_b32 v12, v12, v82, v46 bitop3:0xf6
    v_bitop3_b32 v12, v12, v83, v47 bitop3:0xf6
    v_and_b32 v12, 0xff, v12
    v_cmp_ne_u32 vcc, 0, v12
    s_nop 0
    s_cbranch_vccz L_ok_h2
L_retry_h2:
    s_sleep 1
    buffer_load_dwordx4 v[72:75], v58, s[36:39], 0 offen sc1
    buffer_load_dwordx4 v[76:79], v58, s[36:39], s66 offen sc1
    buffer_load_dwordx4 v[80:83], v58, s[36:39], s67 offen sc1
    buffer_load_dwordx4 v[84:87], v59, s[36:39], s68 offen sc1
    s_waitcnt vmcnt(0)
    v_xor_b32 v12, v84, v44
    v_bitop3_b32 v12, v12, v85, v45 bitop3:0xf6
    v_bitop3_b32 v12, v12, v86, v46 bitop3:0xf6
    v_bitop3_b32 v12, v12, v87, v47 bitop3:0xf6
    v_cndmask_b32 v12, 0, v12, s[96:97]
    v_bitop3_b32 v12, v12, v72, v44 bitop3:0xf6
    v_bitop3_b32 v12, v12, v73, v45 bitop3:0xf6
    v_bitop3_b32 v12, v12, v74, v46 bitop3:0xf6
    v_bitop3_b32 v12, v12, v75, v47 bitop3:0xf6
    v_bitop3_b32 v12, v12, v76, v44 bitop3:0xf6
    v_bitop3_b32 v12, v12, v77, v45 bitop3:0xf6
    v_bitop3_b32 v12, v12, v78, v46 bitop3:0xf6
    v_bitop3_b32 v12, v12, v79, v47 bitop3:0xf6
    v_bitop3_b32 v12, v12, v80, v44 bitop3:0xf6
    v_bitop3_b32 v12, v12, v81, v45 bitop3:0xf6
    v_bitop3_b32 v12, v12, v82, v46 bitop3:0xf6
    v_bitop3_b32 v12, v12, v83, v47 bitop3:0xf6
    v_and_b32 v12, 0xff, v12
    v_cmp_ne_u32 vcc, 0, v12
    s_add_u32 s80, s80, 1
    s_cmp_lt_u32 s80, 100000
    s_cselect_b64 s[82:83], vcc, 0
    s_cmp_lg_u64 s[82:83], 0
    s_cbranch_scc1 L_retry_h2
    s_nop 4
L_ok_h2:
    v_and_b32 v72, s88, v72
    v_and_b32 v73, s88, v73
    v_and_b32_e64 v74, s88, v74
    s_mov_b32 s70, 163840
    s_add_u32 m0, s74, 81920
    s_nop 0
    buffer_load_dwordx4 v30, s[36:39], s70 offen offset:0 sc1 lds
    v_and_b32 v75, s88, v75
    v_and_b32 v76, s88, v76
    v_and_b32 v77, s88, v77
    v_and_b32 v78, s88, v78
    v_and_b32 v79, s88, v79
    v_and_b32 v80, s88, v80
    v_and_b32 v81, s88, v81
    v_and_b32_e64 v82, s88, v82
    buffer_load_dwordx4 v30, s[36:39], s70 offen offset:1024 sc1 lds
    v_and_b32 v83, s88, v83
    v_and_b32 v84, s88, v84
    v_and_b32 v85, s88, v85
    v_and_b32 v86, s88, v86
    v_and_b32_e64 v87, s88, v87
    v_cvt_pk_bf16_f32 v72, v72, v73
    v_cvt_pk_bf16_f32 v73, v74, v75
    ds_write_b64 v60, v[72:73]
    v_cvt_pk_bf16_f32 v76, v76, v77
    buffer_load_dwordx4 v30, s[36:39], s70 offen offset:2048 sc1 lds
    v_cvt_pk_bf16_f32 v77, v78, v79
    ds_write_b64 v61, v[76:77]
    v_cvt_pk_bf16_f32 v80, v80, v81
    v_cvt_pk_bf16_f32 v81, v82, v83
    ds_write_b64 v62, v[80:81]
    v_cvt_pk_bf16_f32 v84, v84, v85
    v_cvt_pk_bf16_f32 v85, v86, v87
    ds_write_b64 v63, v[84:85]
    s_waitcnt lgkmcnt(0)
    s_barrier
    ds_read_b128 a[192:195], v64 offset:0
    buffer_load_dwordx4 v30, s[36:39], s70 offen offset:3072 sc1 lds
    ds_read_b128 a[212:215], v65 offset:0
    ds_read_b128 a[252:255], v67 offset:0
    ds_read_b128 a[196:199], v64 offset:16
    ds_read_b128 a[216:219], v65 offset:16
    ds_read_b128 v[72:75], v67 offset:16
    ds_read_b128 a[200:203], v64 offset:32
    ds_read_b128 a[220:223], v65 offset:32
    ds_read_b128 v[76:79], v67 offset:32
    ds_read_b128 a[204:207], v64 offset:48
    ds_read_b128 a[224:227], v65 offset:48
    ds_read_b128 v[80:83], v67 offset:48
    ds_read_b128 a[208:211], v64 offset:64
    s_mov_b32 s70, 167936
    s_add_u32 m0, s74, 86016
    s_nop 0
    buffer_load_dwordx4 v30, s[36:39], s70 offen sc1 lds
    ds_read_b128 a[228:231], v65 offset:64
    ds_read_b128 v[84:87], v67 offset:64
    ds_read_b128 a[232:235], v66 offset:0
    ds_read_b128 a[236:239], v66 offset:16
    ds_read_b128 a[240:243], v66 offset:32
    ds_read_b128 a[244:247], v66 offset:48
    ds_read_b128 a[248:251], v66 offset:64
    s_waitcnt lgkmcnt(15)
    v_mfma_f32_32x32x16_bf16 v[208:223], a[192:195], v[168:171], 0
    s_mov_b32 s70, 184320
    s_add_u32 m0, s74, 102400
    s_nop 0
    buffer_load_dwordx4 v30, s[36:39], s70 offen offset:0 sc1 lds
    v_mfma_f32_32x32x16_bf16 v[224:239], a[212:215], v[168:171], 0
    v_mfma_f32_32x32x16_bf16 v[240:255], a[252:255], v[188:191], 0
    buffer_load_dwordx4 v30, s[36:39], s70 offen offset:1024 sc1 lds
    v_mfma_f32_32x32x16_bf16 v[208:223], a[196:199], v[172:175], v[208:223]
    v_mfma_f32_32x32x16_bf16 v[224:239], a[216:219], v[172:175], v[224:239]
    buffer_load_dwordx4 v30, s[36:39], s70 offen offset:2048 sc1 lds
    s_waitcnt lgkmcnt(14)
    v_mfma_f32_32x32x16_bf16 v[240:255], v[72:75], v[192:195], v[240:255]
    s_waitcnt lgkmcnt(13)
    v_mfma_f32_32x32x16_bf16 v[208:223], a[200:203], v[176:179], v[208:223]
    buffer_load_dwordx4 v30, s[36:39], s70 offen offset:3072 sc1 lds
    s_waitcnt lgkmcnt(12)
    v_mfma_f32_32x32x16_bf16 v[224:239], a[220:223], v[176:179], v[224:239]
    s_waitcnt lgkmcnt(11)
    v_mfma_f32_32x32x16_bf16 v[240:255], v[76:79], v[196:199], v[240:255]
    s_mov_b32 s70, 188416
    s_add_u32 m0, s74, 106496
    s_nop 0
    buffer_load_dwordx4 v30, s[36:39], s70 offen sc1 lds
    s_waitcnt lgkmcnt(10)
    v_mfma_f32_32x32x16_bf16 v[208:223], a[204:207], v[180:183], v[208:223]
    s_waitcnt lgkmcnt(9)
    v_mfma_f32_32x32x16_bf16 v[224:239], a[224:227], v[180:183], v[224:239]
    s_waitcnt lgkmcnt(8)
    v_mfma_f32_32x32x16_bf16 v[240:255], v[80:83], v[200:203], v[240:255]
    s_waitcnt lgkmcnt(7)
    v_mfma_f32_32x32x16_bf16 v[208:223], a[208:211], v[184:187], v[208:223]
    s_waitcnt lgkmcnt(6)
    v_mfma_f32_32x32x16_bf16 v[224:239], a[228:231], v[184:187], v[224:239]
    s_waitcnt lgkmcnt(5)
    v_mfma_f32_32x32x16_bf16 v[240:255], v[84:87], v[204:207], v[240:255]
    s_waitcnt lgkmcnt(4)
    v_mfma_f32_32x32x16_bf16 v[224:239], a[232:235], v[188:191], v[224:239]
    s_waitcnt lgkmcnt(3)
    v_mfma_f32_32x32x16_bf16 v[224:239], a[236:239], v[192:195], v[224:239]
    s_waitcnt lgkmcnt(2)
    v_mfma_f32_32x32x16_bf16 v[224:239], a[240:243], v[196:199], v[224:239]
    s_waitcnt lgkmcnt(1)
    v_mfma_f32_32x32x16_bf16 v[224:239], a[244:247], v[200:203], v[224:239]
    s_waitcnt lgkmcnt(0)
    v_mfma_f32_32x32x16_bf16 v[224:239], a[248:251], v[204:207], v[224:239]
    s_nop 1
    v_add_f32 v252, 0x358637bd, v252
    v_rcp_f32 v252, v252
    s_nop 7
    v_pk_mul_f32 v[232:233], v[232:233], v[252:253] op_sel_hi:[1,0]
    v_pk_mul_f32 v[234:235], v[234:235], v[252:253] op_sel_hi:[1,0]
    v_pk_mul_f32 v[236:237], v[236:237], v[252:253] op_sel_hi:[1,0]
    v_pk_mul_f32 v[238:239], v[238:239], v[252:253] op_sel_hi:[1,0]
    v_pk_mul_f32 v[240:241], v[240:241], v[252:253] op_sel_hi:[1,0]
    v_pk_mul_f32 v[242:243], v[242:243], v[252:253] op_sel_hi:[1,0]
    v_pk_mul_f32 v[244:245], v[244:245], v[252:253] op_sel_hi:[1,0]
    v_pk_mul_f32 v[246:247], v[246:247], v[252:253] op_sel_hi:[1,0]
    v_pk_mul_f32 v[248:249], v[248:249], v[252:253] op_sel_hi:[1,0]
    v_pk_mul_f32 v[250:251], v[250:251], v[252:253] op_sel_hi:[1,0]
    v_cvt_pk_bf16_f32 v178, v232, v233
    v_cvt_pk_bf16_f32 v179, v234, v235
    v_cvt_pk_bf16_f32 v180, v236, v237
    v_cvt_pk_bf16_f32 v181, v238, v239
    v_cvt_pk_bf16_f32 v182, v240, v241
    v_cvt_pk_bf16_f32 v183, v242, v243
    v_cvt_pk_bf16_f32 v184, v244, v245
    v_cvt_pk_bf16_f32 v185, v246, v247
    v_cvt_pk_bf16_f32 v186, v248, v249
    v_cvt_pk_bf16_f32 v187, v250, v251
    v_add_f32 v228, 0x358637bd, v228
    v_rcp_f32 v228, v228
    s_nop 0
    v_pk_mul_f32 v[208:209], v[208:209], v[228:229] op_sel_hi:[1,0]
    v_pk_mul_f32 v[210:211], v[210:211], v[228:229] op_sel_hi:[1,0]
    v_pk_mul_f32 v[212:213], v[212:213], v[228:229] op_sel_hi:[1,0]
    v_pk_mul_f32 v[214:215], v[214:215], v[228:229] op_sel_hi:[1,0]
    v_pk_mul_f32 v[216:217], v[216:217], v[228:229] op_sel_hi:[1,0]
    v_pk_mul_f32 v[218:219], v[218:219], v[228:229] op_sel_hi:[1,0]
    v_pk_mul_f32 v[220:221], v[220:221], v[228:229] op_sel_hi:[1,0]
    v_pk_mul_f32 v[222:223], v[222:223], v[228:229] op_sel_hi:[1,0]
    v_pk_mul_f32 v[224:225], v[224:225], v[228:229] op_sel_hi:[1,0]
    v_pk_mul_f32 v[226:227], v[226:227], v[228:229] op_sel_hi:[1,0]
    v_cvt_pk_bf16_f32 v168, v208, v209
    v_cvt_pk_bf16_f32 v169, v210, v211
    v_cvt_pk_bf16_f32 v170, v212, v213
    v_cvt_pk_bf16_f32 v171, v214, v215
    v_cvt_pk_bf16_f32 v172, v216, v217
    v_cvt_pk_bf16_f32 v173, v218, v219
    v_cvt_pk_bf16_f32 v174, v220, v221
    v_cvt_pk_bf16_f32 v175, v222, v223
    v_cvt_pk_bf16_f32 v176, v224, v225
    v_cvt_pk_bf16_f32 v177, v226, v227
    buffer_store_dwordx4 v[168:171], v49, s[36:39], 0 offen offset:0 sc1
    buffer_store_dwordx4 v[172:175], v49, s[36:39], 0 offen offset:256 sc1
    buffer_store_dwordx4 v[176:179], v49, s[36:39], 0 offen offset:512 sc1
    buffer_store_dwordx4 v[180:183], v49, s[36:39], 0 offen offset:768 sc1
    buffer_store_dwordx4 v[184:187], v49, s[36:39], 0 offen offset:1024 sc1
    v_mfma_f32_16x16x32_bf16 v[88:91], v[128:131], a[64:67], v[88:91]
    ds_read_b128 v[108:111], v33 offset:30720
    v_mfma_f32_16x16x32_bf16 v[92:95], v[132:135], a[64:67], v[92:95]
    ds_read_b128 v[112:115], v33 offset:31744
    v_mfma_f32_16x16x32_bf16 v[96:99], v[136:139], a[64:67], v[96:99]
    ds_read_b128 v[116:119], v33 offset:32768
    v_mfma_f32_16x16x32_bf16 v[100:103], v[140:143], a[64:67], v[100:103]
    ds_read_b128 v[120:123], v33 offset:33792
    v_mfma_f32_16x16x32_bf16 v[104:107], v[144:147], a[64:67], v[104:107]
    ds_read_b128 v[124:127], v33 offset:34816
    v_mfma_f32_16x16x32_bf16 v[88:91], v[148:151], a[68:71], v[88:91]
    ds_read_b128 v[128:131], v33 offset:35840
    v_mfma_f32_16x16x32_bf16 v[92:95], v[152:155], a[68:71], v[92:95]
    ds_read_b128 v[132:135], v33 offset:36864
    v_mfma_f32_16x16x32_bf16 v[96:99], v[156:159], a[68:71], v[96:99]
    ds_read_b128 v[136:139], v33 offset:37888
    v_mfma_f32_16x16x32_bf16 v[100:103], v[160:163], a[68:71], v[100:103]
    ds_read_b128 v[140:143], v33 offset:38912
    v_mfma_f32_16x16x32_bf16 v[104:107], v[164:167], a[68:71], v[104:107]
    ds_read_b128 v[144:147], v33 offset:39936
    s_barrier
    s_waitcnt lgkmcnt(5)
    v_mfma_f32_16x16x32_bf16 v[88:91], v[108:111], a[72:75], v[88:91]
    ds_read_b128 v[148:151], v33 offset:40960
    s_mov_b32 s70, 204800
    s_add_u32 m0, s74, 0
    s_nop 0
    buffer_load_dwordx4 v30, s[36:39], s70 offen offset:0 sc1 lds
    v_mfma_f32_16x16x32_bf16 v[92:95], v[112:115], a[72:75], v[92:95]
    ds_read_b128 v[152:155], v33 offset:41984
    buffer_load_dwordx4 v30, s[36:39], s70 offen offset:1024 sc1 lds
    v_mfma_f32_16x16x32_bf16 v[96:99], v[116:119], a[72:75], v[96:99]
    ds_read_b128 v[156:159], v33 offset:43008
    v_mfma_f32_16x16x32_bf16 v[100:103], v[120:123], a[72:75], v[100:103]
    ds_read_b128 v[160:163], v33 offset:44032
    buffer_load_dwordx4 v30, s[36:39], s70 offen offset:2048 sc1 lds
    v_mfma_f32_16x16x32_bf16 v[104:107], v[124:127], a[72:75], v[104:107]
    ds_read_b128 v[164:167], v33 offset:45056
    s_waitcnt lgkmcnt(5)
    v_mfma_f32_16x16x32_bf16 v[88:91], v[128:131], a[76:79], v[88:91]
    ds_read_b128 v[108:111], v33 offset:46080
    v_mfma_f32_16x16x32_bf16 v[92:95], v[132:135], a[76:79], v[92:95]
    ds_read_b128 v[112:115], v33 offset:47104
    buffer_load_dwordx4 v30, s[36:39], s70 offen offset:3072 sc1 lds
    v_mfma_f32_16x16x32_bf16 v[96:99], v[136:139], a[76:79], v[96:99]
    ds_read_b128 v[116:119], v33 offset:48128
    v_mfma_f32_16x16x32_bf16 v[100:103], v[140:143], a[76:79], v[100:103]
    ds_read_b128 v[120:123], v33 offset:49152
    v_mfma_f32_16x16x32_bf16 v[104:107], v[144:147], a[76:79], v[104:107]
    ds_read_b128 v[124:127], v33 offset:50176
    s_mov_b32 s70, 208896
    s_add_u32 m0, s74, 4096
    s_nop 0
    buffer_load_dwordx4 v30, s[36:39], s70 offen sc1 lds
    s_waitcnt lgkmcnt(5)
    v_mfma_f32_16x16x32_bf16 v[88:91], v[148:151], a[80:83], v[88:91]
    ds_read_b128 v[128:131], v33 offset:51200
    v_mfma_f32_16x16x32_bf16 v[92:95], v[152:155], a[80:83], v[92:95]
    ds_read_b128 v[132:135], v33 offset:52224
    v_mfma_f32_16x16x32_bf16 v[96:99], v[156:159], a[80:83], v[96:99]
    ds_read_b128 v[136:139], v33 offset:53248
    v_mfma_f32_16x16x32_bf16 v[100:103], v[160:163], a[80:83], v[100:103]
    ds_read_b128 v[140:143], v33 offset:54272
    v_mfma_f32_16x16x32_bf16 v[104:107], v[164:167], a[80:83], v[104:107]
    ds_read_b128 v[144:147], v33 offset:55296
    s_waitcnt lgkmcnt(5)
    s_waitcnt vmcnt(35)
    v_mfma_f32_16x16x32_bf16 v[88:91], v[108:111], a[84:87], v[88:91]
    ds_read_b128 v[148:151], v33 offset:56320
    buffer_load_dword v35, v37, s[36:39], 0 offen offset:32 sc1
    v_mfma_f32_16x16x32_bf16 v[92:95], v[112:115], a[84:87], v[92:95]
    ds_read_b128 v[152:155], v33 offset:57344
    v_mfma_f32_16x16x32_bf16 v[96:99], v[116:119], a[84:87], v[96:99]
    ds_read_b128 v[156:159], v33 offset:58368
    v_mfma_f32_16x16x32_bf16 v[100:103], v[120:123], a[84:87], v[100:103]
    ds_read_b128 v[160:163], v33 offset:59392
    v_mfma_f32_16x16x32_bf16 v[104:107], v[124:127], a[84:87], v[104:107]
    ds_read_b128 v[164:167], v33 offset:60416
    s_waitcnt vmcnt(6)
    s_barrier
    s_waitcnt lgkmcnt(5)
    v_mfma_f32_16x16x32_bf16 v[88:91], v[128:131], a[88:91], v[88:91]
    v_add_u32 v33, 122880, v33
    ds_read_b128 v[108:111], v33 offset:0
    s_mov_b32 s70, 225280
    s_add_u32 m0, s74, 20480
    s_nop 0
    buffer_load_dwordx4 v30, s[36:39], s70 offen offset:0 sc1 lds
    v_mfma_f32_16x16x32_bf16 v[92:95], v[132:135], a[88:91], v[92:95]
    ds_read_b128 v[112:115], v33 offset:1024
    buffer_load_dwordx4 v30, s[36:39], s70 offen offset:1024 sc1 lds
    buffer_store_dword v16, v57, s[36:39], 0 offen sc1
    v_mfma_f32_16x16x32_bf16 v[96:99], v[136:139], a[88:91], v[96:99]
    ds_read_b128 v[116:119], v33 offset:2048
    v_mfma_f32_16x16x32_bf16 v[100:103], v[140:143], a[88:91], v[100:103]
    ds_read_b128 v[120:123], v33 offset:3072
    buffer_load_dwordx4 v30, s[36:39], s70 offen offset:2048 sc1 lds
    v_mfma_f32_16x16x32_bf16 v[104:107], v[144:147], a[88:91], v[104:107]
    ds_read_b128 v[124:127], v33 offset:4096
    s_waitcnt lgkmcnt(5)
    v_mfma_f32_16x16x32_bf16 v[88:91], v[148:151], a[92:95], v[88:91]
    ds_read_b128 v[128:131], v33 offset:5120
    v_mfma_f32_16x16x32_bf16 v[92:95], v[152:155], a[92:95], v[92:95]
    ds_read_b128 v[132:135], v33 offset:6144
    buffer_load_dwordx4 v30, s[36:39], s70 offen offset:3072 sc1 lds
    v_mfma_f32_16x16x32_bf16 v[96:99], v[156:159], a[92:95], v[96:99]
    ds_read_b128 v[136:139], v33 offset:7168
    v_mfma_f32_16x16x32_bf16 v[100:103], v[160:163], a[92:95], v[100:103]
    ds_read_b128 v[140:143], v33 offset:8192
    v_mfma_f32_16x16x32_bf16 v[104:107], v[164:167], a[92:95], v[104:107]
    ds_read_b128 v[144:147], v33 offset:9216
    s_mov_b32 s70, 229376
    s_add_u32 m0, s74, 24576
    s_nop 0
    buffer_load_dwordx4 v30, s[36:39], s70 offen sc1 lds
    s_waitcnt lgkmcnt(5)
    v_mfma_f32_16x16x32_bf16 v[88:91], v[108:111], a[96:99], v[88:91]
    ds_read_b128 v[148:151], v33 offset:10240
    v_mfma_f32_16x16x32_bf16 v[92:95], v[112:115], a[96:99], v[92:95]
    ds_read_b128 v[152:155], v33 offset:11264
    v_mfma_f32_16x16x32_bf16 v[96:99], v[116:119], a[96:99], v[96:99]
    ds_read_b128 v[156:159], v33 offset:12288
    v_mfma_f32_16x16x32_bf16 v[100:103], v[120:123], a[96:99], v[100:103]
    ds_read_b128 v[160:163], v33 offset:13312
    v_mfma_f32_16x16x32_bf16 v[104:107], v[124:127], a[96:99], v[104:107]
    ds_read_b128 v[164:167], v33 offset:14336
    s_waitcnt lgkmcnt(5)
    v_mfma_f32_16x16x32_bf16 v[88:91], v[128:131], a[100:103], v[88:91]
    ds_read_b128 v[108:111], v33 offset:15360
    s_mov_b32 s80, 0
    s_waitcnt vmcnt(6)
    v_cmp_ne_u32 vcc, v35, v16
    s_nop 0
    s_cbranch_vccz L_ok_faB
L_retry_faB:
    s_sleep 1
    buffer_load_dword v35, v37, s[36:39], 0 offen offset:32 sc1
    s_waitcnt vmcnt(0)
    v_cmp_ne_u32 vcc, v35, v16
    s_add_u32 s80, s80, 1
    s_cmp_lt_u32 s80, 100000
    s_cselect_b64 s[82:83], vcc, 0
    s_cmp_lg_u64 s[82:83], 0
    s_cbranch_scc1 L_retry_faB
    s_nop 4
L_ok_faB:
    v_mfma_f32_16x16x32_bf16 v[92:95], v[132:135], a[100:103], v[92:95]
    ds_read_b128 v[112:115], v33 offset:16384
    s_mul_i32 s63, s85, 20480
    s_mul_i32 s64, s84, 160
    s_add_u32 s63, s63, s64
    s_mul_i32 s65, s56, 5376
    v_mfma_f32_16x16x32_bf16 v[96:99], v[136:139], a[100:103], v[96:99]
    ds_read_b128 v[116:119], v33 offset:17408
    s_add_u32 s65, s65, 0
    v_add_u32_e64 v2, 0, v1
    v_mul_u32_u24 v3, 6554, v2
    v_lshrrev_b32_e64 v3, 16, v3
    v_mfma_f32_16x16x32_bf16 v[100:103], v[140:143], a[100:103], v[100:103]
    ds_read_b128 v[120:123], v33 offset:18432
    v_mul_u32_u24 v4, 10, v3
    v_sub_u32 v4, v2, v4
    v_mul_u32_u24 v5, 1280, v3
    v_mfma_f32_16x16x32_bf16 v[104:107], v[144:147], a[100:103], v[104:107]
    ds_read_b128 v[124:127], v33 offset:19456
    v_lshl_add_u32 v5, v4, 4, v5
    v_add_u32_e64 v18, s63, v5
    v_mul_u32_u24 v5, 336, v3
    s_barrier
    s_waitcnt lgkmcnt(5)
    v_mfma_f32_16x16x32_bf16 v[88:91], v[148:151], a[104:107], v[88:91]
    v_subrev_u32 v33, 61440, v33
    ds_read_b128 v[128:131], v33 offset:0
    s_mov_b32 s69, 0
    buffer_load_dwordx4 a[128:131], v31, s[36:39], s69 offen offset:0 sc1
    v_lshl_add_u32 v5, v4, 5, v5
    v_mfma_f32_16x16x32_bf16 v[92:95], v[152:155], a[104:107], v[92:95]
    ds_read_b128 v[132:135], v33 offset:1024
    buffer_load_dwordx4 a[132:135], v31, s[36:39], s69 offen offset:1024 sc1
    v_add_u32 v22, s65, v5
    v_add_u32_e64 v2, 64, v1
    v_mul_u32_u24 v3, 6554, v2
    v_mfma_f32_16x16x32_bf16 v[96:99], v[156:159], a[104:107], v[96:99]
    ds_read_b128 v[136:139], v33 offset:2048
    v_lshrrev_b32 v3, 16, v3
    v_mul_u32_u24 v4, 10, v3
    v_sub_u32_e64 v4, v2, v4
    v_mfma_f32_16x16x32_bf16 v[100:103], v[160:163], a[104:107], v[100:103]
    ds_read_b128 v[140:143], v33 offset:3072
    buffer_load_dwordx4 a[136:139], v31, s[36:39], s69 offen offset:2048 sc1
    v_mul_u32_u24 v5, 1280, v3
    v_lshl_add_u32 v5, v4, 4, v5
    v_add_u32_e64 v19, s63, v5
    v_mfma_f32_16x16x32_bf16 v[104:107], v[164:167], a[104:107], v[104:107]
    ds_read_b128 v[144:147], v33 offset:4096
    v_mul_u32_u24 v5, 336, v3
    v_lshl_add_u32 v5, v4, 5, v5
    v_add_u32 v23, s65, v5
    s_waitcnt lgkmcnt(5)
    v_mfma_f32_16x16x32_bf16 v[88:91], v[108:111], a[108:111], v[88:91]
    ds_read_b128 v[148:151], v33 offset:5120
    v_add_u32 v2, 128, v1
    v_mul_u32_u24 v3, 6554, v2
    v_lshrrev_b32_e64 v3, 16, v3
    v_mfma_f32_16x16x32_bf16 v[92:95], v[112:115], a[108:111], v[92:95]
    ds_read_b128 v[152:155], v33 offset:6144
    buffer_load_dwordx4 a[140:143], v31, s[36:39], s69 offen offset:3072 sc1
    v_mul_u32_u24 v4, 10, v3
    v_sub_u32 v4, v2, v4
    v_mul_u32_u24 v5, 1280, v3
    v_mfma_f32_16x16x32_bf16 v[96:99], v[116:119], a[108:111], v[96:99]
    ds_read_b128 v[156:159], v33 offset:7168
    v_lshl_add_u32 v5, v4, 4, v5
    v_add_u32_e64 v20, s63, v5
    v_mul_u32_u24 v5, 336, v3
    v_mfma_f32_16x16x32_bf16 v[100:103], v[120:123], a[108:111], v[100:103]
    ds_read_b128 v[160:163], v33 offset:8192
    v_lshl_add_u32 v5, v4, 5, v5
    v_add_u32 v24, s65, v5
    v_cmp_gt_u32 vcc, 32, v1
    v_mfma_f32_16x16x32_bf16 v[104:107], v[124:127], a[108:111], v[104:107]
    ds_read_b128 v[164:167], v33 offset:9216
    s_mov_b32 s69, 12288
    buffer_load_dwordx4 a[144:147], v31, s[36:39], s69 offen offset:0 sc1
    v_mov_b32 v2, 2130706432
    s_waitcnt lgkmcnt(5)
    v_mfma_f32_16x16x32_bf16 v[88:91], v[128:131], a[112:115], v[88:91]
    ds_read_b128 v[108:111], v33 offset:10240
    v_cndmask_b32 v20, v2, v20, vcc
    v_cndmask_b32 v24, v22, v24, vcc
    v_and_b32 v2, 15, v1
    v_mfma_f32_16x16x32_bf16 v[92:95], v[132:135], a[112:115], v[92:95]
    ds_read_b128 v[112:115], v33 offset:11264
    v_mul_u32_u24 v2, 336, v2
    v_lshl_add_u32 v2, v11, 4, v2
    v_add_u32_e64 v17, s65, v2
    buffer_load_dwordx4 v[208:211], v18, s[24:27], 0 offen
    v_mfma_f32_16x16x32_bf16 v[96:99], v[136:139], a[112:115], v[96:99]
    ds_read_b128 v[116:119], v33 offset:12288
    buffer_load_dwordx4 a[148:151], v31, s[36:39], s69 offen offset:1024 sc1
    buffer_load_dwordx4 v[212:215], v19, s[24:27], 0 offen
    buffer_load_dwordx4 v[216:219], v20, s[24:27], 0 offen
    v_mfma_f32_16x16x32_bf16 v[100:103], v[140:143], a[112:115], v[100:103]
    ds_read_b128 v[120:123], v33 offset:13312
    v_mfma_f32_16x16x32_bf16 v[104:107], v[144:147], a[112:115], v[104:107]
    ds_read_b128 v[124:127], v33 offset:14336
    s_waitcnt lgkmcnt(5)
    v_mfma_f32_16x16x32_bf16 v[88:91], v[148:151], a[116:119], v[88:91]
    ds_read_b128 v[128:131], v33 offset:15360
    buffer_load_dwordx4 a[152:155], v31, s[36:39], s69 offen offset:2048 sc1
    v_mfma_f32_16x16x32_bf16 v[92:95], v[152:155], a[116:119], v[92:95]
    ds_read_b128 v[132:135], v33 offset:16384
    v_mfma_f32_16x16x32_bf16 v[96:99], v[156:159], a[116:119], v[96:99]
    ds_read_b128 v[136:139], v33 offset:17408
    v_mfma_f32_16x16x32_bf16 v[100:103], v[160:163], a[116:119], v[100:103]
    ds_read_b128 v[140:143], v33 offset:18432
    buffer_load_dwordx4 a[156:159], v31, s[36:39], s69 offen offset:3072 sc1
    v_mfma_f32_16x16x32_bf16 v[104:107], v[164:167], a[116:119], v[104:107]
    ds_read_b128 v[144:147], v33 offset:19456
    s_barrier
    s_waitcnt lgkmcnt(5)
    v_mfma_f32_16x16x32_bf16 v[88:91], v[108:111], a[120:123], v[88:91]
    ds_read_b128 v[148:151], v33 offset:20480
    v_mfma_f32_16x16x32_bf16 v[92:95], v[112:115], a[120:123], v[92:95]
    ds_read_b128 v[152:155], v33 offset:21504
    s_mov_b32 s69, 24576
    buffer_load_dwordx4 a[160:163], v31, s[36:39], s69 offen offset:0 sc1
    v_mfma_f32_16x16x32_bf16 v[96:99], v[116:119], a[120:123], v[96:99]
    ds_read_b128 v[156:159], v33 offset:22528
    v_mfma_f32_16x16x32_bf16 v[100:103], v[120:123], a[120:123], v[100:103]
    ds_read_b128 v[160:163], v33 offset:23552
    v_mfma_f32_16x16x32_bf16 v[104:107], v[124:127], a[120:123], v[104:107]
    ds_read_b128 v[164:167], v33 offset:24576
    buffer_load_dwordx4 a[164:167], v31, s[36:39], s69 offen offset:1024 sc1
    s_waitcnt lgkmcnt(5)
    v_mfma_f32_16x16x32_bf16 v[88:91], v[128:131], a[124:127], v[88:91]
    ds_read_b128 v[108:111], v33 offset:25600
    v_mfma_f32_16x16x32_bf16 v[92:95], v[132:135], a[124:127], v[92:95]
    ds_read_b128 v[112:115], v33 offset:26624
    v_mfma_f32_16x16x32_bf16 v[96:99], v[136:139], a[124:127], v[96:99]
    ds_read_b128 v[116:119], v33 offset:27648
    buffer_load_dwordx4 a[168:171], v31, s[36:39], s69 offen offset:2048 sc1
    v_mfma_f32_16x16x32_bf16 v[100:103], v[140:143], a[124:127], v[100:103]
    ds_read_b128 v[120:123], v33 offset:28672
    v_mfma_f32_16x16x32_bf16 v[104:107], v[144:147], a[124:127], v[104:107]
    ds_read_b128 v[124:127], v33 offset:29696
    s_waitcnt lgkmcnt(5)
    s_waitcnt vmcnt(13)
    v_mfma_f32_16x16x32_bf16 v[88:91], v[148:151], a[128:131], v[88:91]
    ds_read_b128 v[128:131], v33 offset:30720
    buffer_load_dwordx4 a[172:175], v31, s[36:39], s69 offen offset:3072 sc1
    v_mfma_f32_16x16x32_bf16 v[92:95], v[152:155], a[128:131], v[92:95]
    ds_read_b128 v[132:135], v33 offset:31744
    v_mfma_f32_16x16x32_bf16 v[96:99], v[156:159], a[128:131], v[96:99]
    ds_read_b128 v[136:139], v33 offset:32768
    v_mfma_f32_16x16x32_bf16 v[100:103], v[160:163], a[128:131], v[100:103]
    ds_read_b128 v[140:143], v33 offset:33792
    s_mov_b32 s69, 36864
    buffer_load_dwordx4 a[176:179], v31, s[36:39], s69 offen offset:0 sc1
    v_mfma_f32_16x16x32_bf16 v[104:107], v[164:167], a[128:131], v[104:107]
    ds_read_b128 v[144:147], v33 offset:34816
    s_waitcnt lgkmcnt(5)
    s_waitcnt vmcnt(14)
    v_mfma_f32_16x16x32_bf16 v[88:91], v[108:111], a[132:135], v[88:91]
    ds_read_b128 v[148:151], v33 offset:35840
    v_mfma_f32_16x16x32_bf16 v[92:95], v[112:115], a[132:135], v[92:95]
    ds_read_b128 v[152:155], v33 offset:36864
    buffer_load_dwordx4 a[180:183], v31, s[36:39], s69 offen offset:1024 sc1
    v_mfma_f32_16x16x32_bf16 v[96:99], v[116:119], a[132:135], v[96:99]
    ds_read_b128 v[156:159], v33 offset:37888
    v_mfma_f32_16x16x32_bf16 v[100:103], v[120:123], a[132:135], v[100:103]
    ds_read_b128 v[160:163], v33 offset:38912
    v_mfma_f32_16x16x32_bf16 v[104:107], v[124:127], a[132:135], v[104:107]
    ds_read_b128 v[164:167], v33 offset:39936
    buffer_load_dwordx4 a[184:187], v31, s[36:39], s69 offen offset:2048 sc1
    s_barrier
    s_waitcnt lgkmcnt(5)
    s_waitcnt vmcnt(15)
    v_mfma_f32_16x16x32_bf16 v[88:91], v[128:131], a[136:139], v[88:91]
    ds_read_b128 v[108:111], v33 offset:40960
    buffer_load_dword v35, v37, s[36:39], 0 offen offset:2048 sc1
    v_mfma_f32_16x16x32_bf16 v[92:95], v[132:135], a[136:139], v[92:95]
    ds_read_b128 v[112:115], v33 offset:41984
    v_mfma_f32_16x16x32_bf16 v[96:99], v[136:139], a[136:139], v[96:99]
    ds_read_b128 v[116:119], v33 offset:43008
    buffer_load_dwordx4 a[188:191], v31, s[36:39], s69 offen offset:3072 sc1
    v_mfma_f32_16x16x32_bf16 v[100:103], v[140:143], a[136:139], v[100:103]
    ds_read_b128 v[120:123], v33 offset:44032
    v_mfma_f32_16x16x32_bf16 v[104:107], v[144:147], a[136:139], v[104:107]
    ds_read_b128 v[124:127], v33 offset:45056
    s_waitcnt lgkmcnt(5)
    s_waitcnt vmcnt(16)
    v_mfma_f32_16x16x32_bf16 v[88:91], v[148:151], a[140:143], v[88:91]
    ds_read_b128 v[128:131], v33 offset:46080
    s_mov_b32 s70, 245760
    s_add_u32 m0, s74, 40960
    s_nop 0
    buffer_load_dwordx4 v30, s[36:39], s70 offen offset:0 sc1 lds
    v_mfma_f32_16x16x32_bf16 v[92:95], v[152:155], a[140:143], v[92:95]
    ds_read_b128 v[132:135], v33 offset:47104
    v_mfma_f32_16x16x32_bf16 v[96:99], v[156:159], a[140:143], v[96:99]
    ds_read_b128 v[136:139], v33 offset:48128
    v_mfma_f32_16x16x32_bf16 v[100:103], v[160:163], a[140:143], v[100:103]
    ds_read_b128 v[140:143], v33 offset:49152
    buffer_load_dwordx4 v30, s[36:39], s70 offen offset:1024 sc1 lds
    v_mfma_f32_16x16x32_bf16 v[104:107], v[164:167], a[140:143], v[104:107]
    ds_read_b128 v[144:147], v33 offset:50176
    s_waitcnt lgkmcnt(5)
    s_waitcnt vmcnt(17)
    v_mfma_f32_16x16x32_bf16 v[88:91], v[108:111], a[144:147], v[88:91]
    ds_read_b128 v[148:151], v33 offset:51200
    v_mfma_f32_16x16x32_bf16 v[92:95], v[112:115], a[144:147], v[92:95]
    ds_read_b128 v[152:155], v33 offset:52224
    buffer_load_dwordx4 v30, s[36:39], s70 offen offset:2048 sc1 lds
    v_mfma_f32_16x16x32_bf16 v[96:99], v[116:119], a[144:147], v[96:99]
    ds_read_b128 v[156:159], v33 offset:53248
    v_mfma_f32_16x16x32_bf16 v[100:103], v[120:123], a[144:147], v[100:103]
    ds_read_b128 v[160:163], v33 offset:54272
    v_mfma_f32_16x16x32_bf16 v[104:107], v[124:127], a[144:147], v[104:107]
    ds_read_b128 v[164:167], v33 offset:55296
    buffer_load_dwordx4 v30, s[36:39], s70 offen offset:3072 sc1 lds
    s_waitcnt lgkmcnt(5)
    s_waitcnt vmcnt(17)
    v_mfma_f32_16x16x32_bf16 v[88:91], v[128:131], a[148:151], v[88:91]
    ds_read_b128 v[108:111], v33 offset:56320
    v_mfma_f32_16x16x32_bf16 v[92:95], v[132:135], a[148:151], v[92:95]
    ds_read_b128 v[112:115], v33 offset:57344
    v_mfma_f32_16x16x32_bf16 v[96:99], v[136:139], a[148:151], v[96:99]
    ds_read_b128 v[116:119], v33 offset:58368
    s_mov_b32 s70, 249856
    s_add_u32 m0, s74, 45056
    s_nop 0
    buffer_load_dwordx4 v30, s[36:39], s70 offen sc1 lds
    v_mfma_f32_16x16x32_bf16 v[100:103], v[140:143], a[148:151], v[100:103]
    ds_read_b128 v[120:123], v33 offset:59392
    v_mfma_f32_16x16x32_bf16 v[104:107], v[144:147], a[148:151], v[104:107]
    ds_read_b128 v[124:127], v33 offset:60416
    s_barrier
    s_waitcnt lgkmcnt(5)
    s_waitcnt vmcnt(15)
    v_mfma_f32_16x16x32_bf16 v[88:91], v[148:151], a[152:155], v[88:91]
    v_subrev_u32 v33, 61440, v33
    ds_read_b128 v[128:131], v33 offset:0
    s_mov_b32 s70, 266240
    s_add_u32 m0, s74, 122880
    s_nop 0
    buffer_load_dwordx4 v30, s[36:39], s70 offen offset:0 sc1 lds
    v_mfma_f32_16x16x32_bf16 v[92:95], v[152:155], a[152:155], v[92:95]
    ds_read_b128 v[132:135], v33 offset:1024
    v_mfma_f32_16x16x32_bf16 v[96:99], v[156:159], a[152:155], v[96:99]
    ds_read_b128 v[136:139], v33 offset:2048
    v_mfma_f32_16x16x32_bf16 v[100:103], v[160:163], a[152:155], v[100:103]
    ds_read_b128 v[140:143], v33 offset:3072
    buffer_load_dwordx4 v30, s[36:39], s70 offen offset:1024 sc1 lds
    v_mfma_f32_16x16x32_bf16 v[104:107], v[164:167], a[152:155], v[104:107]
    ds_read_b128 v[144:147], v33 offset:4096
    s_waitcnt lgkmcnt(5)
    s_waitcnt vmcnt(16)
    v_mfma_f32_16x16x32_bf16 v[88:91], v[108:111], a[156:159], v[88:91]
    ds_read_b128 v[148:151], v33 offset:5120
    v_mfma_f32_16x16x32_bf16 v[92:95], v[112:115], a[156:159], v[92:95]
    ds_read_b128 v[152:155], v33 offset:6144
    buffer_load_dwordx4 v30, s[36:39], s70 offen offset:2048 sc1 lds
    v_mfma_f32_16x16x32_bf16 v[96:99], v[116:119], a[156:159], v[96:99]
    ds_read_b128 v[156:159], v33 offset:7168
    v_mfma_f32_16x16x32_bf16 v[100:103], v[120:123], a[156:159], v[100:103]
    ds_read_b128 v[160:163], v33 offset:8192
    v_mfma_f32_16x16x32_bf16 v[104:107], v[124:127], a[156:159], v[104:107]
    ds_read_b128 v[164:167], v33 offset:9216
    buffer_load_dwordx4 v30, s[36:39], s70 offen offset:3072 sc1 lds
    s_waitcnt lgkmcnt(5)
    s_waitcnt vmcnt(17)
    v_mfma_f32_16x16x32_bf16 v[88:91], v[128:131], a[160:163], v[88:91]
    ds_read_b128 v[108:111], v33 offset:10240
    v_mfma_f32_16x16x32_bf16 v[92:95], v[132:135], a[160:163], v[92:95]
    ds_read_b128 v[112:115], v33 offset:11264
    v_mfma_f32_16x16x32_bf16 v[96:99], v[136:139], a[160:163], v[96:99]
    ds_read_b128 v[116:119], v33 offset:12288
    s_mov_b32 s70, 270336
    s_add_u32 m0, s74, 126976
    s_nop 0
    buffer_load_dwordx4 v30, s[36:39], s70 offen sc1 lds
    v_mfma_f32_16x16x32_bf16 v[100:103], v[140:143], a[160:163], v[100:103]
    ds_read_b128 v[120:123], v33 offset:13312
    v_mfma_f32_16x16x32_bf16 v[104:107], v[144:147], a[160:163], v[104:107]
    ds_read_b128 v[124:127], v33 offset:14336
    s_waitcnt lgkmcnt(5)
    s_waitcnt vmcnt(17)
    v_mfma_f32_16x16x32_bf16 v[88:91], v[148:151], a[164:167], v[88:91]
    ds_read_b128 v[128:131], v33 offset:15360
    s_mov_b32 s70, 286720
    s_add_u32 m0, s74, 61440
    s_nop 0
    buffer_load_dwordx4 v30, s[36:39], s70 offen offset:0 sc1 lds
    s_mov_b32 s80, 0
    s_waitcnt vmcnt(12)
    v_cmp_ne_u32 vcc, v35, v16
    s_nop 0
    s_cbranch_vccz L_ok_foB
L_retry_foB:
    s_sleep 1
    buffer_load_dword v35, v37, s[36:39], 0 offen offset:2048 sc1
    s_waitcnt vmcnt(0)
    v_cmp_ne_u32 vcc, v35, v16
    s_add_u32 s80, s80, 1
    s_cmp_lt_u32 s80, 100000
    s_cselect_b64 s[82:83], vcc, 0
    s_cmp_lg_u64 s[82:83], 0
    s_cbranch_scc1 L_retry_foB
    s_nop 4
L_ok_foB:
    v_mfma_f32_16x16x32_bf16 v[92:95], v[152:155], a[164:167], v[92:95]
    ds_read_b128 v[132:135], v33 offset:16384
    v_mfma_f32_16x16x32_bf16 v[96:99], v[156:159], a[164:167], v[96:99]
    ds_read_b128 v[136:139], v33 offset:17408
    v_mfma_f32_16x16x32_bf16 v[100:103], v[160:163], a[164:167], v[100:103]
    ds_read_b128 v[140:143], v33 offset:18432
    buffer_load_dwordx4 v30, s[36:39], s70 offen offset:1024 sc1 lds
    v_mfma_f32_16x16x32_bf16 v[104:107], v[164:167], a[164:167], v[104:107]
    ds_read_b128 v[144:147], v33 offset:19456
    s_barrier
    s_waitcnt lgkmcnt(5)
    v_mfma_f32_16x16x32_bf16 v[88:91], v[108:111], a[168:171], v[88:91]
    ds_read_b128 v[148:151], v33 offset:20480
    v_mfma_f32_16x16x32_bf16 v[92:95], v[112:115], a[168:171], v[92:95]
    ds_read_b128 v[152:155], v33 offset:21504
    s_mov_b32 s69, 0
    buffer_load_dwordx4 a[0:3], v32, s[36:39], s69 offen offset:0 sc1
    v_mfma_f32_16x16x32_bf16 v[96:99], v[116:119], a[168:171], v[96:99]
    ds_read_b128 v[156:159], v33 offset:22528
    v_mfma_f32_16x16x32_bf16 v[100:103], v[120:123], a[168:171], v[100:103]
    ds_read_b128 v[160:163], v33 offset:23552
    v_mfma_f32_16x16x32_bf16 v[104:107], v[124:127], a[168:171], v[104:107]
    ds_read_b128 v[164:167], v33 offset:24576
    buffer_load_dwordx4 a[4:7], v32, s[36:39], s69 offen offset:1024 sc1
    s_waitcnt lgkmcnt(5)
    v_mfma_f32_16x16x32_bf16 v[88:91], v[128:131], a[172:175], v[88:91]
    ds_read_b128 v[108:111], v33 offset:25600
    v_mfma_f32_16x16x32_bf16 v[92:95], v[132:135], a[172:175], v[92:95]
    ds_read_b128 v[112:115], v33 offset:26624
    v_mfma_f32_16x16x32_bf16 v[96:99], v[136:139], a[172:175], v[96:99]
    ds_read_b128 v[116:119], v33 offset:27648
    buffer_load_dwordx4 a[8:11], v32, s[36:39], s69 offen offset:2048 sc1
    v_mfma_f32_16x16x32_bf16 v[100:103], v[140:143], a[172:175], v[100:103]
    ds_read_b128 v[120:123], v33 offset:28672
    v_mfma_f32_16x16x32_bf16 v[104:107], v[144:147], a[172:175], v[104:107]
    ds_read_b128 v[124:127], v33 offset:29696
    s_waitcnt lgkmcnt(5)
    v_mfma_f32_16x16x32_bf16 v[88:91], v[148:151], a[176:179], v[88:91]
    ds_read_b128 v[128:131], v33 offset:30720
    buffer_load_dwordx4 a[12:15], v32, s[36:39], s69 offen offset:3072 sc1
    v_mfma_f32_16x16x32_bf16 v[92:95], v[152:155], a[176:179], v[92:95]
    ds_read_b128 v[132:135], v33 offset:31744
    v_mfma_f32_16x16x32_bf16 v[96:99], v[156:159], a[176:179], v[96:99]
    ds_read_b128 v[136:139], v33 offset:32768
    v_mfma_f32_16x16x32_bf16 v[100:103], v[160:163], a[176:179], v[100:103]
    ds_read_b128 v[140:143], v33 offset:33792
    s_mov_b32 s69, 4096
    buffer_load_dwordx4 a[16:19], v32, s[36:39], s69 offen offset:0 sc1
    v_mfma_f32_16x16x32_bf16 v[104:107], v[164:167], a[176:179], v[104:107]
    ds_read_b128 v[144:147], v33 offset:34816
    s_waitcnt lgkmcnt(5)
    v_mfma_f32_16x16x32_bf16 v[88:91], v[108:111], a[180:183], v[88:91]
    ds_read_b128 v[148:151], v33 offset:35840
    v_mfma_f32_16x16x32_bf16 v[92:95], v[112:115], a[180:183], v[92:95]
    ds_read_b128 v[152:155], v33 offset:36864
    buffer_load_dwordx4 a[20:23], v32, s[36:39], s69 offen offset:1024 sc1
    v_mfma_f32_16x16x32_bf16 v[96:99], v[116:119], a[180:183], v[96:99]
    ds_read_b128 v[156:159], v33 offset:37888
    v_mfma_f32_16x16x32_bf16 v[100:103], v[120:123], a[180:183], v[100:103]
    ds_read_b128 v[160:163], v33 offset:38912
    v_mfma_f32_16x16x32_bf16 v[104:107], v[124:127], a[180:183], v[104:107]
    ds_read_b128 v[164:167], v33 offset:39936
    buffer_load_dwordx4 a[24:27], v32, s[36:39], s69 offen offset:2048 sc1
    s_waitcnt vmcnt(14)
    s_barrier
    s_waitcnt lgkmcnt(5)
    v_mfma_f32_16x16x32_bf16 v[88:91], v[128:131], a[184:187], v[88:91]
    ds_read_b128 v[108:111], v33 offset:40960
    v_mfma_f32_16x16x32_bf16 v[92:95], v[132:135], a[184:187], v[92:95]
    ds_read_b128 v[112:115], v33 offset:41984
    v_mfma_f32_16x16x32_bf16 v[96:99], v[136:139], a[184:187], v[96:99]
    ds_read_b128 v[116:119], v33 offset:43008
    buffer_load_dwordx4 a[28:31], v32, s[36:39], s69 offen offset:3072 sc1
    v_mfma_f32_16x16x32_bf16 v[100:103], v[140:143], a[184:187], v[100:103]
    ds_read_b128 v[120:123], v33 offset:44032
    v_mfma_f32_16x16x32_bf16 v[104:107], v[144:147], a[184:187], v[104:107]
    ds_read_b128 v[124:127], v33 offset:45056
    s_waitcnt lgkmcnt(5)
    v_mfma_f32_16x16x32_bf16 v[88:91], v[148:151], a[188:191], v[88:91]
    ds_read_b128 v[128:131], v33 offset:46080
    buffer_load_dwordx4 v30, s[36:39], s70 offen offset:2048 sc1 lds
    v_mfma_f32_16x16x32_bf16 v[92:95], v[152:155], a[188:191], v[92:95]
    ds_read_b128 v[132:135], v33 offset:47104
    v_mfma_f32_16x16x32_bf16 v[96:99], v[156:159], a[188:191], v[96:99]
    ds_read_b128 v[136:139], v33 offset:48128
    v_mfma_f32_16x16x32_bf16 v[100:103], v[160:163], a[188:191], v[100:103]
    ds_read_b128 v[140:143], v33 offset:49152
    buffer_load_dwordx4 v30, s[36:39], s70 offen offset:3072 sc1 lds
    v_mfma_f32_16x16x32_bf16 v[104:107], v[164:167], a[188:191], v[104:107]
    ds_read_b128 v[144:147], v33 offset:50176
    s_waitcnt lgkmcnt(5)
    s_waitcnt vmcnt(9)
    v_mfma_f32_16x16x32_bf16 v[236:239], v[108:111], a[0:3], 0
    ds_read_b128 v[148:151], v33 offset:51200
    v_mfma_f32_16x16x32_bf16 v[240:243], v[112:115], a[0:3], 0
    ds_read_b128 v[152:155], v33 offset:52224
    s_mov_b32 s70, 290816
    s_add_u32 m0, s74, 65536
    s_nop 0
    buffer_load_dwordx4 v30, s[36:39], s70 offen sc1 lds
    v_mfma_f32_16x16x32_bf16 v[244:247], v[116:119], a[0:3], 0
    ds_read_b128 v[156:159], v33 offset:53248
    v_mfma_f32_16x16x32_bf16 v[248:251], v[120:123], a[0:3], 0
    ds_read_b128 v[160:163], v33 offset:54272
    v_mfma_f32_16x16x32_bf16 v[252:255], v[124:127], a[0:3], 0
    ds_read_b128 v[164:167], v33 offset:55296
    s_mov_b32 s69, 8192
    buffer_load_dwordx4 a[32:35], v32, s[36:39], s69 offen offset:0 sc1
    s_waitcnt lgkmcnt(5)
    s_waitcnt vmcnt(10)
    v_mfma_f32_16x16x32_bf16 v[236:239], v[128:131], a[4:7], v[236:239]
    ds_read_b128 v[108:111], v33 offset:56320
    v_mov_b32 v26, 0xbfb8aa3b
    v_pk_mul_f32 v[188:189], v[88:89], v[26:27] op_sel_hi:[1,0]
    v_mfma_f32_16x16x32_bf16 v[240:243], v[132:135], a[4:7], v[240:243]
    ds_read_b128 v[112:115], v33 offset:57344
    v_pk_mul_f32 v[190:191], v[90:91], v[26:27] op_sel_hi:[1,0]
    v_pk_mul_f32 v[192:193], v[92:93], v[26:27] op_sel_hi:[1,0]
    v_mfma_f32_16x16x32_bf16 v[244:247], v[136:139], a[4:7], v[244:247]
    ds_read_b128 v[116:119], v33 offset:58368
    buffer_load_dwordx4 a[36:39], v32, s[36:39], s69 offen offset:1024 sc1
    v_pk_mul_f32 v[194:195], v[94:95], v[26:27] op_sel_hi:[1,0]
    v_pk_mul_f32 v[196:197], v[96:97], v[26:27] op_sel_hi:[1,0]
    v_mfma_f32_16x16x32_bf16 v[248:251], v[140:143], a[4:7], v[248:251]
    ds_read_b128 v[120:123], v33 offset:59392
    v_pk_mul_f32 v[198:199], v[98:99], v[26:27] op_sel_hi:[1,0]
    v_pk_mul_f32 v[200:201], v[100:101], v[26:27] op_sel_hi:[1,0]
    v_mfma_f32_16x16x32_bf16 v[252:255], v[144:147], a[4:7], v[252:255]
    ds_read_b128 v[124:127], v33 offset:60416
    v_pk_mul_f32 v[202:203], v[102:103], v[26:27] op_sel_hi:[1,0]
    v_pk_mul_f32 v[204:205], v[104:105], v[26:27] op_sel_hi:[1,0]
    s_barrier
    s_waitcnt lgkmcnt(5)
    s_waitcnt vmcnt(10)
    v_mfma_f32_16x16x32_bf16 v[236:239], v[148:151], a[8:11], v[236:239]
    v_add_u32 v33, 122880, v33
    ds_read_b128 v[128:131], v33 offset:0
    buffer_load_dwordx4 a[40:43], v32, s[36:39], s69 offen offset:2048 sc1
    v_pk_mul_f32 v[206:207], v[106:107], v[26:27] op_sel_hi:[1,0]
    v_mfma_f32_16x16x32_bf16 v[240:243], v[152:155], a[8:11], v[240:243]
    ds_read_b128 v[132:135], v33 offset:1024
    v_exp_f32_e64 v188, v188
    v_mfma_f32_16x16x32_bf16 v[244:247], v[156:159], a[8:11], v[244:247]
    ds_read_b128 v[136:139], v33 offset:2048
    v_exp_f32_e64 v189, v189
    v_mfma_f32_16x16x32_bf16 v[248:251], v[160:163], a[8:11], v[248:251]
    ds_read_b128 v[140:143], v33 offset:3072
    buffer_load_dwordx4 a[44:47], v32, s[36:39], s69 offen offset:3072 sc1
    v_exp_f32_e64 v190, v190
    v_mfma_f32_16x16x32_bf16 v[252:255], v[164:167], a[8:11], v[252:255]
    ds_read_b128 v[144:147], v33 offset:4096
    v_exp_f32 v191, v191
    s_waitcnt lgkmcnt(5)
    s_waitcnt vmcnt(11)
    v_mfma_f32_16x16x32_bf16 v[236:239], v[108:111], a[12:15], v[236:239]
    ds_read_b128 v[148:151], v33 offset:5120
    v_exp_f32 v192, v192
    v_mfma_f32_16x16x32_bf16 v[240:243], v[112:115], a[12:15], v[240:243]
    ds_read_b128 v[152:155], v33 offset:6144
    s_mov_b32 s70, 307200
    s_add_u32 m0, s74, 81920
    s_nop 0
    buffer_load_dwordx4 v30, s[36:39], s70 offen offset:0 sc1 lds
    v_mfma_f32_16x16x32_bf16 v[244:247], v[116:119], a[12:15], v[244:247]
    ds_read_b128 v[156:159], v33 offset:7168
    v_exp_f32 v193, v193
    v_mfma_f32_16x16x32_bf16 v[248:251], v[120:123], a[12:15], v[248:251]
    ds_read_b128 v[160:163], v33 offset:8192
    v_exp_f32_e64 v194, v194
    v_mfma_f32_16x16x32_bf16 v[252:255], v[124:127], a[12:15], v[252:255]
    ds_read_b128 v[164:167], v33 offset:9216
    buffer_load_dwordx4 v30, s[36:39], s70 offen offset:1024 sc1 lds
    v_exp_f32 v195, v195
    s_waitcnt lgkmcnt(5)
    s_waitcnt vmcnt(12)
    v_mfma_f32_16x16x32_bf16 v[236:239], v[128:131], a[16:19], v[236:239]
    ds_read_b128 v[108:111], v33 offset:10240
    v_exp_f32 v196, v196
    v_mfma_f32_16x16x32_bf16 v[240:243], v[132:135], a[16:19], v[240:243]
    ds_read_b128 v[112:115], v33 offset:11264
    v_exp_f32_e64 v197, v197
    v_mfma_f32_16x16x32_bf16 v[244:247], v[136:139], a[16:19], v[244:247]
    ds_read_b128 v[116:119], v33 offset:12288
    buffer_load_dwordx4 v30, s[36:39], s70 offen offset:2048 sc1 lds
    v_exp_f32_e64 v198, v198
    v_mfma_f32_16x16x32_bf16 v[248:251], v[140:143], a[16:19], v[248:251]
    ds_read_b128 v[120:123], v33 offset:13312
    v_exp_f32_e64 v199, v199
    v_mfma_f32_16x16x32_bf16 v[252:255], v[144:147], a[16:19], v[252:255]
    ds_read_b128 v[124:127], v33 offset:14336
    v_exp_f32 v200, v200
    s_waitcnt lgkmcnt(5)
    s_waitcnt vmcnt(12)
    v_mfma_f32_16x16x32_bf16 v[236:239], v[148:151], a[20:23], v[236:239]
    ds_read_b128 v[128:131], v33 offset:15360
    buffer_load_dwordx4 v30, s[36:39], s70 offen offset:3072 sc1 lds
    v_exp_f32 v201, v201
    v_mfma_f32_16x16x32_bf16 v[240:243], v[152:155], a[20:23], v[240:243]
    ds_read_b128 v[132:135], v33 offset:16384
    v_exp_f32_e64 v202, v202
    v_mfma_f32_16x16x32_bf16 v[244:247], v[156:159], a[20:23], v[244:247]
    ds_read_b128 v[136:139], v33 offset:17408
    v_exp_f32_e64 v203, v203
    v_mfma_f32_16x16x32_bf16 v[248:251], v[160:163], a[20:23], v[248:251]
    ds_read_b128 v[140:143], v33 offset:18432
    s_mov_b32 s70, 311296
    s_add_u32 m0, s74, 86016
    s_nop 0
    buffer_load_dwordx4 v30, s[36:39], s70 offen sc1 lds
    v_mfma_f32_16x16x32_bf16 v[252:255], v[164:167], a[20:23], v[252:255]
    ds_read_b128 v[144:147], v33 offset:19456
    v_exp_f32 v204, v204
    s_waitcnt vmcnt(9)
    s_barrier
    s_waitcnt lgkmcnt(5)
    v_mfma_f32_16x16x32_bf16 v[236:239], v[108:111], a[24:27], v[236:239]
    v_subrev_u32 v33, 61440, v33
    ds_read_b128 v[148:151], v33 offset:0
    v_exp_f32 v205, v205
    v_mfma_f32_16x16x32_bf16 v[240:243], v[112:115], a[24:27], v[240:243]
    ds_read_b128 v[152:155], v33 offset:1024
    s_mov_b32 s69, 12288
    buffer_load_dwordx4 a[48:51], v32, s[36:39], s69 offen offset:0 sc1
    v_exp_f32_e64 v206, v206
    v_mfma_f32_16x16x32_bf16 v[244:247], v[116:119], a[24:27], v[244:247]
    ds_read_b128 v[156:159], v33 offset:2048
    v_exp_f32_e64 v207, v207
    v_mfma_f32_16x16x32_bf16 v[248:251], v[120:123], a[24:27], v[248:251]
    ds_read_b128 v[160:163], v33 offset:3072
    v_pk_add_f32 v[188:189], v[188:189], 1.0 op_sel_hi:[1,0]
    v_pk_add_f32 v[190:191], v[190:191], 1.0 op_sel_hi:[1,0]
    v_mfma_f32_16x16x32_bf16 v[252:255], v[124:127], a[24:27], v[252:255]
    ds_read_b128 v[164:167], v33 offset:4096
    buffer_load_dwordx4 a[52:55], v32, s[36:39], s69 offen offset:1024 sc1
    v_pk_add_f32 v[192:193], v[192:193], 1.0 op_sel_hi:[1,0]
    v_pk_add_f32 v[194:195], v[194:195], 1.0 op_sel_hi:[1,0]
    s_waitcnt lgkmcnt(5)
    v_mfma_f32_16x16x32_bf16 v[236:239], v[128:131], a[28:31], v[236:239]
    ds_read_b128 v[108:111], v33 offset:5120
    v_pk_add_f32 v[196:197], v[196:197], 1.0 op_sel_hi:[1,0]
    v_pk_add_f32 v[198:199], v[198:199], 1.0 op_sel_hi:[1,0]
    v_mfma_f32_16x16x32_bf16 v[240:243], v[132:135], a[28:31], v[240:243]
    ds_read_b128 v[112:115], v33 offset:6144
    v_pk_add_f32 v[200:201], v[200:201], 1.0 op_sel_hi:[1,0]
    v_pk_add_f32 v[202:203], v[202:203], 1.0 op_sel_hi:[1,0]
    v_mfma_f32_16x16x32_bf16 v[244:247], v[136:139], a[28:31], v[244:247]
    ds_read_b128 v[116:119], v33 offset:7168
    buffer_load_dwordx4 a[56:59], v32, s[36:39], s69 offen offset:2048 sc1
    v_pk_add_f32 v[204:205], v[204:205], 1.0 op_sel_hi:[1,0]
    v_pk_add_f32 v[206:207], v[206:207], 1.0 op_sel_hi:[1,0]
    v_mfma_f32_16x16x32_bf16 v[248:251], v[140:143], a[28:31], v[248:251]
    ds_read_b128 v[120:123], v33 offset:8192
    v_rcp_f32 v188, v188
    v_mfma_f32_16x16x32_bf16 v[252:255], v[144:147], a[28:31], v[252:255]
    ds_read_b128 v[124:127], v33 offset:9216
    v_rcp_f32 v189, v189
    s_waitcnt lgkmcnt(5)
    s_waitcnt vmcnt(11)
    v_mfma_f32_16x16x32_bf16 v[236:239], v[148:151], a[32:35], v[236:239]
    ds_read_b128 v[128:131], v33 offset:10240
    buffer_load_dwordx4 a[60:63], v32, s[36:39], s69 offen offset:3072 sc1
    v_rcp_f32 v190, v190
    v_mfma_f32_16x16x32_bf16 v[240:243], v[152:155], a[32:35], v[240:243]
    ds_read_b128 v[132:135], v33 offset:11264
    v_rcp_f32_e64 v191, v191
    v_mfma_f32_16x16x32_bf16 v[244:247], v[156:159], a[32:35], v[244:247]
    ds_read_b128 v[136:139], v33 offset:12288
    v_rcp_f32_e64 v192, v192
    v_mfma_f32_16x16x32_bf16 v[248:251], v[160:163], a[32:35], v[248:251]
    ds_read_b128 v[140:143], v33 offset:13312
    s_mov_b32 s70, 327680
    s_add_u32 m0, s74, 102400
    s_nop 0
    buffer_load_dwordx4 v30, s[36:39], s70 offen offset:0 sc1 lds
    v_mfma_f32_16x16x32_bf16 v[252:255], v[164:167], a[32:35], v[252:255]
    ds_read_b128 v[144:147], v33 offset:14336
    v_rcp_f32 v193, v193
    s_waitcnt lgkmcnt(5)
    s_waitcnt vmcnt(12)
    v_mfma_f32_16x16x32_bf16 v[236:239], v[108:111], a[36:39], v[236:239]
    ds_read_b128 v[148:151], v33 offset:15360
    v_rcp_f32_e64 v194, v194
    v_mfma_f32_16x16x32_bf16 v[240:243], v[112:115], a[36:39], v[240:243]
    ds_read_b128 v[152:155], v33 offset:16384
    buffer_load_dwordx4 v30, s[36:39], s70 offen offset:1024 sc1 lds
    v_rcp_f32_e64 v195, v195
    v_mfma_f32_16x16x32_bf16 v[244:247], v[116:119], a[36:39], v[244:247]
    ds_read_b128 v[156:159], v33 offset:17408
    v_rcp_f32_e64 v196, v196
    v_mfma_f32_16x16x32_bf16 v[248:251], v[120:123], a[36:39], v[248:251]
    ds_read_b128 v[160:163], v33 offset:18432
    v_rcp_f32_e64 v197, v197
    v_mfma_f32_16x16x32_bf16 v[252:255], v[124:127], a[36:39], v[252:255]
    ds_read_b128 v[164:167], v33 offset:19456
    buffer_load_dwordx4 v30, s[36:39], s70 offen offset:2048 sc1 lds
    v_rcp_f32 v198, v198
    s_waitcnt vmcnt(7)
    s_barrier
    s_waitcnt lgkmcnt(5)
    v_mfma_f32_16x16x32_bf16 v[236:239], v[128:131], a[40:43], v[236:239]
    ds_read_b128 v[108:111], v33 offset:20480
    v_rcp_f32_e64 v199, v199
    v_mfma_f32_16x16x32_bf16 v[240:243], v[132:135], a[40:43], v[240:243]
    ds_read_b128 v[112:115], v33 offset:21504
    v_rcp_f32_e64 v200, v200
    v_mfma_f32_16x16x32_bf16 v[244:247], v[136:139], a[40:43], v[244:247]
    ds_read_b128 v[116:119], v33 offset:22528
    buffer_load_dwordx4 v30, s[36:39], s70 offen offset:3072 sc1 lds
    v_rcp_f32_e64 v201, v201
    v_mfma_f32_16x16x32_bf16 v[248:251], v[140:143], a[40:43], v[248:251]
    ds_read_b128 v[120:123], v33 offset:23552
    v_rcp_f32_e64 v202, v202
    v_mfma_f32_16x16x32_bf16 v[252:255], v[144:147], a[40:43], v[252:255]
    ds_read_b128 v[124:127], v33 offset:24576
    v_rcp_f32 v203, v203
    s_waitcnt lgkmcnt(5)
    v_mfma_f32_16x16x32_bf16 v[236:239], v[148:151], a[44:47], v[236:239]
    ds_read_b128 v[128:131], v33 offset:25600
    s_mov_b32 s70, 331776
    s_add_u32 m0, s74, 106496
    s_nop 0
    buffer_load_dwordx4 v30, s[36:39], s70 offen sc1 lds
    v_mfma_f32_16x16x32_bf16 v[240:243], v[152:155], a[44:47], v[240:243]
    ds_read_b128 v[132:135], v33 offset:26624
    v_rcp_f32 v204, v204
    v_mfma_f32_16x16x32_bf16 v[244:247], v[156:159], a[44:47], v[244:247]
    ds_read_b128 v[136:139], v33 offset:27648
    v_rcp_f32_e64 v205, v205
    v_mfma_f32_16x16x32_bf16 v[248:251], v[160:163], a[44:47], v[248:251]
    ds_read_b128 v[140:143], v33 offset:28672
    s_mov_b32 s69, 16384
    buffer_load_dwordx4 a[64:67], v32, s[36:39], s69 offen offset:0 sc1
    v_rcp_f32_e64 v206, v206
    v_mfma_f32_16x16x32_bf16 v[252:255], v[164:167], a[44:47], v[252:255]
    ds_read_b128 v[144:147], v33 offset:29696
    v_rcp_f32 v207, v207
    s_waitcnt lgkmcnt(5)
    s_waitcnt vmcnt(9)
    v_mfma_f32_16x16x32_bf16 v[236:239], v[108:111], a[48:51], v[236:239]
    ds_read_b128 v[148:151], v33 offset:30720
    v_pk_mul_f32 v[188:189], v[88:89], v[188:189]
    v_pk_mul_f32 v[190:191], v[90:91], v[190:191]
    v_mfma_f32_16x16x32_bf16 v[240:243], v[112:115], a[48:51], v[240:243]
    ds_read_b128 v[152:155], v33 offset:31744
    buffer_load_dwordx4 a[68:71], v32, s[36:39], s69 offen offset:1024 sc1
    v_pk_mul_f32 v[192:193], v[92:93], v[192:193]
    v_pk_mul_f32 v[194:195], v[94:95], v[194:195]
    v_mfma_f32_16x16x32_bf16 v[244:247], v[116:119], a[48:51], v[244:247]
    ds_read_b128 v[156:159], v33 offset:32768
    v_pk_mul_f32 v[196:197], v[96:97], v[196:197]
    v_pk_mul_f32 v[198:199], v[98:99], v[198:199]
    v_mfma_f32_16x16x32_bf16 v[248:251], v[120:123], a[48:51], v[248:251]
    ds_read_b128 v[160:163], v33 offset:33792
    v_pk_mul_f32 v[200:201], v[100:101], v[200:201]
    v_pk_mul_f32 v[202:203], v[102:103], v[202:203]
    v_mfma_f32_16x16x32_bf16 v[252:255], v[124:127], a[48:51], v[252:255]
    ds_read_b128 v[164:167], v33 offset:34816
    buffer_load_dwordx4 a[72:75], v32, s[36:39], s69 offen offset:2048 sc1
    v_pk_mul_f32 v[204:205], v[104:105], v[204:205]
    v_pk_mul_f32 v[206:207], v[106:107], v[206:207]
    s_waitcnt lgkmcnt(5)
    s_waitcnt vmcnt(10)
    v_mfma_f32_16x16x32_bf16 v[236:239], v[128:131], a[52:55], v[236:239]
    ds_read_b128 v[108:111], v33 offset:35840
    v_lshlrev_b32 v228, 16, v208
    v_and_b32 v229, 0xffff0000, v208
    v_mfma_f32_16x16x32_bf16 v[240:243], v[132:135], a[52:55], v[240:243]
    ds_read_b128 v[112:115], v33 offset:36864
    v_lshlrev_b32_e64 v230, 16, v209
    v_and_b32 v231, 0xffff0000, v209
    v_mfma_f32_16x16x32_bf16 v[244:247], v[136:139], a[52:55], v[244:247]
    ds_read_b128 v[116:119], v33 offset:37888
    buffer_load_dwordx4 a[76:79], v32, s[36:39], s69 offen offset:3072 sc1
    v_lshlrev_b32_e64 v232, 16, v210
    v_and_b32 v233, 0xffff0000, v210
    v_mfma_f32_16x16x32_bf16 v[248:251], v[140:143], a[52:55], v[248:251]
    ds_read_b128 v[120:123], v33 offset:38912
    v_lshlrev_b32_e64 v234, 16, v211
    v_and_b32 v235, 0xffff0000, v211
    v_mfma_f32_16x16x32_bf16 v[252:255], v[144:147], a[52:55], v[252:255]
    ds_read_b128 v[124:127], v33 offset:39936
    v_lshlrev_b32_e64 v220, 16, v212
    v_and_b32 v221, 0xffff0000, v212
    s_waitcnt vmcnt(4)
    s_barrier
    s_waitcnt lgkmcnt(5)
    v_mfma_f32_16x16x32_bf16 v[236:239], v[148:151], a[56:59], v[236:239]
    ds_read_b128 v[128:131], v33 offset:40960
    v_lshlrev_b32 v222, 16, v213
    v_and_b32 v223, 0xffff0000, v213
    v_mfma_f32_16x16x32_bf16 v[240:243], v[152:155], a[56:59], v[240:243]
    ds_read_b128 v[132:135], v33 offset:41984
    v_lshlrev_b32_e64 v224, 16, v214
    v_and_b32 v225, 0xffff0000, v214
    v_mfma_f32_16x16x32_bf16 v[244:247], v[156:159], a[56:59], v[244:247]
    ds_read_b128 v[136:139], v33 offset:43008
    v_lshlrev_b32_e64 v226, 16, v215
    v_and_b32 v227, 0xffff0000, v215
    v_mfma_f32_16x16x32_bf16 v[248:251], v[160:163], a[56:59], v[248:251]
    ds_read_b128 v[140:143], v33 offset:44032
    v_lshlrev_b32_e64 v180, 16, v216
    v_and_b32 v181, 0xffff0000, v216
    v_mfma_f32_16x16x32_bf16 v[252:255], v[164:167], a[56:59], v[252:255]
    ds_read_b128 v[144:147], v33 offset:45056
    v_lshlrev_b32_e64 v182, 16, v217
    v_and_b32 v183, 0xffff0000, v217
    s_waitcnt lgkmcnt(5)
    v_mfma_f32_16x16x32_bf16 v[236:239], v[108:111], a[60:63], v[236:239]
    ds_read_b128 v[148:151], v33 offset:46080
    v_lshlrev_b32 v184, 16, v218
    v_and_b32 v185, 0xffff0000, v218
    v_mfma_f32_16x16x32_bf16 v[240:243], v[112:115], a[60:63], v[240:243]
    ds_read_b128 v[152:155], v33 offset:47104
    v_lshlrev_b32_e64 v186, 16, v219
    v_and_b32 v187, 0xffff0000, v219
    v_mfma_f32_16x16x32_bf16 v[244:247], v[116:119], a[60:63], v[244:247]
    ds_read_b128 v[156:159], v33 offset:48128
    v_mfma_f32_16x16x32_bf16 v[248:251], v[120:123], a[60:63], v[248:251]
    ds_read_b128 v[160:163], v33 offset:49152
    v_mfma_f32_16x16x32_bf16 v[252:255], v[124:127], a[60:63], v[252:255]
    ds_read_b128 v[164:167], v33 offset:50176
    s_waitcnt lgkmcnt(5)
    s_waitcnt vmcnt(3)
    v_mfma_f32_16x16x32_bf16 v[236:239], v[128:131], a[64:67], v[236:239]
    ds_read_b128 v[108:111], v33 offset:51200
    v_mfma_f32_16x16x32_bf16 v[240:243], v[132:135], a[64:67], v[240:243]
    ds_read_b128 v[112:115], v33 offset:52224
    v_mfma_f32_16x16x32_bf16 v[244:247], v[136:139], a[64:67], v[244:247]
    ds_read_b128 v[116:119], v33 offset:53248
    v_mfma_f32_16x16x32_bf16 v[248:251], v[140:143], a[64:67], v[248:251]
    ds_read_b128 v[120:123], v33 offset:54272
    v_mfma_f32_16x16x32_bf16 v[252:255], v[144:147], a[64:67], v[252:255]
    ds_read_b128 v[124:127], v33 offset:55296
    s_waitcnt lgkmcnt(5)
    s_waitcnt vmcnt(2)
    v_mfma_f32_16x16x32_bf16 v[236:239], v[148:151], a[68:71], v[236:239]
    ds_read_b128 v[128:131], v33 offset:56320
    v_mfma_f32_16x16x32_bf16 v[240:243], v[152:155], a[68:71], v[240:243]
    ds_read_b128 v[132:135], v33 offset:57344
    v_mfma_f32_16x16x32_bf16 v[244:247], v[156:159], a[68:71], v[244:247]
    ds_read_b128 v[136:139], v33 offset:58368
    v_mfma_f32_16x16x32_bf16 v[248:251], v[160:163], a[68:71], v[248:251]
    ds_read_b128 v[140:143], v33 offset:59392
    v_mfma_f32_16x16x32_bf16 v[252:255], v[164:167], a[68:71], v[252:255]
    ds_read_b128 v[144:147], v33 offset:60416
    s_waitcnt lgkmcnt(5)
    s_waitcnt vmcnt(1)
    v_mfma_f32_16x16x32_bf16 v[236:239], v[108:111], a[72:75], v[236:239]
    v_mfma_f32_16x16x32_bf16 v[240:243], v[112:115], a[72:75], v[240:243]
    v_mfma_f32_16x16x32_bf16 v[244:247], v[116:119], a[72:75], v[244:247]
    v_mfma_f32_16x16x32_bf16 v[248:251], v[120:123], a[72:75], v[248:251]
    v_mfma_f32_16x16x32_bf16 v[252:255], v[124:127], a[72:75], v[252:255]
    s_waitcnt lgkmcnt(0)
    s_waitcnt vmcnt(0)
    v_mfma_f32_16x16x32_bf16 v[236:239], v[128:131], a[76:79], v[236:239]
    v_mfma_f32_16x16x32_bf16 v[240:243], v[132:135], a[76:79], v[240:243]
    v_mfma_f32_16x16x32_bf16 v[244:247], v[136:139], a[76:79], v[244:247]
    v_mfma_f32_16x16x32_bf16 v[248:251], v[140:143], a[76:79], v[248:251]
    v_mfma_f32_16x16x32_bf16 v[252:255], v[144:147], a[76:79], v[252:255]
    s_nop 3
    v_pk_mul_f32 v[188:189], v[236:237], v[188:189]
    v_pk_mul_f32 v[190:191], v[238:239], v[190:191]
    ds_write_b128 v17, v[188:191] offset:0
    v_pk_mul_f32 v[192:193], v[240:241], v[192:193]
    v_pk_mul_f32 v[194:195], v[242:243], v[194:195]
    ds_write_b128 v17, v[192:195] offset:64
    v_pk_mul_f32 v[196:197], v[244:245], v[196:197]
    v_pk_mul_f32 v[198:199], v[246:247], v[198:199]
    ds_write_b128 v17, v[196:199] offset:128
    v_pk_mul_f32 v[200:201], v[248:249], v[200:201]
    v_pk_mul_f32 v[202:203], v[250:251], v[202:203]
    ds_write_b128 v17, v[200:203] offset:192
    v_pk_mul_f32 v[204:205], v[252:253], v[204:205]
    v_pk_mul_f32 v[206:207], v[254:255], v[206:207]
    ds_write_b128 v17, v[204:207] offset:256
    ds_read_b128 v[108:111], v22
    ds_read_b128 v[112:115], v22 offset:16
    ds_read_b128 v[116:119], v23
    ds_read_b128 v[120:123], v23 offset:16
    ds_read_b128 v[124:127], v24
    ds_read_b128 v[128:131], v24 offset:16
    s_waitcnt lgkmcnt(5)
    v_pk_add_f32 v[228:229], v[228:229], v[108:109]
    v_pk_add_f32 v[230:231], v[230:231], v[110:111]
    s_waitcnt lgkmcnt(4)
    v_pk_add_f32 v[232:233], v[232:233], v[112:113]
    v_pk_add_f32 v[234:235], v[234:235], v[114:115]
    v_cvt_pk_bf16_f32 v208, v228, v229
    v_cvt_pk_bf16_f32 v209, v230, v231
    v_cvt_pk_bf16_f32 v210, v232, v233
    v_cvt_pk_bf16_f32 v211, v234, v235
    buffer_store_dwordx4 v[208:211], v18, s[48:51], 0 offen
    s_waitcnt lgkmcnt(3)
    v_pk_add_f32 v[220:221], v[220:221], v[116:117]
    v_pk_add_f32 v[222:223], v[222:223], v[118:119]
    s_waitcnt lgkmcnt(2)
    v_pk_add_f32 v[224:225], v[224:225], v[120:121]
    v_pk_add_f32 v[226:227], v[226:227], v[122:123]
    v_cvt_pk_bf16_f32 v212, v220, v221
    v_cvt_pk_bf16_f32 v213, v222, v223
    v_cvt_pk_bf16_f32 v214, v224, v225
    v_cvt_pk_bf16_f32 v215, v226, v227
    buffer_store_dwordx4 v[212:215], v19, s[48:51], 0 offen
    s_waitcnt lgkmcnt(1)
    v_pk_add_f32 v[180:181], v[180:181], v[124:125]
    v_pk_add_f32 v[182:183], v[182:183], v[126:127]
    s_waitcnt lgkmcnt(0)
    v_pk_add_f32 v[184:185], v[184:185], v[128:129]
    v_pk_add_f32 v[186:187], v[186:187], v[130:131]
    v_cvt_pk_bf16_f32 v216, v180, v181
    v_cvt_pk_bf16_f32 v217, v182, v183
    v_cvt_pk_bf16_f32 v218, v184, v185
    v_cvt_pk_bf16_f32 v219, v186, v187
    buffer_store_dwordx4 v[216:219], v20, s[48:51], 0 offen
    s_endpgm
L_end:
    s_endpgm
.fill 2113, 4, 0xbf810000
.section .rodata,"a"
.p2align 6
.amdhsa_kernel recurrent_scan__linear_kernel_hedgehog__dense_activation_silu__prompt_kernel
  .amdhsa_next_free_vgpr 512
  .amdhsa_next_free_sgpr 102
  .amdhsa_accum_offset 256
  .amdhsa_group_segment_fixed_size 0
  .amdhsa_kernarg_size 80
  .amdhsa_user_sgpr_count 2
  .amdhsa_user_sgpr_kernarg_segment_ptr 1
  .amdhsa_system_sgpr_workgroup_id_x 1
.end_amdhsa_kernel
```
